```python
import torch

def _softmax(x, axis=-1):
    return torch.softmax(x, dim=axis)

def _gelu(x):
    return torch.nn.functional.gelu(x, approximate='tanh')

def _silu(x):
    return torch.nn.functional.silu(x)

def _sigmoid(x):
    return torch.sigmoid(x)

def _layernorm(x, axis=-1, eps=1e-05):
    m = x.mean(dim=axis, keepdim=True)
    v = x.var(dim=axis, keepdim=True, unbiased=False)
    return (x - m) / torch.sqrt(v + eps)

def _scatter_add(tgt, idx, src, axis=0):
    return tgt.clone().index_add_(axis, idx, src)

def _segment_sum(src, seg, n):
    out = torch.zeros((n,) + src.shape[1:], dtype=src.dtype)
    return out.index_add_(0, seg, src)

def _pad(x, pw):
    flat = tuple((v for pair in reversed(pw) for v in pair))
    return torch.nn.functional.pad(x, flat)
kernel_name = 'adaLN_cond__spectral_gfnet__glu_gated_geglu__prompt'

def setup_inputs():

    _w = lambda a: (lambda t: t.to(torch.bfloat16) if t.is_floating_point() else t)(torch.as_tensor(a))

    def _A_setup():
        B, S, D = (1, 2048, 640)
        Df = D // 2 + 1
        return {'x': _w((lambda *s: torch.randn(*s, dtype=torch.bfloat16) * 0.05)(B, S, D)), 'w_r': _w((lambda *s: torch.randn(*s, dtype=torch.bfloat16) * 3.2)(S, Df) * 0.02), 'w_i': _w((lambda *s: torch.randn(*s, dtype=torch.bfloat16) * 3.2)(S, Df) * 0.02)}
    _A_in = _A_setup()

    def _B_setup():
        B, S, Dm, Df = (1, 2048, 640, 1536)
        return {'x': _w((lambda *s: torch.randn(*s, dtype=torch.bfloat16) * 0.05)(B, S, Dm)), 'w_gate': _w((lambda *s: torch.randn(*s, dtype=torch.bfloat16) * 0.4)(Dm, Df) * Dm ** (-0.5)), 'w_up': _w((lambda *s: torch.randn(*s, dtype=torch.bfloat16) * 0.4)(Dm, Df) * Dm ** (-0.5)), 'w_down': _w((lambda *s: torch.randn(*s, dtype=torch.bfloat16) * 0.4)(Df, Dm) * Df ** (-0.5))}
    _B_in = _B_setup()
    return {'A_x': _A_in['x'], 'A_w_r': _A_in['w_r'], 'A_w_i': _A_in['w_i'], 'B_x': _B_in['x'], 'B_w_gate': _B_in['w_gate'], 'B_w_up': _B_in['w_up'], 'B_w_down': _B_in['w_down'], 'c': _w((lambda *s: torch.randn(*s, dtype=torch.bfloat16) * 0.1)(1, 640) * 8.0), 'w_mod': _w((lambda *s: torch.randn(*s, dtype=torch.bfloat16) * 0.1)(640, 6 * 640) * 640 ** (-0.5) * 8.0)}

def reference(A_x, A_w_r, A_w_i, B_x, B_w_gate, B_w_up, B_w_down, c, w_mod):

    def _A_ref(x, w_r, w_i):
        B, S, D = x.shape
        X = (lambda x, axes=(-2, -1): torch.fft.rfft2(x.float(), dim=axes))(x, axes=(-2, -1))
        W = w_r + 1j * w_i
        X = X * W
        y = (lambda x, s, axes=(-2, -1): torch.fft.irfft2(x, s=s, dim=axes).to(torch.bfloat16))(X, (S, D), axes=(-2, -1))
        return y

    def _B_ref(x, w_gate, w_up, w_down):
        g = torch.einsum('bsd,df->bsf', x, w_gate)
        u = torch.einsum('bsd,df->bsf', x, w_up)
        h = _gelu(g) * u
        return torch.einsum('bsf,fd->bsd', h, w_down)
    x = A_x
    mod = (_silu(c) @ w_mod).reshape(c.shape[0], 6, 1, -1)
    sa, ca, ga, sb, cb, gb = (mod[:, 0].clone(), mod[:, 1].clone(), mod[:, 2].clone(), mod[:, 3].clone(), mod[:, 4].clone(), mod[:, 5].clone())
    h = _layernorm(x, axis=-1) * (1 + ca) + sa
    x = x + ga * _A_ref(h, A_w_r, A_w_i)
    h = _layernorm(x, axis=-1) * (1 + cb) + sb
    x = x + gb * _B_ref(h, B_w_gate, B_w_up, B_w_down)
    return x
```

```asm
; @launch kernel=k1_kernel grid=(344,1,1) block=(256,1,1) lds=81920
; @launch kernel=k2_kernel grid=(256,1,1) block=(512,1,1) lds=54272
; @launch kernel=kf_kernel grid=(256,1,1) block=(256,1,1) lds=163840
.amdgcn_target "amdgcn-amd-amdhsa--gfx950"
.text
.globl k1_kernel
.p2align 8
.type k1_kernel,@function
k1_kernel:
    s_load_dwordx2 s[8:9], s[0:1], 88
    s_cmp_ge_u32 s2, 344
    s_cbranch_scc1 K1_END
    s_cmp_ge_u32 s2, 280
    s_cbranch_scc1 K1_WM
    s_cmp_ge_u32 s2, 160
    s_cbranch_scc1 K1_MOD
    s_load_dwordx2 s[4:5], s[0:1], 0
    s_and_b32 s12, s2, 31
    s_lshr_b32 s13, s2, 5
    s_mul_i32 s14, s12, 1280
    s_lshl_b32 s15, s13, 8
    v_and_b32 v1, 15, v0
    v_bfe_u32 v2, v0, 4, 2
    v_lshrrev_b32 v3, 6, v0
    v_and_b32 v14, 63, v0
    v_readfirstlane_b32 s20, v3
    s_mov_b32 s16, 40960
    v_lshrrev_b32 v4, 3, v14
    v_bfe_u32 v5, v4, 1, 1
    v_and_b32 v6, 7, v14
    v_xor_b32 v5, v5, v6
    v_lshl_add_u32 v4, v3, 4, v4
    v_mul_lo_u32 v4, v4, s16
    v_add_u32 v4, s14, v4
    v_xor_b32 v6, 6, v5
    v_lshl_add_u32 v6, v6, 4, v4
    v_add_u32 v6, 326656, v6
    v_lshl_add_u32 v4, v5, 4, v4
    s_lshl_b32 s21, s20, 11
    s_add_u32 s18, s14, s15
    v_lshrrev_b32 v16, 1, v1
    v_cvt_f32_u32 v16, v16
    v_and_b32 v7, 1, v1
    v_cvt_f32_u32 v7, v7
    v_mul_f32 v7, 0x3e800000, v7
    v_lshlrev_b32 v8, 3, v2
    v_cvt_f32_u32 v8, v8
    v_cmp_eq_u32 vcc, 1, v1
    v_mov_b32 v9, 0x42000000
    s_nop 0
    v_cndmask_b32 v9, v16, v9, vcc
    v_mov_b32 v10, 0
    v_cndmask_b32 v10, v7, v10, vcc
    v_bfe_u32 v11, v1, 1, 1
    s_mov_b32 s22, 0x80008000
    v_mul_lo_u32 v11, v11, s22
    s_waitcnt lgkmcnt(0)
    s_and_b32 s5, s5, 0xffff
    s_mov_b32 s6, 0x280000
    s_mov_b32 s7, 0x00020000
    s_and_b32 s9, s9, 0xffff
    s_mov_b32 s10, 0x10000000
    s_mov_b32 s11, 0x00020000
    s_mov_b32 s19, s15
    s_add_u32 m0, s21, 0
    s_nop 0
    buffer_load_dwordx4 v4, s[4:7], s19 offen lds
    buffer_load_dwordx4 v6, s[4:7], s19 offen offset:1024 lds
    s_add_u32 s19, s19, 128
    s_cmp_eq_u32 s19, 1280
    s_cselect_b32 s19, 0, s19
    s_add_u32 m0, s21, 8192
    s_nop 0
    buffer_load_dwordx4 v4, s[4:7], s19 offen lds
    buffer_load_dwordx4 v6, s[4:7], s19 offen offset:1024 lds
    s_add_u32 s19, s19, 128
    s_cmp_eq_u32 s19, 1280
    s_cselect_b32 s19, 0, s19
    s_add_u32 m0, s21, 16384
    s_nop 0
    buffer_load_dwordx4 v4, s[4:7], s19 offen lds
    buffer_load_dwordx4 v6, s[4:7], s19 offen offset:1024 lds
    s_add_u32 s19, s19, 128
    s_cmp_eq_u32 s19, 1280
    s_cselect_b32 s19, 0, s19
    s_add_u32 m0, s21, 24576
    s_nop 0
    buffer_load_dwordx4 v4, s[4:7], s19 offen lds
    buffer_load_dwordx4 v6, s[4:7], s19 offen offset:1024 lds
    s_add_u32 s19, s19, 128
    s_cmp_eq_u32 s19, 1280
    s_cselect_b32 s19, 0, s19
    v_mul_f32 v12, 0x3c800000, v9
    v_fma_f32 v13, v8, v12, v10
    v_fract_f32 v144, v13
    v_add_f32 v13, v13, v12
    v_fract_f32 v145, v13
    v_add_f32 v13, v13, v12
    v_fract_f32 v146, v13
    v_add_f32 v13, v13, v12
    v_fract_f32 v147, v13
    v_add_f32 v13, v13, v12
    v_fract_f32 v148, v13
    v_add_f32 v13, v13, v12
    v_fract_f32 v149, v13
    v_add_f32 v13, v13, v12
    v_fract_f32 v150, v13
    v_add_f32 v13, v13, v12
    v_fract_f32 v151, v13
    v_cos_f32 v144, v144
    v_cos_f32 v145, v145
    v_cos_f32 v146, v146
    s_add_u32 m0, s21, 32768
    s_nop 0
    buffer_load_dwordx4 v4, s[4:7], s19 offen lds
    buffer_load_dwordx4 v6, s[4:7], s19 offen offset:1024 lds
    s_add_u32 s19, s19, 128
    s_cmp_eq_u32 s19, 1280
    s_cselect_b32 s19, 0, s19
    v_cos_f32 v147, v147
    v_cos_f32 v148, v148
    v_cos_f32 v149, v149
    v_cos_f32 v150, v150
    v_cos_f32 v151, v151
    v_cvt_pk_f16_f32 v112, v144, v145
    v_cvt_pk_f16_f32 v113, v146, v147
    v_cvt_pk_f16_f32 v114, v148, v149
    v_cvt_pk_f16_f32 v115, v150, v151
    v_xor_b32 v116, v112, v11
    v_xor_b32 v117, v113, v11
    v_xor_b32 v118, v114, v11
    v_xor_b32 v119, v115, v11
    v_add_f32 v12, 0x41000000, v16
    v_mul_f32 v12, 0x3c800000, v12
    v_fma_f32 v13, v8, v12, v7
    v_fract_f32 v144, v13
    v_add_f32 v13, v13, v12
    v_fract_f32 v145, v13
    v_add_f32 v13, v13, v12
    s_add_u32 m0, s21, 40960
    s_nop 0
    buffer_load_dwordx4 v4, s[4:7], s19 offen lds
    buffer_load_dwordx4 v6, s[4:7], s19 offen offset:1024 lds
    s_add_u32 s19, s19, 128
    s_cmp_eq_u32 s19, 1280
    s_cselect_b32 s19, 0, s19
    v_fract_f32 v146, v13
    v_add_f32 v13, v13, v12
    v_fract_f32 v147, v13
    v_add_f32 v13, v13, v12
    v_fract_f32 v148, v13
    v_add_f32 v13, v13, v12
    v_fract_f32 v149, v13
    v_add_f32 v13, v13, v12
    v_fract_f32 v150, v13
    v_add_f32 v13, v13, v12
    v_fract_f32 v151, v13
    v_cos_f32 v144, v144
    v_cos_f32 v145, v145
    v_cos_f32 v146, v146
    v_cos_f32 v147, v147
    v_cos_f32 v148, v148
    v_cos_f32 v149, v149
    v_cos_f32 v150, v150
    v_cos_f32 v151, v151
    v_cvt_pk_f16_f32 v120, v144, v145
    s_add_u32 m0, s21, 49152
    s_nop 0
    buffer_load_dwordx4 v4, s[4:7], s19 offen lds
    buffer_load_dwordx4 v6, s[4:7], s19 offen offset:1024 lds
    s_add_u32 s19, s19, 128
    s_cmp_eq_u32 s19, 1280
    s_cselect_b32 s19, 0, s19
    v_cvt_pk_f16_f32 v121, v146, v147
    v_cvt_pk_f16_f32 v122, v148, v149
    v_cvt_pk_f16_f32 v123, v150, v151
    v_xor_b32 v124, v120, v11
    v_xor_b32 v125, v121, v11
    v_xor_b32 v126, v122, v11
    v_xor_b32 v127, v123, v11
    v_add_f32 v12, 0x41800000, v16
    v_mul_f32 v12, 0x3c800000, v12
    v_fma_f32 v13, v8, v12, v7
    v_fract_f32 v144, v13
    v_add_f32 v13, v13, v12
    v_fract_f32 v145, v13
    v_add_f32 v13, v13, v12
    v_fract_f32 v146, v13
    v_add_f32 v13, v13, v12
    v_fract_f32 v147, v13
    v_add_f32 v13, v13, v12
    v_fract_f32 v148, v13
    v_add_f32 v13, v13, v12
    s_add_u32 m0, s21, 57344
    s_nop 0
    buffer_load_dwordx4 v4, s[4:7], s19 offen lds
    buffer_load_dwordx4 v6, s[4:7], s19 offen offset:1024 lds
    s_add_u32 s19, s19, 128
    s_cmp_eq_u32 s19, 1280
    s_cselect_b32 s19, 0, s19
    v_fract_f32 v149, v13
    v_add_f32 v13, v13, v12
    v_fract_f32 v150, v13
    v_add_f32 v13, v13, v12
    v_fract_f32 v151, v13
    v_cos_f32 v144, v144
    v_cos_f32 v145, v145
    v_cos_f32 v146, v146
    v_cos_f32 v147, v147
    v_cos_f32 v148, v148
    v_cos_f32 v149, v149
    v_cos_f32 v150, v150
    v_cos_f32 v151, v151
    v_cvt_pk_f16_f32 v128, v144, v145
    v_cvt_pk_f16_f32 v129, v146, v147
    v_cvt_pk_f16_f32 v130, v148, v149
    v_cvt_pk_f16_f32 v131, v150, v151
    v_xor_b32 v132, v128, v11
    v_xor_b32 v133, v129, v11
    v_xor_b32 v134, v130, v11
    s_add_u32 m0, s21, 65536
    s_nop 0
    buffer_load_dwordx4 v4, s[4:7], s19 offen lds
    buffer_load_dwordx4 v6, s[4:7], s19 offen offset:1024 lds
    s_add_u32 s19, s19, 128
    s_cmp_eq_u32 s19, 1280
    s_cselect_b32 s19, 0, s19
    v_xor_b32 v135, v131, v11
    v_add_f32 v12, 0x41c00000, v16
    v_mul_f32 v12, 0x3c800000, v12
    v_fma_f32 v13, v8, v12, v7
    v_fract_f32 v144, v13
    v_add_f32 v13, v13, v12
    v_fract_f32 v145, v13
    v_add_f32 v13, v13, v12
    v_fract_f32 v146, v13
    v_add_f32 v13, v13, v12
    v_fract_f32 v147, v13
    v_add_f32 v13, v13, v12
    v_fract_f32 v148, v13
    v_add_f32 v13, v13, v12
    v_fract_f32 v149, v13
    v_add_f32 v13, v13, v12
    v_fract_f32 v150, v13
    v_add_f32 v13, v13, v12
    v_fract_f32 v151, v13
    v_cos_f32 v144, v144
    s_add_u32 m0, s21, 73728
    s_nop 0
    buffer_load_dwordx4 v4, s[4:7], s19 offen lds
    buffer_load_dwordx4 v6, s[4:7], s19 offen offset:1024 lds
    s_add_u32 s19, s19, 128
    s_cmp_eq_u32 s19, 1280
    s_cselect_b32 s19, 0, s19
    v_cos_f32 v145, v145
    v_cos_f32 v146, v146
    v_cos_f32 v147, v147
    v_cos_f32 v148, v148
    v_cos_f32 v149, v149
    v_cos_f32 v150, v150
    v_cos_f32 v151, v151
    v_cvt_pk_f16_f32 v136, v144, v145
    v_cvt_pk_f16_f32 v137, v146, v147
    v_cvt_pk_f16_f32 v138, v148, v149
    v_cvt_pk_f16_f32 v139, v150, v151
    v_xor_b32 v140, v136, v11
    v_xor_b32 v141, v137, v11
    v_xor_b32 v142, v138, v11
    v_xor_b32 v143, v139, v11
    v_mov_b32 v152, 0x3f803f80
    v_mov_b32 v153, 0x3f803f80
    v_mov_b32 v154, 0x3f803f80
    v_mov_b32 v155, 0x3f803f80
    v_bfe_u32 v7, v1, 3, 1
    v_mul_u32_u24 v7, 6, v7
    v_bfe_u32 v8, v1, 1, 1
    v_or_b32 v7, v7, v8
    v_lshlrev_b32 v8, 1, v2
    v_xor_b32 v7, v7, v8
    v_lshlrev_b32 v7, 4, v7
    v_lshl_add_u32 v7, v1, 7, v7
    v_add_u32 v7, s21, v7
    v_xor_b32 v8, 16, v7
    v_add_u32 v9, 40960, v7
    v_add_u32 v10, 40960, v8
    v_and_b32 v12, 3, v1
    v_cmp_eq_u32 s[22:23], 1, v12
    v_cmp_eq_u32 s[24:25], 2, v12
    v_cmp_eq_u32 s[26:27], 3, v12
    v_lshrrev_b32 v13, 2, v1
    v_cmp_eq_u32 s[28:29], v13, v2
    v_and_b32 v15, 1, v2
    v_mul_u32_u24 v15, 6, v15
    v_bfe_u32 v17, v1, 3, 1
    v_or_b32 v15, v15, v17
    s_and_b32 s17, s20, 1
    s_lshl_b32 s17, s17, 2
    v_add_u32 v17, s17, v12
    v_xor_b32 v15, v15, v17
    v_lshlrev_b32 v15, 4, v15
    v_lshl_add_u32 v17, v2, 3, v13
    v_lshl_add_u32 v15, v17, 7, v15
    s_lshr_b32 s17, s20, 1
    s_lshl_b32 s17, s17, 13
    v_add_u32 v15, s17, v15
    s_waitcnt vmcnt(18)
    ds_read_b128 v[16:19], v7 offset:0
    ds_read_b128 v[20:23], v8 offset:0
    s_waitcnt vmcnt(16)
    ds_read_b128 v[24:27], v7 offset:8192
    ds_read_b128 v[28:31], v8 offset:8192
    s_waitcnt vmcnt(14)
    ds_read_b128 v[32:35], v7 offset:16384
    ds_read_b128 v[36:39], v8 offset:16384
    s_waitcnt lgkmcnt(5)
    v_mfma_f32_16x16x32_bf16 v[156:159], v[16:19], v[16:19], 0
    v_mfma_f32_16x16x32_bf16 v[160:163], v[152:155], v[16:19], 0
    s_waitcnt lgkmcnt(4)
    v_mfma_f32_16x16x32_bf16 v[156:159], v[20:23], v[20:23], v[156:159]
    v_mfma_f32_16x16x32_bf16 v[160:163], v[152:155], v[20:23], v[160:163]
    s_waitcnt vmcnt(12)
    ds_read_b128 v[40:43], v7 offset:24576
    ds_read_b128 v[44:47], v8 offset:24576
    s_waitcnt lgkmcnt(5)
    v_mfma_f32_16x16x32_bf16 v[156:159], v[24:27], v[24:27], v[156:159]
    v_mfma_f32_16x16x32_bf16 v[160:163], v[152:155], v[24:27], v[160:163]
    s_waitcnt lgkmcnt(4)
    v_mfma_f32_16x16x32_bf16 v[156:159], v[28:31], v[28:31], v[156:159]
    v_mfma_f32_16x16x32_bf16 v[160:163], v[152:155], v[28:31], v[160:163]
    s_waitcnt vmcnt(10)
    ds_read_b128 v[16:19], v7 offset:32768
    ds_read_b128 v[20:23], v8 offset:32768
    s_waitcnt lgkmcnt(5)
    v_mfma_f32_16x16x32_bf16 v[156:159], v[32:35], v[32:35], v[156:159]
    v_mfma_f32_16x16x32_bf16 v[160:163], v[152:155], v[32:35], v[160:163]
    s_waitcnt lgkmcnt(4)
    v_mfma_f32_16x16x32_bf16 v[156:159], v[36:39], v[36:39], v[156:159]
    v_mfma_f32_16x16x32_bf16 v[160:163], v[152:155], v[36:39], v[160:163]
    s_waitcnt vmcnt(8)
    ds_read_b128 v[24:27], v9 offset:0
    ds_read_b128 v[28:31], v10 offset:0
    s_waitcnt lgkmcnt(5)
    v_mfma_f32_16x16x32_bf16 v[156:159], v[40:43], v[40:43], v[156:159]
    v_mfma_f32_16x16x32_bf16 v[160:163], v[152:155], v[40:43], v[160:163]
    s_waitcnt lgkmcnt(4)
    v_mfma_f32_16x16x32_bf16 v[156:159], v[44:47], v[44:47], v[156:159]
    v_mfma_f32_16x16x32_bf16 v[160:163], v[152:155], v[44:47], v[160:163]
    s_waitcnt vmcnt(6)
    ds_read_b128 v[32:35], v9 offset:8192
    ds_read_b128 v[36:39], v10 offset:8192
    s_waitcnt lgkmcnt(5)
    v_mfma_f32_16x16x32_bf16 v[156:159], v[16:19], v[16:19], v[156:159]
    v_mfma_f32_16x16x32_bf16 v[160:163], v[152:155], v[16:19], v[160:163]
    s_waitcnt lgkmcnt(4)
    v_mfma_f32_16x16x32_bf16 v[156:159], v[20:23], v[20:23], v[156:159]
    v_mfma_f32_16x16x32_bf16 v[160:163], v[152:155], v[20:23], v[160:163]
    s_waitcnt vmcnt(4)
    ds_read_b128 v[40:43], v9 offset:16384
    ds_read_b128 v[44:47], v10 offset:16384
    s_waitcnt lgkmcnt(5)
    v_mfma_f32_16x16x32_bf16 v[156:159], v[24:27], v[24:27], v[156:159]
    v_mfma_f32_16x16x32_bf16 v[160:163], v[152:155], v[24:27], v[160:163]
    s_waitcnt lgkmcnt(4)
    v_mfma_f32_16x16x32_bf16 v[156:159], v[28:31], v[28:31], v[156:159]
    v_mfma_f32_16x16x32_bf16 v[160:163], v[152:155], v[28:31], v[160:163]
    s_waitcnt vmcnt(2)
    ds_read_b128 v[16:19], v9 offset:24576
    ds_read_b128 v[20:23], v10 offset:24576
    s_waitcnt lgkmcnt(5)
    v_mfma_f32_16x16x32_bf16 v[156:159], v[32:35], v[32:35], v[156:159]
    v_mfma_f32_16x16x32_bf16 v[160:163], v[152:155], v[32:35], v[160:163]
    s_waitcnt lgkmcnt(4)
    v_mfma_f32_16x16x32_bf16 v[156:159], v[36:39], v[36:39], v[156:159]
    v_mfma_f32_16x16x32_bf16 v[160:163], v[152:155], v[36:39], v[160:163]
    s_waitcnt vmcnt(0)
    ds_read_b128 v[24:27], v9 offset:32768
    ds_read_b128 v[28:31], v10 offset:32768
    s_waitcnt lgkmcnt(5)
    v_mfma_f32_16x16x32_bf16 v[156:159], v[40:43], v[40:43], v[156:159]
    v_mfma_f32_16x16x32_bf16 v[160:163], v[152:155], v[40:43], v[160:163]
    s_waitcnt lgkmcnt(4)
    v_mfma_f32_16x16x32_bf16 v[156:159], v[44:47], v[44:47], v[156:159]
    v_mfma_f32_16x16x32_bf16 v[160:163], v[152:155], v[44:47], v[160:163]
    s_waitcnt lgkmcnt(3)
    v_mfma_f32_16x16x32_bf16 v[156:159], v[16:19], v[16:19], v[156:159]
    v_mfma_f32_16x16x32_bf16 v[160:163], v[152:155], v[16:19], v[160:163]
    s_waitcnt lgkmcnt(2)
    v_mfma_f32_16x16x32_bf16 v[156:159], v[20:23], v[20:23], v[156:159]
    v_mfma_f32_16x16x32_bf16 v[160:163], v[152:155], v[20:23], v[160:163]
    s_waitcnt lgkmcnt(1)
    v_mfma_f32_16x16x32_bf16 v[156:159], v[24:27], v[24:27], v[156:159]
    v_mfma_f32_16x16x32_bf16 v[160:163], v[152:155], v[24:27], v[160:163]
    s_waitcnt lgkmcnt(0)
    v_mfma_f32_16x16x32_bf16 v[156:159], v[28:31], v[28:31], v[156:159]
    v_mfma_f32_16x16x32_bf16 v[160:163], v[152:155], v[28:31], v[160:163]
    s_nop 6
    v_cndmask_b32 v12, v156, v157, s[22:23]
    v_cndmask_b32 v12, v12, v158, s[24:25]
    v_cndmask_b32 v12, v12, v159, s[26:27]
    v_mul_f32 v13, 0x3acccccd, v160
    v_mul_f32 v12, 0x3acccccd, v12
    v_fma_f32 v12, -v13, v13, v12
    v_max_f32 v12, 0, v12
    v_cvt_pk_bf16_f32 v12, v12, v12
    v_and_b32 v12, 0xffff0000, v12
    v_cvt_pk_bf16_f32 v13, v13, v13
    v_and_b32 v13, 0xffff0000, v13
    v_add_f32 v12, 0x3727c5ac, v12
    v_cvt_pk_bf16_f32 v12, v12, v12
    v_and_b32 v12, 0xffff0000, v12
    v_sqrt_f32 v12, v12
    s_nop 0
    v_cvt_pk_bf16_f32 v12, v12, v12
    v_and_b32 v12, 0xffff0000, v12
    v_rcp_f32 v12, v12
    s_nop 0
    v_mul_f32 v18, 0x3e000000, v12
    v_mul_f32 v19, v13, v18
    v_sub_f32 v19, 0, v19
    v_lshl_add_u32 v12, v1, 3, s21
    v_add_u32 v12, 73728, v12
    s_mov_b64 s[30:31], exec
    s_and_b64 exec, exec, s[28:29]
    ds_write_b64 v12, v[18:19]
    s_mov_b64 exec, s[30:31]
    s_waitcnt lgkmcnt(0)
    s_barrier
    ds_read_b64_tr_b16 v[96:97], v15 offset:0
    ds_read_b64_tr_b16 v[98:99], v15 offset:512
    ds_read_b64_tr_b16 v[100:101], v15 offset:8
    ds_read_b64_tr_b16 v[102:103], v15 offset:520
    ds_read_b64_tr_b16 v[104:105], v15 offset:4096
    ds_read_b64_tr_b16 v[106:107], v15 offset:4608
    ds_read_b64_tr_b16 v[108:109], v15 offset:4104
    ds_read_b64_tr_b16 v[110:111], v15 offset:4616
    v_lshrrev_b32 v12, 1, v2
    v_lshlrev_b32 v12, 11, v12
    v_and_b32 v13, 1, v2
    v_lshl_add_u32 v12, v13, 6, v12
    v_add_u32 v12, 73728, v12
    ds_read_b128 v[16:19], v12 offset:0
    ds_read_b128 v[20:23], v12 offset:16
    ds_read_b128 v[24:27], v12 offset:32
    ds_read_b128 v[28:31], v12 offset:48
    ds_read_b128 v[32:35], v12 offset:4096
    ds_read_b128 v[36:39], v12 offset:4112
    ds_read_b128 v[40:43], v12 offset:4128
    ds_read_b128 v[44:47], v12 offset:4144
    v_mul_lo_u32 v12, v1, s16
    v_lshl_add_u32 v12, v3, 6, v12
    v_lshl_add_u32 v12, v2, 4, v12
    s_add_u32 s18, s18, 0x100000
    v_add_u32 v12, s18, v12
    s_waitcnt lgkmcnt(0)
    v_lshlrev_b32 v48, 16, v96
    v_and_b32 v49, 0xffff0000, v96
    v_fma_f32 v48, v48, v16, v17
    v_fma_f32 v49, v49, v18, v19
    v_cvt_pk_f16_f32 v80, v48, v49
    v_lshlrev_b32 v48, 16, v97
    v_and_b32 v49, 0xffff0000, v97
    v_fma_f32 v48, v48, v20, v21
    v_fma_f32 v49, v49, v22, v23
    v_cvt_pk_f16_f32 v81, v48, v49
    v_lshlrev_b32 v48, 16, v98
    v_and_b32 v49, 0xffff0000, v98
    v_fma_f32 v48, v48, v24, v25
    v_fma_f32 v49, v49, v26, v27
    v_cvt_pk_f16_f32 v82, v48, v49
    v_lshlrev_b32 v48, 16, v99
    v_and_b32 v49, 0xffff0000, v99
    v_fma_f32 v48, v48, v28, v29
    v_fma_f32 v49, v49, v30, v31
    v_cvt_pk_f16_f32 v83, v48, v49
    v_lshlrev_b32 v48, 16, v100
    v_and_b32 v49, 0xffff0000, v100
    v_fma_f32 v48, v48, v16, v17
    v_fma_f32 v49, v49, v18, v19
    v_cvt_pk_f16_f32 v84, v48, v49
    v_lshlrev_b32 v48, 16, v101
    v_and_b32 v49, 0xffff0000, v101
    v_fma_f32 v48, v48, v20, v21
    v_fma_f32 v49, v49, v22, v23
    v_cvt_pk_f16_f32 v85, v48, v49
    v_lshlrev_b32 v48, 16, v102
    v_and_b32 v49, 0xffff0000, v102
    v_fma_f32 v48, v48, v24, v25
    v_fma_f32 v49, v49, v26, v27
    v_cvt_pk_f16_f32 v86, v48, v49
    v_lshlrev_b32 v48, 16, v103
    v_and_b32 v49, 0xffff0000, v103
    v_fma_f32 v48, v48, v28, v29
    v_fma_f32 v49, v49, v30, v31
    v_cvt_pk_f16_f32 v87, v48, v49
    v_lshlrev_b32 v48, 16, v104
    v_and_b32 v49, 0xffff0000, v104
    v_fma_f32 v48, v48, v32, v33
    v_fma_f32 v49, v49, v34, v35
    v_cvt_pk_f16_f32 v88, v48, v49
    v_lshlrev_b32 v48, 16, v105
    v_and_b32 v49, 0xffff0000, v105
    v_fma_f32 v48, v48, v36, v37
    v_fma_f32 v49, v49, v38, v39
    v_cvt_pk_f16_f32 v89, v48, v49
    v_lshlrev_b32 v48, 16, v106
    v_and_b32 v49, 0xffff0000, v106
    v_fma_f32 v48, v48, v40, v41
    v_fma_f32 v49, v49, v42, v43
    v_cvt_pk_f16_f32 v90, v48, v49
    v_lshlrev_b32 v48, 16, v107
    v_and_b32 v49, 0xffff0000, v107
    v_fma_f32 v48, v48, v44, v45
    v_fma_f32 v49, v49, v46, v47
    v_cvt_pk_f16_f32 v91, v48, v49
    v_lshlrev_b32 v48, 16, v108
    v_and_b32 v49, 0xffff0000, v108
    v_fma_f32 v48, v48, v32, v33
    v_fma_f32 v49, v49, v34, v35
    v_cvt_pk_f16_f32 v92, v48, v49
    v_lshlrev_b32 v48, 16, v109
    v_and_b32 v49, 0xffff0000, v109
    v_fma_f32 v48, v48, v36, v37
    v_fma_f32 v49, v49, v38, v39
    v_cvt_pk_f16_f32 v93, v48, v49
    v_lshlrev_b32 v48, 16, v110
    v_and_b32 v49, 0xffff0000, v110
    v_fma_f32 v48, v48, v40, v41
    v_fma_f32 v49, v49, v42, v43
    v_cvt_pk_f16_f32 v94, v48, v49
    v_lshlrev_b32 v48, 16, v111
    v_and_b32 v49, 0xffff0000, v111
    v_fma_f32 v48, v48, v44, v45
    v_fma_f32 v49, v49, v46, v47
    v_cvt_pk_f16_f32 v95, v48, v49
    v_mfma_f32_16x16x32_f16 v[48:51], v[80:83], v[112:115], 0
    v_mfma_f32_16x16x32_f16 v[52:55], v[84:87], v[112:115], 0
    v_mfma_f32_16x16x32_f16 v[56:59], v[80:83], v[120:123], 0
    v_mfma_f32_16x16x32_f16 v[60:63], v[84:87], v[120:123], 0
    v_mfma_f32_16x16x32_f16 v[64:67], v[80:83], v[128:131], 0
    v_mfma_f32_16x16x32_f16 v[68:71], v[84:87], v[128:131], 0
    v_mfma_f32_16x16x32_f16 v[72:75], v[80:83], v[136:139], 0
    v_mfma_f32_16x16x32_f16 v[76:79], v[84:87], v[136:139], 0
    v_mfma_f32_16x16x32_f16 v[48:51], v[88:91], v[116:119], v[48:51]
    v_mfma_f32_16x16x32_f16 v[52:55], v[92:95], v[116:119], v[52:55]
    v_mfma_f32_16x16x32_f16 v[56:59], v[88:91], v[124:127], v[56:59]
    v_mfma_f32_16x16x32_f16 v[60:63], v[92:95], v[124:127], v[60:63]
    v_mfma_f32_16x16x32_f16 v[64:67], v[88:91], v[132:135], v[64:67]
    v_mfma_f32_16x16x32_f16 v[68:71], v[92:95], v[132:135], v[68:71]
    v_mfma_f32_16x16x32_f16 v[72:75], v[88:91], v[140:143], v[72:75]
    v_mfma_f32_16x16x32_f16 v[76:79], v[92:95], v[140:143], v[76:79]
    s_nop 0
    v_cvt_pk_f16_f32 v16, v48, v49
    v_cvt_pk_f16_f32 v17, v50, v51
    v_cvt_pk_f16_f32 v18, v52, v53
    v_cvt_pk_f16_f32 v19, v54, v55
    s_mov_b32 s19, 0
    buffer_store_dwordx4 v[16:19], v12, s[8:11], s19 offen
    v_cvt_pk_f16_f32 v20, v56, v57
    v_cvt_pk_f16_f32 v21, v58, v59
    v_cvt_pk_f16_f32 v22, v60, v61
    v_cvt_pk_f16_f32 v23, v62, v63
    s_mov_b32 s19, 655360
    buffer_store_dwordx4 v[20:23], v12, s[8:11], s19 offen
    v_cvt_pk_f16_f32 v24, v64, v65
    v_cvt_pk_f16_f32 v25, v66, v67
    v_cvt_pk_f16_f32 v26, v68, v69
    v_cvt_pk_f16_f32 v27, v70, v71
    s_mov_b32 s19, 1310720
    buffer_store_dwordx4 v[24:27], v12, s[8:11], s19 offen
    v_cvt_pk_f16_f32 v28, v72, v73
    v_cvt_pk_f16_f32 v29, v74, v75
    v_cvt_pk_f16_f32 v30, v76, v77
    v_cvt_pk_f16_f32 v31, v78, v79
    s_mov_b32 s19, 1966080
    buffer_store_dwordx4 v[28:31], v12, s[8:11], s19 offen
    s_endpgm
K1_MOD:
    s_load_dwordx2 s[4:5], s[0:1], 64
    s_load_dwordx2 s[12:13], s[0:1], 56
    s_sub_u32 s16, s2, 160
    s_and_b32 s17, s16, 7
    s_lshr_b32 s18, s16, 3
    s_lshr_b32 s19, s18, 1
    s_lshl_b32 s19, s19, 3
    s_add_u32 s19, s19, s17
    s_lshl_b32 s19, s19, 1
    s_and_b32 s20, s18, 1
    s_add_u32 s19, s19, s20
    s_cmp_lt_u32 s18, 14
    s_cselect_b32 s16, s19, s16
    s_lshl_b32 s17, s16, 6
    v_and_b32 v1, 3, v0
    v_lshrrev_b32 v2, 2, v0
    s_mov_b32 s18, 7680
    v_mul_lo_u32 v3, v2, s18
    v_lshl_add_u32 v3, v1, 4, v3
    v_add_u32 v3, s17, v3
    v_lshlrev_b32 v4, 1, v2
    s_waitcnt lgkmcnt(0)
    s_and_b32 s5, s5, 0xffff
    s_mov_b32 s6, 0x4b0000
    s_mov_b32 s7, 0x00020000
    s_and_b32 s13, s13, 0xffff
    s_mov_b32 s14, 0x500
    s_mov_b32 s15, 0x00020000
    s_and_b32 s9, s9, 0xffff
    s_mov_b32 s10, 0x10000000
    s_mov_b32 s11, 0x00020000
    v_mov_b32 v8, 0
    v_mov_b32 v9, 0
    v_mov_b32 v10, 0
    v_mov_b32 v11, 0
    v_mov_b32 v12, 0
    v_mov_b32 v13, 0
    v_mov_b32 v14, 0
    v_mov_b32 v15, 0
    v_mov_b32 v16, 0
    v_mov_b32 v17, 0
    buffer_load_short_d16_hi v8, v4, s[12:15], 0 offen offset:0
    buffer_load_short_d16_hi v9, v4, s[12:15], 0 offen offset:128
    buffer_load_short_d16_hi v10, v4, s[12:15], 0 offen offset:256
    buffer_load_short_d16_hi v11, v4, s[12:15], 0 offen offset:384
    buffer_load_short_d16_hi v12, v4, s[12:15], 0 offen offset:512
    buffer_load_short_d16_hi v13, v4, s[12:15], 0 offen offset:640
    buffer_load_short_d16_hi v14, v4, s[12:15], 0 offen offset:768
    buffer_load_short_d16_hi v15, v4, s[12:15], 0 offen offset:896
    buffer_load_short_d16_hi v16, v4, s[12:15], 0 offen offset:1024
    buffer_load_short_d16_hi v17, v4, s[12:15], 0 offen offset:1152
    s_mov_b32 s19, 0
    buffer_load_dwordx4 v[24:27], v3, s[4:7], s19 offen
    s_mov_b32 s19, 491520
    buffer_load_dwordx4 v[28:31], v3, s[4:7], s19 offen
    s_mov_b32 s19, 983040
    buffer_load_dwordx4 v[32:35], v3, s[4:7], s19 offen
    s_mov_b32 s19, 1474560
    buffer_load_dwordx4 v[36:39], v3, s[4:7], s19 offen
    s_mov_b32 s19, 1966080
    buffer_load_dwordx4 v[40:43], v3, s[4:7], s19 offen
    s_mov_b32 s19, 2457600
    buffer_load_dwordx4 v[44:47], v3, s[4:7], s19 offen
    s_mov_b32 s19, 2949120
    buffer_load_dwordx4 v[48:51], v3, s[4:7], s19 offen
    s_mov_b32 s19, 3440640
    buffer_load_dwordx4 v[52:55], v3, s[4:7], s19 offen
    s_mov_b32 s19, 3932160
    buffer_load_dwordx4 v[56:59], v3, s[4:7], s19 offen
    s_mov_b32 s19, 4423680
    buffer_load_dwordx4 v[60:63], v3, s[4:7], s19 offen
    s_waitcnt vmcnt(10)
    v_mul_f32 v64, 0xbfb8aa3b, v8
    v_mul_f32 v65, 0xbfb8aa3b, v9
    v_mul_f32 v66, 0xbfb8aa3b, v10
    v_mul_f32 v67, 0xbfb8aa3b, v11
    v_mul_f32 v68, 0xbfb8aa3b, v12
    v_mul_f32 v69, 0xbfb8aa3b, v13
    v_mul_f32 v70, 0xbfb8aa3b, v14
    v_mul_f32 v71, 0xbfb8aa3b, v15
    v_mul_f32 v72, 0xbfb8aa3b, v16
    v_mul_f32 v73, 0xbfb8aa3b, v17
    v_exp_f32 v64, v64
    v_exp_f32 v65, v65
    v_exp_f32 v66, v66
    v_exp_f32 v67, v67
    v_exp_f32 v68, v68
    v_exp_f32 v69, v69
    v_exp_f32 v70, v70
    v_exp_f32 v71, v71
    v_exp_f32 v72, v72
    v_exp_f32 v73, v73
    v_add_f32 v64, 1.0, v64
    v_add_f32 v65, 1.0, v65
    v_add_f32 v66, 1.0, v66
    v_add_f32 v67, 1.0, v67
    v_add_f32 v68, 1.0, v68
    v_add_f32 v69, 1.0, v69
    v_add_f32 v70, 1.0, v70
    v_add_f32 v71, 1.0, v71
    v_add_f32 v72, 1.0, v72
    v_add_f32 v73, 1.0, v73
    v_rcp_f32 v64, v64
    v_rcp_f32 v65, v65
    v_rcp_f32 v66, v66
    v_rcp_f32 v67, v67
    v_rcp_f32 v68, v68
    v_rcp_f32 v69, v69
    v_rcp_f32 v70, v70
    v_rcp_f32 v71, v71
    v_rcp_f32 v72, v72
    v_rcp_f32 v73, v73
    v_mul_f32 v8, v8, v64
    v_cvt_pk_bf16_f32 v8, v8, v8
    v_and_b32 v8, 0xffff0000, v8
    v_mul_f32 v9, v9, v65
    v_cvt_pk_bf16_f32 v9, v9, v9
    v_and_b32 v9, 0xffff0000, v9
    v_mul_f32 v10, v10, v66
    v_cvt_pk_bf16_f32 v10, v10, v10
    v_and_b32 v10, 0xffff0000, v10
    v_mul_f32 v11, v11, v67
    v_cvt_pk_bf16_f32 v11, v11, v11
    v_and_b32 v11, 0xffff0000, v11
    v_mul_f32 v12, v12, v68
    v_cvt_pk_bf16_f32 v12, v12, v12
    v_and_b32 v12, 0xffff0000, v12
    v_mul_f32 v13, v13, v69
    v_cvt_pk_bf16_f32 v13, v13, v13
    v_and_b32 v13, 0xffff0000, v13
    v_mul_f32 v14, v14, v70
    v_cvt_pk_bf16_f32 v14, v14, v14
    v_and_b32 v14, 0xffff0000, v14
    v_mul_f32 v15, v15, v71
    v_cvt_pk_bf16_f32 v15, v15, v15
    v_and_b32 v15, 0xffff0000, v15
    v_mul_f32 v16, v16, v72
    v_cvt_pk_bf16_f32 v16, v16, v16
    v_and_b32 v16, 0xffff0000, v16
    v_mul_f32 v17, v17, v73
    v_cvt_pk_bf16_f32 v17, v17, v17
    v_and_b32 v17, 0xffff0000, v17
    s_waitcnt vmcnt(9)
    v_lshlrev_b32 v72, 16, v24
    v_and_b32 v73, 0xffff0000, v24
    v_mul_f32 v64, v72, v8
    v_mul_f32 v65, v73, v8
    v_lshlrev_b32 v72, 16, v25
    v_and_b32 v73, 0xffff0000, v25
    v_mul_f32 v66, v72, v8
    v_mul_f32 v67, v73, v8
    v_lshlrev_b32 v72, 16, v26
    v_and_b32 v73, 0xffff0000, v26
    v_mul_f32 v68, v72, v8
    v_mul_f32 v69, v73, v8
    v_lshlrev_b32 v72, 16, v27
    v_and_b32 v73, 0xffff0000, v27
    v_mul_f32 v70, v72, v8
    v_mul_f32 v71, v73, v8
    s_waitcnt vmcnt(8)
    v_lshlrev_b32 v72, 16, v28
    v_and_b32 v73, 0xffff0000, v28
    v_fmac_f32 v64, v72, v9
    v_fmac_f32 v65, v73, v9
    v_lshlrev_b32 v72, 16, v29
    v_and_b32 v73, 0xffff0000, v29
    v_fmac_f32 v66, v72, v9
    v_fmac_f32 v67, v73, v9
    v_lshlrev_b32 v72, 16, v30
    v_and_b32 v73, 0xffff0000, v30
    v_fmac_f32 v68, v72, v9
    v_fmac_f32 v69, v73, v9
    v_lshlrev_b32 v72, 16, v31
    v_and_b32 v73, 0xffff0000, v31
    v_fmac_f32 v70, v72, v9
    v_fmac_f32 v71, v73, v9
    s_waitcnt vmcnt(7)
    v_lshlrev_b32 v72, 16, v32
    v_and_b32 v73, 0xffff0000, v32
    v_fmac_f32 v64, v72, v10
    v_fmac_f32 v65, v73, v10
    v_lshlrev_b32 v72, 16, v33
    v_and_b32 v73, 0xffff0000, v33
    v_fmac_f32 v66, v72, v10
    v_fmac_f32 v67, v73, v10
    v_lshlrev_b32 v72, 16, v34
    v_and_b32 v73, 0xffff0000, v34
    v_fmac_f32 v68, v72, v10
    v_fmac_f32 v69, v73, v10
    v_lshlrev_b32 v72, 16, v35
    v_and_b32 v73, 0xffff0000, v35
    v_fmac_f32 v70, v72, v10
    v_fmac_f32 v71, v73, v10
    s_waitcnt vmcnt(6)
    v_lshlrev_b32 v72, 16, v36
    v_and_b32 v73, 0xffff0000, v36
    v_fmac_f32 v64, v72, v11
    v_fmac_f32 v65, v73, v11
    v_lshlrev_b32 v72, 16, v37
    v_and_b32 v73, 0xffff0000, v37
    v_fmac_f32 v66, v72, v11
    v_fmac_f32 v67, v73, v11
    v_lshlrev_b32 v72, 16, v38
    v_and_b32 v73, 0xffff0000, v38
    v_fmac_f32 v68, v72, v11
    v_fmac_f32 v69, v73, v11
    v_lshlrev_b32 v72, 16, v39
    v_and_b32 v73, 0xffff0000, v39
    v_fmac_f32 v70, v72, v11
    v_fmac_f32 v71, v73, v11
    s_waitcnt vmcnt(5)
    v_lshlrev_b32 v72, 16, v40
    v_and_b32 v73, 0xffff0000, v40
    v_fmac_f32 v64, v72, v12
    v_fmac_f32 v65, v73, v12
    v_lshlrev_b32 v72, 16, v41
    v_and_b32 v73, 0xffff0000, v41
    v_fmac_f32 v66, v72, v12
    v_fmac_f32 v67, v73, v12
    v_lshlrev_b32 v72, 16, v42
    v_and_b32 v73, 0xffff0000, v42
    v_fmac_f32 v68, v72, v12
    v_fmac_f32 v69, v73, v12
    v_lshlrev_b32 v72, 16, v43
    v_and_b32 v73, 0xffff0000, v43
    v_fmac_f32 v70, v72, v12
    v_fmac_f32 v71, v73, v12
    s_waitcnt vmcnt(4)
    v_lshlrev_b32 v72, 16, v44
    v_and_b32 v73, 0xffff0000, v44
    v_fmac_f32 v64, v72, v13
    v_fmac_f32 v65, v73, v13
    v_lshlrev_b32 v72, 16, v45
    v_and_b32 v73, 0xffff0000, v45
    v_fmac_f32 v66, v72, v13
    v_fmac_f32 v67, v73, v13
    v_lshlrev_b32 v72, 16, v46
    v_and_b32 v73, 0xffff0000, v46
    v_fmac_f32 v68, v72, v13
    v_fmac_f32 v69, v73, v13
    v_lshlrev_b32 v72, 16, v47
    v_and_b32 v73, 0xffff0000, v47
    v_fmac_f32 v70, v72, v13
    v_fmac_f32 v71, v73, v13
    s_waitcnt vmcnt(3)
    v_lshlrev_b32 v72, 16, v48
    v_and_b32 v73, 0xffff0000, v48
    v_fmac_f32 v64, v72, v14
    v_fmac_f32 v65, v73, v14
    v_lshlrev_b32 v72, 16, v49
    v_and_b32 v73, 0xffff0000, v49
    v_fmac_f32 v66, v72, v14
    v_fmac_f32 v67, v73, v14
    v_lshlrev_b32 v72, 16, v50
    v_and_b32 v73, 0xffff0000, v50
    v_fmac_f32 v68, v72, v14
    v_fmac_f32 v69, v73, v14
    v_lshlrev_b32 v72, 16, v51
    v_and_b32 v73, 0xffff0000, v51
    v_fmac_f32 v70, v72, v14
    v_fmac_f32 v71, v73, v14
    s_waitcnt vmcnt(2)
    v_lshlrev_b32 v72, 16, v52
    v_and_b32 v73, 0xffff0000, v52
    v_fmac_f32 v64, v72, v15
    v_fmac_f32 v65, v73, v15
    v_lshlrev_b32 v72, 16, v53
    v_and_b32 v73, 0xffff0000, v53
    v_fmac_f32 v66, v72, v15
    v_fmac_f32 v67, v73, v15
    v_lshlrev_b32 v72, 16, v54
    v_and_b32 v73, 0xffff0000, v54
    v_fmac_f32 v68, v72, v15
    v_fmac_f32 v69, v73, v15
    v_lshlrev_b32 v72, 16, v55
    v_and_b32 v73, 0xffff0000, v55
    v_fmac_f32 v70, v72, v15
    v_fmac_f32 v71, v73, v15
    s_waitcnt vmcnt(1)
    v_lshlrev_b32 v72, 16, v56
    v_and_b32 v73, 0xffff0000, v56
    v_fmac_f32 v64, v72, v16
    v_fmac_f32 v65, v73, v16
    v_lshlrev_b32 v72, 16, v57
    v_and_b32 v73, 0xffff0000, v57
    v_fmac_f32 v66, v72, v16
    v_fmac_f32 v67, v73, v16
    v_lshlrev_b32 v72, 16, v58
    v_and_b32 v73, 0xffff0000, v58
    v_fmac_f32 v68, v72, v16
    v_fmac_f32 v69, v73, v16
    v_lshlrev_b32 v72, 16, v59
    v_and_b32 v73, 0xffff0000, v59
    v_fmac_f32 v70, v72, v16
    v_fmac_f32 v71, v73, v16
    s_waitcnt vmcnt(0)
    v_lshlrev_b32 v72, 16, v60
    v_and_b32 v73, 0xffff0000, v60
    v_fmac_f32 v64, v72, v17
    v_fmac_f32 v65, v73, v17
    v_lshlrev_b32 v72, 16, v61
    v_and_b32 v73, 0xffff0000, v61
    v_fmac_f32 v66, v72, v17
    v_fmac_f32 v67, v73, v17
    v_lshlrev_b32 v72, 16, v62
    v_and_b32 v73, 0xffff0000, v62
    v_fmac_f32 v68, v72, v17
    v_fmac_f32 v69, v73, v17
    v_lshlrev_b32 v72, 16, v63
    v_and_b32 v73, 0xffff0000, v63
    v_fmac_f32 v70, v72, v17
    v_fmac_f32 v71, v73, v17
    v_add_f32_dpp v80, v64, v64 row_ror:4 row_mask:0xf bank_mask:0xf
    v_add_f32_dpp v81, v65, v65 row_ror:4 row_mask:0xf bank_mask:0xf
    v_add_f32_dpp v82, v66, v66 row_ror:4 row_mask:0xf bank_mask:0xf
    v_add_f32_dpp v83, v67, v67 row_ror:4 row_mask:0xf bank_mask:0xf
    v_add_f32_dpp v84, v68, v68 row_ror:4 row_mask:0xf bank_mask:0xf
    v_add_f32_dpp v85, v69, v69 row_ror:4 row_mask:0xf bank_mask:0xf
    v_add_f32_dpp v86, v70, v70 row_ror:4 row_mask:0xf bank_mask:0xf
    v_add_f32_dpp v87, v71, v71 row_ror:4 row_mask:0xf bank_mask:0xf
    v_add_f32_dpp v64, v80, v80 row_ror:8 row_mask:0xf bank_mask:0xf
    v_add_f32_dpp v65, v81, v81 row_ror:8 row_mask:0xf bank_mask:0xf
    v_add_f32_dpp v66, v82, v82 row_ror:8 row_mask:0xf bank_mask:0xf
    v_add_f32_dpp v67, v83, v83 row_ror:8 row_mask:0xf bank_mask:0xf
    v_add_f32_dpp v68, v84, v84 row_ror:8 row_mask:0xf bank_mask:0xf
    v_add_f32_dpp v69, v85, v85 row_ror:8 row_mask:0xf bank_mask:0xf
    v_add_f32_dpp v70, v86, v86 row_ror:8 row_mask:0xf bank_mask:0xf
    v_add_f32_dpp v71, v87, v87 row_ror:8 row_mask:0xf bank_mask:0xf
    s_sub_u32 s31, s2, 160
    v_lshrrev_b32 v5, 4, v0
    v_lshlrev_b32 v5, 7, v5
    v_lshl_add_u32 v5, v1, 5, v5
    v_and_b32 v6, 15, v0
    v_cmp_gt_u32 vcc, 4, v6
    s_nop 0
    s_and_saveexec_b64 s[20:21], vcc
    ds_write_b128 v5, v[64:67]
    ds_write_b128 v5, v[68:71] offset:16
    s_mov_b64 exec, s[20:21]
    s_waitcnt lgkmcnt(0)
    s_barrier
    v_readfirstlane_b32 s20, v0
    s_nop 0
    s_cmp_ge_u32 s20, 64
    s_cbranch_scc1 K1_END
    v_and_b32 v5, 31, v0
    v_lshlrev_b32 v6, 2, v5
    ds_read_b32 v8, v6 offset:0
    ds_read_b32 v9, v6 offset:128
    ds_read_b32 v10, v6 offset:256
    ds_read_b32 v11, v6 offset:384
    ds_read_b32 v12, v6 offset:512
    ds_read_b32 v13, v6 offset:640
    ds_read_b32 v14, v6 offset:768
    ds_read_b32 v15, v6 offset:896
    ds_read_b32 v16, v6 offset:1024
    ds_read_b32 v17, v6 offset:1152
    ds_read_b32 v18, v6 offset:1280
    ds_read_b32 v19, v6 offset:1408
    ds_read_b32 v20, v6 offset:1536
    ds_read_b32 v21, v6 offset:1664
    ds_read_b32 v22, v6 offset:1792
    ds_read_b32 v23, v6 offset:1920
    s_waitcnt lgkmcnt(0)
    v_add_f32 v8, v8, v16
    v_add_f32 v9, v9, v17
    v_add_f32 v10, v10, v18
    v_add_f32 v11, v11, v19
    v_add_f32 v12, v12, v20
    v_add_f32 v13, v13, v21
    v_add_f32 v14, v14, v22
    v_add_f32 v15, v15, v23
    v_add_f32 v8, v8, v12
    v_add_f32 v9, v9, v13
    v_add_f32 v10, v10, v14
    v_add_f32 v11, v11, v15
    v_add_f32 v8, v8, v10
    v_add_f32 v9, v9, v11
    v_add_f32 v8, v8, v9
    v_cvt_pk_bf16_f32 v8, v8, v8
    v_and_b32 v8, 0xffff0000, v8
    s_sub_u32 s21, s16, 20
    s_cmp_lt_u32 s21, 20
    s_cselect_b32 s22, 1.0, 0
    s_sub_u32 s21, s16, 80
    s_cmp_lt_u32 s21, 20
    s_cselect_b32 s22, 1.0, s22
    v_add_f32 v8, s22, v8
    v_cvt_pk_bf16_f32 v8, v8, v8
    v_and_b32 v8, 0xffff0000, v8
    s_lshl_b32 s17, s16, 7
    v_add_u32 v6, s17, v6
    buffer_store_dword v8, v6, s[8:11], 0 offen offset:0
    v_lshrrev_b32 v7, 1, v6
    s_movk_i32 s21, 0x5000
    buffer_store_short_d16_hi v8, v7, s[8:11], s21 offen
    s_cmp_ge_u32 s16, 40
    s_cbranch_scc1 K1_END
    v_and_b32 v9, 0x7fffffff, v8
    s_nop 1
    v_max_f32_dpp v9, v9, v9 row_ror:1 row_mask:0xf bank_mask:0xf
    s_nop 1
    v_max_f32_dpp v9, v9, v9 row_ror:2 row_mask:0xf bank_mask:0xf
    s_nop 1
    v_max_f32_dpp v9, v9, v9 row_ror:4 row_mask:0xf bank_mask:0xf
    s_nop 1
    v_max_f32_dpp v9, v9, v9 row_ror:8 row_mask:0xf bank_mask:0xf
    s_nop 0
    v_readlane_b32 s20, v9, 16
    s_nop 1
    v_max_f32 v9, s20, v9
    s_lshl_b32 s17, s16, 2
    s_add_u32 s17, s17, 0x4000
    v_mov_b32 v10, s17
    v_cmp_eq_u32 vcc, 0, v0
    s_nop 0
    s_and_saveexec_b64 s[20:21], vcc
    buffer_store_dword v9, v10, s[8:11], 0 offen
    s_endpgm
K1_WM:
    s_sub_u32 s16, s2, 280
    s_lshr_b32 s17, s16, 5
    s_lshl_b32 s17, s17, 3
    s_add_u32 s18, s0, s17
    s_addc_u32 s19, s1, 0
    s_load_dwordx2 s[4:5], s[18:19], 8
    s_and_b32 s17, s16, 31
    s_lshl_b32 s17, s17, 12
    v_lshlrev_b32 v1, 4, v0
    v_add_u32 v1, s17, v1
    s_waitcnt lgkmcnt(0)
    s_and_b32 s5, s5, 0xffff
    s_mov_b32 s6, 0x141000
    s_mov_b32 s7, 0x00020000
    s_and_b32 s9, s9, 0xffff
    s_mov_b32 s10, 0x10000000
    s_mov_b32 s11, 0x00020000
    s_cmp_lg_u32 s16, 0
    s_cbranch_scc1 K1_NOZ
    v_lshrrev_b32 v2, 2, v0
    v_mul_u32_u24 v2, 4352, v2
    v_and_b32 v3, 3, v0
    v_lshl_add_u32 v2, v3, 4, v2
    v_mov_b32 v4, 0
    v_mov_b32 v5, 0
    v_mov_b32 v6, 0
    v_mov_b32 v7, 0
    s_mov_b32 s21, 0x40000
    buffer_store_dwordx4 v[4:7], v2, s[8:11], s21 offen
K1_NOZ:
    s_cmp_ge_u32 s16, 16
    s_cbranch_scc1 K1_NOPF
    v_lshlrev_b32 v60, 4, v0
    s_getpc_b64 s[24:25]
PCB_1:
    s_add_u32 s24, s24, k2_kernel-PCB_1
    s_addc_u32 s25, s25, 0
    s_mov_b32 s26, CODE_END-k2_kernel-16
    v_mov_b32 v67, s25
    v_add_u32 v66, 0, v60
    v_min_u32 v66, s26, v66
    v_add_co_u32 v64, vcc, s24, v66
    s_nop 1
    v_addc_co_u32 v65, vcc, 0, v67, vcc
    global_load_dwordx4 v[68:71], v[64:65], off
    v_add_u32 v66, 4096, v60
    v_min_u32 v66, s26, v66
    v_add_co_u32 v64, vcc, s24, v66
    s_nop 1
    v_addc_co_u32 v65, vcc, 0, v67, vcc
    global_load_dwordx4 v[68:71], v[64:65], off
    v_add_u32 v66, 8192, v60
    v_min_u32 v66, s26, v66
    v_add_co_u32 v64, vcc, s24, v66
    s_nop 1
    v_addc_co_u32 v65, vcc, 0, v67, vcc
    global_load_dwordx4 v[68:71], v[64:65], off
    v_add_u32 v66, 12288, v60
    v_min_u32 v66, s26, v66
    v_add_co_u32 v64, vcc, s24, v66
    s_nop 1
    v_addc_co_u32 v65, vcc, 0, v67, vcc
    global_load_dwordx4 v[68:71], v[64:65], off
    v_add_u32 v66, 16384, v60
    v_min_u32 v66, s26, v66
    v_add_co_u32 v64, vcc, s24, v66
    s_nop 1
    v_addc_co_u32 v65, vcc, 0, v67, vcc
    global_load_dwordx4 v[68:71], v[64:65], off
    v_add_u32 v66, 20480, v60
    v_min_u32 v66, s26, v66
    v_add_co_u32 v64, vcc, s24, v66
    s_nop 1
    v_addc_co_u32 v65, vcc, 0, v67, vcc
    global_load_dwordx4 v[68:71], v[64:65], off
    v_add_u32 v66, 24576, v60
    v_min_u32 v66, s26, v66
    v_add_co_u32 v64, vcc, s24, v66
    s_nop 1
    v_addc_co_u32 v65, vcc, 0, v67, vcc
    global_load_dwordx4 v[68:71], v[64:65], off
    v_add_u32 v66, 28672, v60
    v_min_u32 v66, s26, v66
    v_add_co_u32 v64, vcc, s24, v66
    s_nop 1
    v_addc_co_u32 v65, vcc, 0, v67, vcc
    global_load_dwordx4 v[68:71], v[64:65], off
    v_add_u32 v66, 32768, v60
    v_min_u32 v66, s26, v66
    v_add_co_u32 v64, vcc, s24, v66
    s_nop 1
    v_addc_co_u32 v65, vcc, 0, v67, vcc
    global_load_dwordx4 v[68:71], v[64:65], off
    v_add_u32 v66, 36864, v60
    v_min_u32 v66, s26, v66
    v_add_co_u32 v64, vcc, s24, v66
    s_nop 1
    v_addc_co_u32 v65, vcc, 0, v67, vcc
    global_load_dwordx4 v[68:71], v[64:65], off
K1_NOPF:
    s_mov_b32 s19, 0
    buffer_load_dwordx4 v[8:11], v1, s[4:7], s19 offen
    s_mov_b32 s19, 131072
    buffer_load_dwordx4 v[12:15], v1, s[4:7], s19 offen
    s_mov_b32 s19, 262144
    buffer_load_dwordx4 v[16:19], v1, s[4:7], s19 offen
    s_mov_b32 s19, 393216
    buffer_load_dwordx4 v[20:23], v1, s[4:7], s19 offen
    s_mov_b32 s19, 524288
    buffer_load_dwordx4 v[24:27], v1, s[4:7], s19 offen
    s_mov_b32 s19, 655360
    buffer_load_dwordx4 v[28:31], v1, s[4:7], s19 offen
    s_mov_b32 s19, 786432
    buffer_load_dwordx4 v[32:35], v1, s[4:7], s19 offen
    s_mov_b32 s19, 917504
    buffer_load_dwordx4 v[36:39], v1, s[4:7], s19 offen
    s_mov_b32 s19, 1048576
    buffer_load_dwordx4 v[40:43], v1, s[4:7], s19 offen
    s_mov_b32 s19, 1179648
    buffer_load_dwordx4 v[44:47], v1, s[4:7], s19 offen
    s_mov_b32 s19, 1310720
    buffer_load_dwordx4 v[48:51], v1, s[4:7], s19 offen
    v_mov_b32 v2, 0
    s_mov_b32 s20, 0x7fff7fff
    s_waitcnt vmcnt(10)
    v_and_b32 v3, s20, v8
    v_pk_max_u16 v2, v2, v3
    v_and_b32 v3, s20, v9
    v_pk_max_u16 v2, v2, v3
    v_and_b32 v3, s20, v10
    v_pk_max_u16 v2, v2, v3
    v_and_b32 v3, s20, v11
    v_pk_max_u16 v2, v2, v3
    s_waitcnt vmcnt(9)
    v_and_b32 v3, s20, v12
    v_pk_max_u16 v2, v2, v3
    v_and_b32 v3, s20, v13
    v_pk_max_u16 v2, v2, v3
    v_and_b32 v3, s20, v14
    v_pk_max_u16 v2, v2, v3
    v_and_b32 v3, s20, v15
    v_pk_max_u16 v2, v2, v3
    s_waitcnt vmcnt(8)
    v_and_b32 v3, s20, v16
    v_pk_max_u16 v2, v2, v3
    v_and_b32 v3, s20, v17
    v_pk_max_u16 v2, v2, v3
    v_and_b32 v3, s20, v18
    v_pk_max_u16 v2, v2, v3
    v_and_b32 v3, s20, v19
    v_pk_max_u16 v2, v2, v3
    s_waitcnt vmcnt(7)
    v_and_b32 v3, s20, v20
    v_pk_max_u16 v2, v2, v3
    v_and_b32 v3, s20, v21
    v_pk_max_u16 v2, v2, v3
    v_and_b32 v3, s20, v22
    v_pk_max_u16 v2, v2, v3
    v_and_b32 v3, s20, v23
    v_pk_max_u16 v2, v2, v3
    s_waitcnt vmcnt(6)
    v_and_b32 v3, s20, v24
    v_pk_max_u16 v2, v2, v3
    v_and_b32 v3, s20, v25
    v_pk_max_u16 v2, v2, v3
    v_and_b32 v3, s20, v26
    v_pk_max_u16 v2, v2, v3
    v_and_b32 v3, s20, v27
    v_pk_max_u16 v2, v2, v3
    s_waitcnt vmcnt(5)
    v_and_b32 v3, s20, v28
    v_pk_max_u16 v2, v2, v3
    v_and_b32 v3, s20, v29
    v_pk_max_u16 v2, v2, v3
    v_and_b32 v3, s20, v30
    v_pk_max_u16 v2, v2, v3
    v_and_b32 v3, s20, v31
    v_pk_max_u16 v2, v2, v3
    s_waitcnt vmcnt(4)
    v_and_b32 v3, s20, v32
    v_pk_max_u16 v2, v2, v3
    v_and_b32 v3, s20, v33
    v_pk_max_u16 v2, v2, v3
    v_and_b32 v3, s20, v34
    v_pk_max_u16 v2, v2, v3
    v_and_b32 v3, s20, v35
    v_pk_max_u16 v2, v2, v3
    s_waitcnt vmcnt(3)
    v_and_b32 v3, s20, v36
    v_pk_max_u16 v2, v2, v3
    v_and_b32 v3, s20, v37
    v_pk_max_u16 v2, v2, v3
    v_and_b32 v3, s20, v38
    v_pk_max_u16 v2, v2, v3
    v_and_b32 v3, s20, v39
    v_pk_max_u16 v2, v2, v3
    s_waitcnt vmcnt(2)
    v_and_b32 v3, s20, v40
    v_pk_max_u16 v2, v2, v3
    v_and_b32 v3, s20, v41
    v_pk_max_u16 v2, v2, v3
    v_and_b32 v3, s20, v42
    v_pk_max_u16 v2, v2, v3
    v_and_b32 v3, s20, v43
    v_pk_max_u16 v2, v2, v3
    s_waitcnt vmcnt(1)
    v_and_b32 v3, s20, v44
    v_pk_max_u16 v2, v2, v3
    v_and_b32 v3, s20, v45
    v_pk_max_u16 v2, v2, v3
    v_and_b32 v3, s20, v46
    v_pk_max_u16 v2, v2, v3
    v_and_b32 v3, s20, v47
    v_pk_max_u16 v2, v2, v3
    s_waitcnt vmcnt(0)
    v_and_b32 v3, s20, v48
    v_pk_max_u16 v2, v2, v3
    v_and_b32 v3, s20, v49
    v_pk_max_u16 v2, v2, v3
    v_and_b32 v3, s20, v50
    v_pk_max_u16 v2, v2, v3
    v_and_b32 v3, s20, v51
    v_pk_max_u16 v2, v2, v3
    v_lshlrev_b32 v3, 16, v2
    v_and_b32 v2, 0xffff0000, v2
    v_max_u32 v2, v2, v3
    s_nop 1
    v_max_u32_dpp v2, v2, v2 row_ror:1 row_mask:0xf bank_mask:0xf
    s_nop 1
    v_max_u32_dpp v2, v2, v2 row_ror:2 row_mask:0xf bank_mask:0xf
    s_nop 1
    v_max_u32_dpp v2, v2, v2 row_ror:4 row_mask:0xf bank_mask:0xf
    s_nop 1
    v_max_u32_dpp v2, v2, v2 row_ror:8 row_mask:0xf bank_mask:0xf
    v_lshrrev_b32 v3, 4, v0
    v_lshlrev_b32 v3, 2, v3
    ds_write_b32 v3, v2
    s_waitcnt lgkmcnt(0)
    s_barrier
    v_readfirstlane_b32 s20, v0
    s_nop 0
    s_cmp_ge_u32 s20, 64
    s_cbranch_scc1 K1_END
    v_and_b32 v3, 15, v0
    v_lshlrev_b32 v3, 2, v3
    ds_read_b32 v2, v3
    s_waitcnt lgkmcnt(0)
    v_max_u32_dpp v2, v2, v2 row_ror:1 row_mask:0xf bank_mask:0xf
    s_nop 1
    v_max_u32_dpp v2, v2, v2 row_ror:2 row_mask:0xf bank_mask:0xf
    s_nop 1
    v_max_u32_dpp v2, v2, v2 row_ror:4 row_mask:0xf bank_mask:0xf
    s_nop 1
    v_max_u32_dpp v2, v2, v2 row_ror:8 row_mask:0xf bank_mask:0xf
    s_lshl_b32 s17, s16, 2
    s_add_u32 s17, s17, 0x4100
    v_mov_b32 v10, s17
    v_cmp_eq_u32 vcc, 0, v0
    s_nop 0
    s_and_saveexec_b64 s[20:21], vcc
    buffer_store_dword v2, v10, s[8:11], 0 offen
K1_END:
    s_endpgm
.text
.globl k2_kernel
.p2align 8
.type k2_kernel,@function
k2_kernel:
    s_load_dwordx2 s[8:9], s[0:1], 88
    v_lshrrev_b32 v3, 6, v0
    s_cmp_ge_u32 s2, 256
    s_cbranch_scc1 K2_END
    v_readfirstlane_b32 s20, v3
    v_and_b32 v1, 15, v0
    v_bfe_u32 v2, v0, 4, 2
    v_and_b32 v3, 63, v0
    s_and_b32 s16, s2, 31
    s_lshr_b32 s17, s2, 5
    s_and_b32 s18, s17, 1
    s_lshr_b32 s19, s17, 1
    v_lshrrev_b32 v5, 3, v1
    v_cmp_eq_u32 s[26:27], 1, v5
    s_cmp_eq_u32 s16, 0
    s_cselect_b32 s36, 32, s16
    s_cselect_b32 s37, 0, 0xbe800000
    s_movk_i32 s22, 0x4000
    s_movk_i32 s54, 0x5000
    s_sub_u32 s23, s20, 4
    s_cmp_lt_u32 s23, 3
    s_cbranch_scc1 K2_NOA1
    s_setprio 3
    s_min_u32 s23, s20, 4
    s_lshl_b32 s23, s23, 6
    v_add_u32 v4, s23, v3
    v_mul_u32_u24 v6, 410, v4
    v_lshrrev_b32 v6, 14, v6
    v_mul_u32_u24 v7, 40, v6
    v_sub_u32 v7, v4, v7
    s_mul_i32 s21, s16, 81920
    s_add_u32 s21, s21, 0x100000
    v_mul_u32_u24 v8, 10240, v6
    v_lshl_add_u32 v8, v7, 4, v8
    v_add_u32 v8, s21, v8
    v_lshlrev_b32 v9, 4, v7
    v_mul_u32_u24 v10, 5376, v6
    v_lshl_add_u32 v10, v7, 4, v10
    v_min_u32 v4, 39, v3
    v_lshlrev_b32 v164, 2, v4
    v_mov_b32 v56, 0
    v_mov_b32 v57, 0
    v_mov_b32 v58, 0
    v_mov_b32 v59, 0
    s_waitcnt lgkmcnt(0)
    s_and_b32 s9, s9, 0xffff
    s_mov_b32 s10, 0x10000000
    s_mov_b32 s11, 0x00020000
    s_cmp_lg_u32 s16, 0
    s_cbranch_scc1 K2_NOSA
    buffer_load_dwordx4 v[56:59], v9, s[8:11], s54 offen offset:0
    buffer_load_dwordx4 v[60:63], v9, s[8:11], s54 offen offset:640
K2_NOSA:
    buffer_load_dword v164, v164, s[8:11], s22 offen
    buffer_load_dwordx4 v[48:51], v9, s[8:11], s54 offen offset:1280
    buffer_load_dwordx4 v[52:55], v9, s[8:11], s54 offen offset:1920
    s_movk_i32 s52, 0
    buffer_load_dwordx4 v[168:171], v8, s[8:11], s52 offen offset:0
    buffer_load_dwordx4 v[172:175], v8, s[8:11], s52 offen offset:640
    buffer_load_dwordx4 v[176:179], v8, s[8:11], s52 offen offset:1280
    buffer_load_dwordx4 v[180:183], v8, s[8:11], s52 offen offset:1920
    s_movk_i32 s52, 2560
    buffer_load_dwordx4 v[184:187], v8, s[8:11], s52 offen offset:0
    buffer_load_dwordx4 v[188:191], v8, s[8:11], s52 offen offset:640
    buffer_load_dwordx4 v[192:195], v8, s[8:11], s52 offen offset:1280
    buffer_load_dwordx4 v[196:199], v8, s[8:11], s52 offen offset:1920
    s_movk_i32 s52, 5120
    buffer_load_dwordx4 v[200:203], v8, s[8:11], s52 offen offset:0
    buffer_load_dwordx4 v[204:207], v8, s[8:11], s52 offen offset:640
    buffer_load_dwordx4 v[208:211], v8, s[8:11], s52 offen offset:1280
    buffer_load_dwordx4 v[212:215], v8, s[8:11], s52 offen offset:1920
    s_movk_i32 s52, 7680
    buffer_load_dwordx4 v[216:219], v8, s[8:11], s52 offen offset:0
    buffer_load_dwordx4 v[220:223], v8, s[8:11], s52 offen offset:640
    buffer_load_dwordx4 v[224:227], v8, s[8:11], s52 offen offset:1280
    buffer_load_dwordx4 v[228:231], v8, s[8:11], s52 offen offset:1920
    s_setprio 1
K2_NOA1:
    s_cmp_gt_u32 s20, 5
    s_cbranch_scc1 K2_PREP
    s_cmp_lt_u32 s20, 5
    s_cbranch_scc1 K2_GO
    s_sub_u32 s35, s2, 32
    s_cmp_lg_u32 s17, 0
    s_cbranch_scc1 K2_WD
K2_GO:
    s_load_dwordx2 s[4:5], s[0:1], 8
    s_load_dwordx2 s[12:13], s[0:1], 16
    v_lshlrev_b32 v165, 2, v3
    v_and_b32 v4, 7, v1
    s_mul_i32 s23, s19, 5
    s_add_u32 s53, s23, s20
    s_lshl_b32 s23, s53, 4
    s_add_u32 s23, s23, s18
    v_lshl_add_u32 v4, v4, 1, s23
    s_cmp_eq_u32 s20, 5
    s_cselect_b64 s[24:25], -1, 0
    v_mov_b32 v11, 320
    v_cndmask_b32 v4, v4, v11, s[24:25]
    s_sub_u32 s28, 2048, s16
    s_cmp_eq_u32 s16, 0
    s_cselect_b32 s28, 32, s28
    s_mov_b32 s30, 41088
    s_mov_b32 s31, 4294926208
    s_cselect_b32 s29, s30, s31
    v_mov_b32 v11, s16
    v_mov_b32 v12, s28
    v_cndmask_b32 v11, v11, v12, s[26:27]
    v_mov_b32 v12, s30
    v_mov_b32 v13, s29
    v_cndmask_b32 v15, v12, v13, s[26:27]
    v_mul_u32_u24 v11, 642, v11
    v_lshl_add_u32 v11, v4, 1, v11
    v_lshlrev_b32 v13, 2, v2
    v_mul_lo_u32 v13, v13, v15
    v_add_u32 v166, v11, v13
    v_lshl_add_u32 v167, v15, 4, v166
    v_cvt_f32_u32 v11, v4
    v_cvt_f32_u32 v12, v5
    v_mul_f32 v12, 0xbe800000, v12
    v_lshlrev_b32 v13, 3, v2
    v_cvt_f32_u32 v13, v13
    v_mul_f32 v13, v13, v11
    s_mov_b32 s32, 0x3acccccd
    s_mov_b32 s33, 0xc4200000
    v_mul_f32 v14, s32, v13
    v_floor_f32 v14, v14
    v_fma_f32 v14, v14, s33, v13
    v_fma_f32 v144, v14, s32, v12
    v_add_f32 v13, v13, v11
    v_mul_f32 v14, s32, v13
    v_floor_f32 v14, v14
    v_fma_f32 v14, v14, s33, v13
    v_fma_f32 v145, v14, s32, v12
    v_fmamk_f32 v13, v11, 0x41f80000, v13
    v_mul_f32 v14, s32, v13
    v_floor_f32 v14, v14
    v_fma_f32 v14, v14, s33, v13
    v_fma_f32 v152, v14, s32, v12
    v_add_f32 v13, v13, v11
    v_mul_f32 v14, s32, v13
    v_floor_f32 v14, v14
    v_fma_f32 v14, v14, s33, v13
    v_fma_f32 v153, v14, s32, v12
    v_mul_f32 v12, s32, v11
    v_mul_f32 v14, 0x3d4ccccd, v11
    v_floor_f32 v14, v14
    v_fmamk_f32 v14, v14, 0xc1a00000, v11
    v_mul_f32 v14, 0x3d4ccccd, v14
    v_cos_f32 v144, v144
    v_cos_f32 v145, v145
    v_cos_f32 v152, v152
    v_cos_f32 v153, v153
    v_cos_f32 v12, v12
    v_cos_f32 v14, v14
    v_mul_f32 v144, 0x3d21e89b, v144
    v_mul_f32 v145, 0x3d21e89b, v145
    v_mul_f32 v152, 0x3d21e89b, v152
    v_mul_f32 v153, 0x3d21e89b, v153
    v_add_f32 v11, v12, v12
    v_add_f32 v12, v14, v14
    v_add_f32 v13, v14, v14
    s_waitcnt lgkmcnt(0)
    s_and_b32 s5, s5, 0xffff
    s_mov_b32 s6, 0x141000
    s_mov_b32 s7, 0x00020000
    s_and_b32 s13, s13, 0xffff
    s_mov_b32 s14, 0x141000
    s_mov_b32 s15, 0x00020000
    s_and_b32 s9, s9, 0xffff
    s_mov_b32 s10, 0x10000000
    s_mov_b32 s11, 0x00020000
    v_fma_f32 v146, v11, v145, -v144
    v_fma_f32 v154, v11, v153, -v152
    v_fma_f32 v147, v11, v146, -v145
    v_fma_f32 v155, v11, v154, -v153
    v_fma_f32 v148, v11, v147, -v146
    v_fma_f32 v156, v11, v155, -v154
    v_fma_f32 v149, v11, v148, -v147
    v_fma_f32 v157, v11, v156, -v155
    buffer_load_dword v165, v165, s[8:11], s22 offen offset:256
    v_fma_f32 v150, v11, v149, -v148
    v_fma_f32 v158, v11, v157, -v156
    v_fma_f32 v151, v11, v150, -v149
    v_fma_f32 v159, v11, v158, -v157
    v_cvt_pk_f16_f32 v80, v144, v145
    v_cvt_pk_f16_f32 v81, v146, v147
    v_cvt_pk_f16_f32 v82, v148, v149
    v_cvt_pk_f16_f32 v83, v150, v151
    v_mov_b32 v64, 0
    v_mov_b32 v72, 0
    buffer_load_short_d16_hi v64, v166, s[4:7], 0 offen
    buffer_load_short_d16_hi v72, v166, s[12:15], 0 offen
    v_cvt_pk_f16_f32 v84, v152, v153
    v_cvt_pk_f16_f32 v85, v154, v155
    v_cvt_pk_f16_f32 v86, v156, v157
    v_cvt_pk_f16_f32 v87, v158, v159
    v_pk_fma_f32 v[144:145], v[12:13], v[152:153], v[144:145] neg_lo:[0,0,1] neg_hi:[0,0,1]
    v_pk_fma_f32 v[146:147], v[12:13], v[154:155], v[146:147] neg_lo:[0,0,1] neg_hi:[0,0,1]
    v_pk_fma_f32 v[148:149], v[12:13], v[156:157], v[148:149] neg_lo:[0,0,1] neg_hi:[0,0,1]
    v_pk_fma_f32 v[150:151], v[12:13], v[158:159], v[150:151] neg_lo:[0,0,1] neg_hi:[0,0,1]
    v_add_u32 v166, v166, v15
    v_mov_b32 v65, 0
    v_mov_b32 v73, 0
    buffer_load_short_d16_hi v65, v166, s[4:7], 0 offen
    buffer_load_short_d16_hi v73, v166, s[12:15], 0 offen
    v_cvt_pk_f16_f32 v88, v144, v145
    v_cvt_pk_f16_f32 v89, v146, v147
    v_cvt_pk_f16_f32 v90, v148, v149
    v_cvt_pk_f16_f32 v91, v150, v151
    v_pk_fma_f32 v[152:153], v[12:13], v[144:145], v[152:153] neg_lo:[0,0,1] neg_hi:[0,0,1]
    v_pk_fma_f32 v[154:155], v[12:13], v[146:147], v[154:155] neg_lo:[0,0,1] neg_hi:[0,0,1]
    v_pk_fma_f32 v[156:157], v[12:13], v[148:149], v[156:157] neg_lo:[0,0,1] neg_hi:[0,0,1]
    v_pk_fma_f32 v[158:159], v[12:13], v[150:151], v[158:159] neg_lo:[0,0,1] neg_hi:[0,0,1]
    v_add_u32 v166, v166, v15
    v_mov_b32 v66, 0
    v_mov_b32 v74, 0
    buffer_load_short_d16_hi v66, v166, s[4:7], 0 offen
    buffer_load_short_d16_hi v74, v166, s[12:15], 0 offen
    v_cvt_pk_f16_f32 v92, v152, v153
    v_cvt_pk_f16_f32 v93, v154, v155
    v_cvt_pk_f16_f32 v94, v156, v157
    v_cvt_pk_f16_f32 v95, v158, v159
    v_pk_fma_f32 v[144:145], v[12:13], v[152:153], v[144:145] neg_lo:[0,0,1] neg_hi:[0,0,1]
    v_pk_fma_f32 v[146:147], v[12:13], v[154:155], v[146:147] neg_lo:[0,0,1] neg_hi:[0,0,1]
    v_pk_fma_f32 v[148:149], v[12:13], v[156:157], v[148:149] neg_lo:[0,0,1] neg_hi:[0,0,1]
    v_pk_fma_f32 v[150:151], v[12:13], v[158:159], v[150:151] neg_lo:[0,0,1] neg_hi:[0,0,1]
    v_add_u32 v166, v166, v15
    v_mov_b32 v67, 0
    v_mov_b32 v75, 0
    buffer_load_short_d16_hi v67, v166, s[4:7], 0 offen
    buffer_load_short_d16_hi v75, v166, s[12:15], 0 offen
    v_cvt_pk_f16_f32 v96, v144, v145
    v_cvt_pk_f16_f32 v97, v146, v147
    v_cvt_pk_f16_f32 v98, v148, v149
    v_cvt_pk_f16_f32 v99, v150, v151
    v_pk_fma_f32 v[152:153], v[12:13], v[144:145], v[152:153] neg_lo:[0,0,1] neg_hi:[0,0,1]
    v_pk_fma_f32 v[154:155], v[12:13], v[146:147], v[154:155] neg_lo:[0,0,1] neg_hi:[0,0,1]
    v_pk_fma_f32 v[156:157], v[12:13], v[148:149], v[156:157] neg_lo:[0,0,1] neg_hi:[0,0,1]
    v_pk_fma_f32 v[158:159], v[12:13], v[150:151], v[158:159] neg_lo:[0,0,1] neg_hi:[0,0,1]
    v_mov_b32 v68, 0
    v_mov_b32 v76, 0
    buffer_load_short_d16_hi v68, v167, s[4:7], 0 offen
    buffer_load_short_d16_hi v76, v167, s[12:15], 0 offen
    v_cvt_pk_f16_f32 v100, v152, v153
    v_cvt_pk_f16_f32 v101, v154, v155
    v_cvt_pk_f16_f32 v102, v156, v157
    v_cvt_pk_f16_f32 v103, v158, v159
    v_pk_fma_f32 v[144:145], v[12:13], v[152:153], v[144:145] neg_lo:[0,0,1] neg_hi:[0,0,1]
    v_pk_fma_f32 v[146:147], v[12:13], v[154:155], v[146:147] neg_lo:[0,0,1] neg_hi:[0,0,1]
    v_pk_fma_f32 v[148:149], v[12:13], v[156:157], v[148:149] neg_lo:[0,0,1] neg_hi:[0,0,1]
    v_pk_fma_f32 v[150:151], v[12:13], v[158:159], v[150:151] neg_lo:[0,0,1] neg_hi:[0,0,1]
    v_add_u32 v167, v167, v15
    v_mov_b32 v69, 0
    v_mov_b32 v77, 0
    buffer_load_short_d16_hi v69, v167, s[4:7], 0 offen
    buffer_load_short_d16_hi v77, v167, s[12:15], 0 offen
    v_cvt_pk_f16_f32 v104, v144, v145
    v_cvt_pk_f16_f32 v105, v146, v147
    v_cvt_pk_f16_f32 v106, v148, v149
    v_cvt_pk_f16_f32 v107, v150, v151
    v_pk_fma_f32 v[152:153], v[12:13], v[144:145], v[152:153] neg_lo:[0,0,1] neg_hi:[0,0,1]
    v_pk_fma_f32 v[154:155], v[12:13], v[146:147], v[154:155] neg_lo:[0,0,1] neg_hi:[0,0,1]
    v_pk_fma_f32 v[156:157], v[12:13], v[148:149], v[156:157] neg_lo:[0,0,1] neg_hi:[0,0,1]
    v_pk_fma_f32 v[158:159], v[12:13], v[150:151], v[158:159] neg_lo:[0,0,1] neg_hi:[0,0,1]
    v_add_u32 v167, v167, v15
    v_mov_b32 v70, 0
    v_mov_b32 v78, 0
    buffer_load_short_d16_hi v70, v167, s[4:7], 0 offen
    buffer_load_short_d16_hi v78, v167, s[12:15], 0 offen
    v_cvt_pk_f16_f32 v108, v152, v153
    v_cvt_pk_f16_f32 v109, v154, v155
    v_cvt_pk_f16_f32 v110, v156, v157
    v_cvt_pk_f16_f32 v111, v158, v159
    v_pk_fma_f32 v[144:145], v[12:13], v[152:153], v[144:145] neg_lo:[0,0,1] neg_hi:[0,0,1]
    v_pk_fma_f32 v[146:147], v[12:13], v[154:155], v[146:147] neg_lo:[0,0,1] neg_hi:[0,0,1]
    v_pk_fma_f32 v[148:149], v[12:13], v[156:157], v[148:149] neg_lo:[0,0,1] neg_hi:[0,0,1]
    v_pk_fma_f32 v[150:151], v[12:13], v[158:159], v[150:151] neg_lo:[0,0,1] neg_hi:[0,0,1]
    v_add_u32 v167, v167, v15
    v_mov_b32 v71, 0
    v_mov_b32 v79, 0
    buffer_load_short_d16_hi v71, v167, s[4:7], 0 offen
    buffer_load_short_d16_hi v79, v167, s[12:15], 0 offen
    v_cvt_pk_f16_f32 v112, v144, v145
    v_cvt_pk_f16_f32 v113, v146, v147
    v_cvt_pk_f16_f32 v114, v148, v149
    v_cvt_pk_f16_f32 v115, v150, v151
    v_pk_fma_f32 v[152:153], v[12:13], v[144:145], v[152:153] neg_lo:[0,0,1] neg_hi:[0,0,1]
    v_pk_fma_f32 v[154:155], v[12:13], v[146:147], v[154:155] neg_lo:[0,0,1] neg_hi:[0,0,1]
    v_pk_fma_f32 v[156:157], v[12:13], v[148:149], v[156:157] neg_lo:[0,0,1] neg_hi:[0,0,1]
    v_pk_fma_f32 v[158:159], v[12:13], v[150:151], v[158:159] neg_lo:[0,0,1] neg_hi:[0,0,1]
    v_cvt_pk_f16_f32 v116, v152, v153
    v_cvt_pk_f16_f32 v117, v154, v155
    v_cvt_pk_f16_f32 v118, v156, v157
    v_cvt_pk_f16_f32 v119, v158, v159
    s_cmp_ge_u32 s20, 4
    s_cbranch_scc1 K2_NOPREP
    s_waitcnt vmcnt(35)
    v_max_u32_dpp v164, v164, v164 row_ror:1 row_mask:0xf bank_mask:0xf
    s_nop 1
    v_max_u32_dpp v164, v164, v164 row_ror:2 row_mask:0xf bank_mask:0xf
    s_nop 1
    v_max_u32_dpp v164, v164, v164 row_ror:4 row_mask:0xf bank_mask:0xf
    s_nop 1
    v_max_u32_dpp v164, v164, v164 row_ror:8 row_mask:0xf bank_mask:0xf
    s_nop 0
    v_readlane_b32 s40, v164, 0
    v_readlane_b32 s41, v164, 16
    s_nop 0
    s_max_u32 s40, s40, s41
    v_readlane_b32 s41, v164, 32
    s_nop 0
    s_max_u32 s40, s40, s41
    v_readlane_b32 s41, v164, 48
    s_nop 0
    s_max_u32 s40, s40, s41
    s_lshr_b32 s40, s40, 23
    s_max_u32 s40, s40, 64
    s_min_u32 s40, s40, 189
    s_sub_u32 s41, 253, s40
    s_lshl_b32 s41, s41, 23
    s_lshl_b32 s44, s18, 31
    s_xor_b32 s42, s44, s41
    s_waitcnt vmcnt(33)
    v_lshlrev_b32 v144, 16, v48
    v_and_b32 v145, 0xffff0000, v48
    v_mul_f32 v144, s41, v144
    v_mul_f32 v145, s41, v145
    v_cvt_pk_f16_f32 v48, v144, v145
    v_lshlrev_b32 v146, 16, v52
    v_and_b32 v147, 0xffff0000, v52
    v_mul_f32 v146, s42, v146
    v_mul_f32 v147, s42, v147
    v_cvt_pk_f16_f32 v52, v146, v147
    v_lshlrev_b32 v144, 16, v49
    v_and_b32 v145, 0xffff0000, v49
    v_mul_f32 v144, s41, v144
    v_mul_f32 v145, s41, v145
    v_cvt_pk_f16_f32 v49, v144, v145
    v_lshlrev_b32 v146, 16, v53
    v_and_b32 v147, 0xffff0000, v53
    v_mul_f32 v146, s42, v146
    v_mul_f32 v147, s42, v147
    v_cvt_pk_f16_f32 v53, v146, v147
    v_lshlrev_b32 v144, 16, v50
    v_and_b32 v145, 0xffff0000, v50
    v_mul_f32 v144, s41, v144
    v_mul_f32 v145, s41, v145
    v_cvt_pk_f16_f32 v50, v144, v145
    v_lshlrev_b32 v146, 16, v54
    v_and_b32 v147, 0xffff0000, v54
    v_mul_f32 v146, s42, v146
    v_mul_f32 v147, s42, v147
    v_cvt_pk_f16_f32 v54, v146, v147
    v_lshlrev_b32 v144, 16, v51
    v_and_b32 v145, 0xffff0000, v51
    v_mul_f32 v144, s41, v144
    v_mul_f32 v145, s41, v145
    v_cvt_pk_f16_f32 v51, v144, v145
    v_lshlrev_b32 v146, 16, v55
    v_and_b32 v147, 0xffff0000, v55
    v_mul_f32 v146, s42, v146
    v_mul_f32 v147, s42, v147
    v_cvt_pk_f16_f32 v55, v146, v147
    s_cmp_lg_u32 s16, 0
    s_cbranch_scc1 K2_NOSA2_1
    s_add_u32 s43, s41, 25165824
    v_cmp_gt_u32 vcc, 4, v6
    v_mov_b32 v150, s43
    s_nop 0
    v_cndmask_b32 v150, 0, v150, vcc
    v_xor_b32 v151, s44, v150
    v_lshlrev_b32 v146, 16, v56
    v_and_b32 v147, 0xffff0000, v56
    v_lshlrev_b32 v148, 16, v60
    v_and_b32 v149, 0xffff0000, v60
    v_mul_f32 v146, v150, v146
    v_mul_f32 v147, v150, v147
    v_fmac_f32 v146, v151, v148
    v_fmac_f32 v147, v151, v149
    v_cvt_pk_f16_f32 v56, v146, v147
    v_lshlrev_b32 v146, 16, v57
    v_and_b32 v147, 0xffff0000, v57
    v_lshlrev_b32 v148, 16, v61
    v_and_b32 v149, 0xffff0000, v61
    v_mul_f32 v146, v150, v146
    v_mul_f32 v147, v150, v147
    v_fmac_f32 v146, v151, v148
    v_fmac_f32 v147, v151, v149
    v_cvt_pk_f16_f32 v57, v146, v147
    v_lshlrev_b32 v146, 16, v58
    v_and_b32 v147, 0xffff0000, v58
    v_lshlrev_b32 v148, 16, v62
    v_and_b32 v149, 0xffff0000, v62
    v_mul_f32 v146, v150, v146
    v_mul_f32 v147, v150, v147
    v_fmac_f32 v146, v151, v148
    v_fmac_f32 v147, v151, v149
    v_cvt_pk_f16_f32 v58, v146, v147
    v_lshlrev_b32 v146, 16, v59
    v_and_b32 v147, 0xffff0000, v59
    v_lshlrev_b32 v148, 16, v63
    v_and_b32 v149, 0xffff0000, v63
    v_mul_f32 v146, v150, v146
    v_mul_f32 v147, v150, v147
    v_fmac_f32 v146, v151, v148
    v_fmac_f32 v147, v151, v149
    v_cvt_pk_f16_f32 v59, v146, v147
K2_NOSA2_1:
    s_waitcnt vmcnt(31)
    v_pk_fma_f16 v168, v168, v48, v56
    v_pk_fma_f16 v169, v169, v49, v57
    v_pk_fma_f16 v170, v170, v50, v58
    v_pk_fma_f16 v171, v171, v51, v59
    v_pk_fma_f16 v168, v172, v52, v168
    v_pk_fma_f16 v169, v173, v53, v169
    v_pk_fma_f16 v170, v174, v54, v170
    v_pk_fma_f16 v171, v175, v55, v171
    ds_write_b128 v10, v[168:171] offset:0
    s_waitcnt vmcnt(29)
    v_pk_fma_f16 v176, v176, v48, v56
    v_pk_fma_f16 v177, v177, v49, v57
    v_pk_fma_f16 v178, v178, v50, v58
    v_pk_fma_f16 v179, v179, v51, v59
    v_pk_fma_f16 v176, v180, v52, v176
    v_pk_fma_f16 v177, v181, v53, v177
    v_pk_fma_f16 v178, v182, v54, v178
    v_pk_fma_f16 v179, v183, v55, v179
    ds_write_b128 v10, v[176:179] offset:672
    s_waitcnt vmcnt(27)
    v_pk_fma_f16 v184, v184, v48, v56
    v_pk_fma_f16 v185, v185, v49, v57
    v_pk_fma_f16 v186, v186, v50, v58
    v_pk_fma_f16 v187, v187, v51, v59
    v_pk_fma_f16 v184, v188, v52, v184
    v_pk_fma_f16 v185, v189, v53, v185
    v_pk_fma_f16 v186, v190, v54, v186
    v_pk_fma_f16 v187, v191, v55, v187
    ds_write_b128 v10, v[184:187] offset:1344
    s_waitcnt vmcnt(25)
    v_pk_fma_f16 v192, v192, v48, v56
    v_pk_fma_f16 v193, v193, v49, v57
    v_pk_fma_f16 v194, v194, v50, v58
    v_pk_fma_f16 v195, v195, v51, v59
    v_pk_fma_f16 v192, v196, v52, v192
    v_pk_fma_f16 v193, v197, v53, v193
    v_pk_fma_f16 v194, v198, v54, v194
    v_pk_fma_f16 v195, v199, v55, v195
    ds_write_b128 v10, v[192:195] offset:2016
    s_waitcnt vmcnt(23)
    v_pk_fma_f16 v200, v200, v48, v56
    v_pk_fma_f16 v201, v201, v49, v57
    v_pk_fma_f16 v202, v202, v50, v58
    v_pk_fma_f16 v203, v203, v51, v59
    v_pk_fma_f16 v200, v204, v52, v200
    v_pk_fma_f16 v201, v205, v53, v201
    v_pk_fma_f16 v202, v206, v54, v202
    v_pk_fma_f16 v203, v207, v55, v203
    ds_write_b128 v10, v[200:203] offset:2688
    s_waitcnt vmcnt(21)
    v_pk_fma_f16 v208, v208, v48, v56
    v_pk_fma_f16 v209, v209, v49, v57
    v_pk_fma_f16 v210, v210, v50, v58
    v_pk_fma_f16 v211, v211, v51, v59
    v_pk_fma_f16 v208, v212, v52, v208
    v_pk_fma_f16 v209, v213, v53, v209
    v_pk_fma_f16 v210, v214, v54, v210
    v_pk_fma_f16 v211, v215, v55, v211
    ds_write_b128 v10, v[208:211] offset:3360
    s_waitcnt vmcnt(19)
    v_pk_fma_f16 v216, v216, v48, v56
    v_pk_fma_f16 v217, v217, v49, v57
    v_pk_fma_f16 v218, v218, v50, v58
    v_pk_fma_f16 v219, v219, v51, v59
    v_pk_fma_f16 v216, v220, v52, v216
    v_pk_fma_f16 v217, v221, v53, v217
    v_pk_fma_f16 v218, v222, v54, v218
    v_pk_fma_f16 v219, v223, v55, v219
    ds_write_b128 v10, v[216:219] offset:4032
    s_waitcnt vmcnt(17)
    v_pk_fma_f16 v224, v224, v48, v56
    v_pk_fma_f16 v225, v225, v49, v57
    v_pk_fma_f16 v226, v226, v50, v58
    v_pk_fma_f16 v227, v227, v51, v59
    v_pk_fma_f16 v224, v228, v52, v224
    v_pk_fma_f16 v225, v229, v53, v225
    v_pk_fma_f16 v226, v230, v54, v226
    v_pk_fma_f16 v227, v231, v55, v227
    ds_write_b128 v10, v[224:227] offset:4704
K2_NOPREP:
    v_mul_u32_u24 v10, 672, v1
    v_lshl_add_u32 v10, v2, 4, v10
    v_lshlrev_b32 v9, 4, v3
    s_waitcnt lgkmcnt(0)
    s_barrier
    ds_read_b128 v[32:35], v10 offset:0
    ds_read_b128 v[36:39], v10 offset:10752
    ds_read_b128 v[40:43], v10 offset:21504
    ds_read_b128 v[44:47], v10 offset:32256
    ds_read_b128 v[48:51], v10 offset:64
    ds_read_b128 v[52:55], v10 offset:10816
    ds_read_b128 v[56:59], v10 offset:21568
    ds_read_b128 v[60:63], v10 offset:32320
    s_waitcnt lgkmcnt(7)
    v_mfma_f32_16x16x32_f16 v[16:19], v[32:35], v[80:83], 0
    s_waitcnt lgkmcnt(6)
    v_mfma_f32_16x16x32_f16 v[20:23], v[36:39], v[80:83], 0
    s_waitcnt lgkmcnt(5)
    v_mfma_f32_16x16x32_f16 v[24:27], v[40:43], v[80:83], 0
    s_waitcnt lgkmcnt(4)
    v_mfma_f32_16x16x32_f16 v[28:31], v[44:47], v[80:83], 0
    ds_read_b128 v[32:35], v10 offset:128
    ds_read_b128 v[36:39], v10 offset:10880
    ds_read_b128 v[40:43], v10 offset:21632
    ds_read_b128 v[44:47], v10 offset:32384
    s_waitcnt lgkmcnt(7)
    v_mfma_f32_16x16x32_f16 v[16:19], v[48:51], v[84:87], v[16:19]
    s_waitcnt lgkmcnt(6)
    v_mfma_f32_16x16x32_f16 v[20:23], v[52:55], v[84:87], v[20:23]
    s_waitcnt lgkmcnt(5)
    v_mfma_f32_16x16x32_f16 v[24:27], v[56:59], v[84:87], v[24:27]
    s_waitcnt lgkmcnt(4)
    v_mfma_f32_16x16x32_f16 v[28:31], v[60:63], v[84:87], v[28:31]
    ds_read_b128 v[48:51], v10 offset:192
    ds_read_b128 v[52:55], v10 offset:10944
    ds_read_b128 v[56:59], v10 offset:21696
    ds_read_b128 v[60:63], v10 offset:32448
    s_waitcnt lgkmcnt(7)
    v_mfma_f32_16x16x32_f16 v[16:19], v[32:35], v[88:91], v[16:19]
    s_waitcnt lgkmcnt(6)
    v_mfma_f32_16x16x32_f16 v[20:23], v[36:39], v[88:91], v[20:23]
    s_waitcnt lgkmcnt(5)
    v_mfma_f32_16x16x32_f16 v[24:27], v[40:43], v[88:91], v[24:27]
    s_waitcnt lgkmcnt(4)
    v_mfma_f32_16x16x32_f16 v[28:31], v[44:47], v[88:91], v[28:31]
    ds_read_b128 v[32:35], v10 offset:256
    ds_read_b128 v[36:39], v10 offset:11008
    ds_read_b128 v[40:43], v10 offset:21760
    ds_read_b128 v[44:47], v10 offset:32512
    s_waitcnt lgkmcnt(7)
    v_mfma_f32_16x16x32_f16 v[16:19], v[48:51], v[92:95], v[16:19]
    s_waitcnt lgkmcnt(6)
    v_mfma_f32_16x16x32_f16 v[20:23], v[52:55], v[92:95], v[20:23]
    s_waitcnt lgkmcnt(5)
    v_mfma_f32_16x16x32_f16 v[24:27], v[56:59], v[92:95], v[24:27]
    s_waitcnt lgkmcnt(4)
    v_mfma_f32_16x16x32_f16 v[28:31], v[60:63], v[92:95], v[28:31]
    ds_read_b128 v[48:51], v10 offset:320
    ds_read_b128 v[52:55], v10 offset:11072
    ds_read_b128 v[56:59], v10 offset:21824
    ds_read_b128 v[60:63], v10 offset:32576
    s_waitcnt lgkmcnt(7)
    v_mfma_f32_16x16x32_f16 v[16:19], v[32:35], v[96:99], v[16:19]
    s_waitcnt lgkmcnt(6)
    v_mfma_f32_16x16x32_f16 v[20:23], v[36:39], v[96:99], v[20:23]
    s_waitcnt lgkmcnt(5)
    v_mfma_f32_16x16x32_f16 v[24:27], v[40:43], v[96:99], v[24:27]
    s_waitcnt lgkmcnt(4)
    v_mfma_f32_16x16x32_f16 v[28:31], v[44:47], v[96:99], v[28:31]
    ds_read_b128 v[32:35], v10 offset:384
    ds_read_b128 v[36:39], v10 offset:11136
    ds_read_b128 v[40:43], v10 offset:21888
    ds_read_b128 v[44:47], v10 offset:32640
    s_waitcnt lgkmcnt(7)
    v_mfma_f32_16x16x32_f16 v[16:19], v[48:51], v[100:103], v[16:19]
    s_waitcnt lgkmcnt(6)
    v_mfma_f32_16x16x32_f16 v[20:23], v[52:55], v[100:103], v[20:23]
    s_waitcnt lgkmcnt(5)
    v_mfma_f32_16x16x32_f16 v[24:27], v[56:59], v[100:103], v[24:27]
    s_waitcnt lgkmcnt(4)
    v_mfma_f32_16x16x32_f16 v[28:31], v[60:63], v[100:103], v[28:31]
    ds_read_b128 v[48:51], v10 offset:448
    ds_read_b128 v[52:55], v10 offset:11200
    ds_read_b128 v[56:59], v10 offset:21952
    ds_read_b128 v[60:63], v10 offset:32704
    s_waitcnt lgkmcnt(7)
    v_mfma_f32_16x16x32_f16 v[16:19], v[32:35], v[104:107], v[16:19]
    s_waitcnt lgkmcnt(6)
    v_mfma_f32_16x16x32_f16 v[20:23], v[36:39], v[104:107], v[20:23]
    s_waitcnt lgkmcnt(5)
    v_mfma_f32_16x16x32_f16 v[24:27], v[40:43], v[104:107], v[24:27]
    s_waitcnt lgkmcnt(4)
    v_mfma_f32_16x16x32_f16 v[28:31], v[44:47], v[104:107], v[28:31]
    ds_read_b128 v[32:35], v10 offset:512
    ds_read_b128 v[36:39], v10 offset:11264
    ds_read_b128 v[40:43], v10 offset:22016
    ds_read_b128 v[44:47], v10 offset:32768
    s_waitcnt lgkmcnt(7)
    v_mfma_f32_16x16x32_f16 v[16:19], v[48:51], v[108:111], v[16:19]
    s_waitcnt lgkmcnt(6)
    v_mfma_f32_16x16x32_f16 v[20:23], v[52:55], v[108:111], v[20:23]
    s_waitcnt lgkmcnt(5)
    v_mfma_f32_16x16x32_f16 v[24:27], v[56:59], v[108:111], v[24:27]
    s_waitcnt lgkmcnt(4)
    v_mfma_f32_16x16x32_f16 v[28:31], v[60:63], v[108:111], v[28:31]
    ds_read_b128 v[48:51], v10 offset:576
    ds_read_b128 v[52:55], v10 offset:11328
    ds_read_b128 v[56:59], v10 offset:22080
    ds_read_b128 v[60:63], v10 offset:32832
    s_waitcnt lgkmcnt(7)
    v_mfma_f32_16x16x32_f16 v[16:19], v[32:35], v[112:115], v[16:19]
    s_waitcnt lgkmcnt(6)
    v_mfma_f32_16x16x32_f16 v[20:23], v[36:39], v[112:115], v[20:23]
    s_waitcnt lgkmcnt(5)
    v_mfma_f32_16x16x32_f16 v[24:27], v[40:43], v[112:115], v[24:27]
    s_waitcnt lgkmcnt(4)
    v_mfma_f32_16x16x32_f16 v[28:31], v[44:47], v[112:115], v[28:31]
    s_waitcnt lgkmcnt(3)
    v_mfma_f32_16x16x32_f16 v[16:19], v[48:51], v[116:119], v[16:19]
    s_waitcnt lgkmcnt(2)
    v_mfma_f32_16x16x32_f16 v[20:23], v[52:55], v[116:119], v[20:23]
    s_waitcnt lgkmcnt(1)
    v_mfma_f32_16x16x32_f16 v[24:27], v[56:59], v[116:119], v[24:27]
    s_waitcnt lgkmcnt(0)
    v_mfma_f32_16x16x32_f16 v[28:31], v[60:63], v[116:119], v[28:31]
    ds_read_b128 v[120:123], v9 offset:43008
    ds_read_b128 v[124:127], v9 offset:44032
    ds_read_b128 v[128:131], v9 offset:45056
    ds_read_b128 v[132:135], v9 offset:46080
    ds_read_b128 v[136:139], v9 offset:47104
    ds_read_b128 v[140:143], v9 offset:48128
    ds_read_b128 v[144:147], v9 offset:49152
    ds_read_b128 v[148:151], v9 offset:50176
    ds_read_b128 v[152:155], v9 offset:51200
    ds_read_b128 v[156:159], v9 offset:52224
    ds_read_b128 v[160:163], v9 offset:53248
    s_waitcnt vmcnt(0)
    v_max_u32_dpp v165, v165, v165 row_ror:1 row_mask:0xf bank_mask:0xf
    s_nop 1
    v_max_u32_dpp v165, v165, v165 row_ror:2 row_mask:0xf bank_mask:0xf
    s_nop 1
    v_max_u32_dpp v165, v165, v165 row_ror:4 row_mask:0xf bank_mask:0xf
    s_nop 1
    v_max_u32_dpp v165, v165, v165 row_ror:8 row_mask:0xf bank_mask:0xf
    s_nop 0
    v_readlane_b32 s45, v165, 0
    v_readlane_b32 s46, v165, 16
    s_nop 0
    s_max_u32 s45, s45, s46
    v_readlane_b32 s46, v165, 32
    s_nop 0
    s_max_u32 s45, s45, s46
    v_readlane_b32 s46, v165, 48
    s_nop 0
    s_max_u32 s45, s45, s46
    s_lshr_b32 s45, s45, 23
    s_max_u32 s45, s45, 64
    s_min_u32 s45, s45, 189
    s_sub_u32 s46, 253, s45
    s_lshl_b32 s46, s46, 23
    s_xor_b32 s47, s46, 0x80000000
    s_cmp_eq_u32 s16, 0
    s_cselect_b32 s47, s46, s47
    v_mov_b32 v11, s46
    v_mov_b32 v12, s47
    v_cndmask_b32 v11, v11, v12, s[26:27]
    v_mul_f32 v64, s46, v64
    v_mul_f32 v72, v11, v72
    v_mul_f32 v65, s46, v65
    v_mul_f32 v73, v11, v73
    v_mul_f32 v66, s46, v66
    v_mul_f32 v74, v11, v74
    v_mul_f32 v67, s46, v67
    v_mul_f32 v75, v11, v75
    v_mul_f32 v68, s46, v68
    v_mul_f32 v76, v11, v76
    v_mul_f32 v69, s46, v69
    v_mul_f32 v77, v11, v77
    v_mul_f32 v70, s46, v70
    v_mul_f32 v78, v11, v78
    v_mul_f32 v71, s46, v71
    v_mul_f32 v79, v11, v79
    s_waitcnt lgkmcnt(0)
    s_cmp_eq_u32 s16, 0
    s_cbranch_scc1 K2_S0A
    v_sub_f32_dpp v32, v16, v24 row_ror:8 row_mask:0xf bank_mask:0xf
    v_add_f32_dpp v40, v24, v16 row_ror:8 row_mask:0xf bank_mask:0xf
    v_sub_f32_dpp v33, v17, v25 row_ror:8 row_mask:0xf bank_mask:0xf
    v_add_f32_dpp v41, v25, v17 row_ror:8 row_mask:0xf bank_mask:0xf
    v_sub_f32_dpp v34, v18, v26 row_ror:8 row_mask:0xf bank_mask:0xf
    v_add_f32_dpp v42, v26, v18 row_ror:8 row_mask:0xf bank_mask:0xf
    v_sub_f32_dpp v35, v19, v27 row_ror:8 row_mask:0xf bank_mask:0xf
    v_add_f32_dpp v43, v27, v19 row_ror:8 row_mask:0xf bank_mask:0xf
    v_sub_f32_dpp v36, v20, v28 row_ror:8 row_mask:0xf bank_mask:0xf
    v_add_f32_dpp v44, v28, v20 row_ror:8 row_mask:0xf bank_mask:0xf
    v_sub_f32_dpp v37, v21, v29 row_ror:8 row_mask:0xf bank_mask:0xf
    v_add_f32_dpp v45, v29, v21 row_ror:8 row_mask:0xf bank_mask:0xf
    v_sub_f32_dpp v38, v22, v30 row_ror:8 row_mask:0xf bank_mask:0xf
    v_add_f32_dpp v46, v30, v22 row_ror:8 row_mask:0xf bank_mask:0xf
    v_sub_f32_dpp v39, v23, v31 row_ror:8 row_mask:0xf bank_mask:0xf
    v_add_f32_dpp v47, v31, v23 row_ror:8 row_mask:0xf bank_mask:0xf
    s_branch K2_S0A_DONE
K2_S0A:
    v_mov_b32 v12, 0
    v_mov_b32 v32, v16
    v_sub_f32 v40, 0, v24
    v_mov_b32 v33, v17
    v_sub_f32 v41, 0, v25
    v_mov_b32 v34, v18
    v_sub_f32 v42, 0, v26
    v_mov_b32 v35, v19
    v_sub_f32 v43, 0, v27
    v_mov_b32 v36, v20
    v_sub_f32 v44, 0, v28
    v_mov_b32 v37, v21
    v_sub_f32 v45, 0, v29
    v_mov_b32 v38, v22
    v_sub_f32 v46, 0, v30
    v_mov_b32 v39, v23
    v_sub_f32 v47, 0, v31
    v_mov_b32_dpp v32, v24 row_ror:8 row_mask:0xf bank_mask:0xc
    v_subrev_f32_dpp v40, v16, v12 row_ror:8 row_mask:0xf bank_mask:0x3
    v_mov_b32_dpp v33, v25 row_ror:8 row_mask:0xf bank_mask:0xc
    v_subrev_f32_dpp v41, v17, v12 row_ror:8 row_mask:0xf bank_mask:0x3
    v_mov_b32_dpp v34, v26 row_ror:8 row_mask:0xf bank_mask:0xc
    v_subrev_f32_dpp v42, v18, v12 row_ror:8 row_mask:0xf bank_mask:0x3
    v_mov_b32_dpp v35, v27 row_ror:8 row_mask:0xf bank_mask:0xc
    v_subrev_f32_dpp v43, v19, v12 row_ror:8 row_mask:0xf bank_mask:0x3
    v_mov_b32_dpp v36, v28 row_ror:8 row_mask:0xf bank_mask:0xc
    v_subrev_f32_dpp v44, v20, v12 row_ror:8 row_mask:0xf bank_mask:0x3
    v_mov_b32_dpp v37, v29 row_ror:8 row_mask:0xf bank_mask:0xc
    v_subrev_f32_dpp v45, v21, v12 row_ror:8 row_mask:0xf bank_mask:0x3
    v_mov_b32_dpp v38, v30 row_ror:8 row_mask:0xf bank_mask:0xc
    v_subrev_f32_dpp v46, v22, v12 row_ror:8 row_mask:0xf bank_mask:0x3
    v_mov_b32_dpp v39, v31 row_ror:8 row_mask:0xf bank_mask:0xc
    v_subrev_f32_dpp v47, v23, v12 row_ror:8 row_mask:0xf bank_mask:0x3
K2_S0A_DONE:
    v_pk_mul_f32 v[48:49], v[32:33], v[144:145]
    v_pk_mul_f32 v[56:57], v[32:33], v[152:153]
    v_pk_mul_f32 v[50:51], v[34:35], v[146:147]
    v_pk_mul_f32 v[58:59], v[34:35], v[154:155]
    v_pk_mul_f32 v[52:53], v[36:37], v[148:149]
    v_pk_mul_f32 v[60:61], v[36:37], v[156:157]
    v_pk_mul_f32 v[54:55], v[38:39], v[150:151]
    v_pk_mul_f32 v[62:63], v[38:39], v[158:159]
    v_pk_fma_f32 v[48:49], v[40:41], v[152:153], v[48:49] neg_lo:[1,0,0] neg_hi:[1,0,0]
    v_pk_fma_f32 v[56:57], v[40:41], v[144:145], v[56:57]
    v_pk_fma_f32 v[50:51], v[42:43], v[154:155], v[50:51] neg_lo:[1,0,0] neg_hi:[1,0,0]
    v_pk_fma_f32 v[58:59], v[42:43], v[146:147], v[58:59]
    v_pk_fma_f32 v[52:53], v[44:45], v[156:157], v[52:53] neg_lo:[1,0,0] neg_hi:[1,0,0]
    v_pk_fma_f32 v[60:61], v[44:45], v[148:149], v[60:61]
    v_pk_fma_f32 v[54:55], v[46:47], v[158:159], v[54:55] neg_lo:[1,0,0] neg_hi:[1,0,0]
    v_pk_fma_f32 v[62:63], v[46:47], v[150:151], v[62:63]
    v_cvt_pk_f16_f32 v80, v48, v49
    v_cvt_pk_f16_f32 v84, v56, v57
    v_cvt_pk_f16_f32 v81, v50, v51
    v_cvt_pk_f16_f32 v85, v58, v59
    v_cvt_pk_f16_f32 v82, v52, v53
    v_cvt_pk_f16_f32 v86, v60, v61
    v_cvt_pk_f16_f32 v83, v54, v55
    v_cvt_pk_f16_f32 v87, v62, v63
    s_nop 0
    v_mfma_f32_16x16x32_f16 v[16:19], v[120:123], v[80:83], 0
    v_mfma_f32_16x16x32_f16 v[24:27], v[128:131], v[80:83], 0
    v_mfma_f32_16x16x32_f16 v[20:23], v[124:127], v[80:83], 0
    v_mfma_f32_16x16x32_f16 v[28:31], v[132:135], v[80:83], 0
    v_mfma_f32_16x16x32_f16 v[16:19], v[136:139], v[84:87], v[16:19]
    v_mfma_f32_16x16x32_f16 v[24:27], v[120:123], v[84:87], v[24:27]
    v_mfma_f32_16x16x32_f16 v[20:23], v[140:143], v[84:87], v[20:23]
    v_mfma_f32_16x16x32_f16 v[28:31], v[124:127], v[84:87], v[28:31]
    v_lshrrev_b32 v11, 1, v2
    v_lshl_add_u32 v11, v11, 4, v1
    s_mov_b32 s48, 81920
    v_mul_lo_u32 v11, v11, s48
    v_and_b32 v12, 1, v2
    v_lshl_add_u32 v11, v12, 5, v11
    s_mul_i32 s48, s16, 2560
    s_mul_i32 s49, s18, 20
    s_add_u32 s49, s49, s53
    s_cmp_eq_u32 s20, 5
    s_cselect_b32 s49, 0, s49
    s_lshl_b32 s50, s49, 6
    s_add_u32 s48, s48, s50
    s_add_u32 s48, s48, 0x400000
    v_add_u32 v11, s48, v11
    v_pk_mul_f32 v[32:33], v[16:17], v[64:65]
    v_pk_mul_f32 v[40:41], v[16:17], v[72:73]
    v_pk_mul_f32 v[34:35], v[18:19], v[66:67]
    v_pk_mul_f32 v[42:43], v[18:19], v[74:75]
    v_pk_mul_f32 v[36:37], v[20:21], v[68:69]
    v_pk_mul_f32 v[44:45], v[20:21], v[76:77]
    v_pk_mul_f32 v[38:39], v[22:23], v[70:71]
    v_pk_mul_f32 v[46:47], v[22:23], v[78:79]
    v_pk_fma_f32 v[32:33], v[24:25], v[72:73], v[32:33] neg_lo:[1,0,0] neg_hi:[1,0,0]
    v_pk_fma_f32 v[40:41], v[24:25], v[64:65], v[40:41]
    v_pk_fma_f32 v[34:35], v[26:27], v[74:75], v[34:35] neg_lo:[1,0,0] neg_hi:[1,0,0]
    v_pk_fma_f32 v[42:43], v[26:27], v[66:67], v[42:43]
    v_pk_fma_f32 v[36:37], v[28:29], v[76:77], v[36:37] neg_lo:[1,0,0] neg_hi:[1,0,0]
    v_pk_fma_f32 v[44:45], v[28:29], v[68:69], v[44:45]
    v_pk_fma_f32 v[38:39], v[30:31], v[78:79], v[38:39] neg_lo:[1,0,0] neg_hi:[1,0,0]
    v_pk_fma_f32 v[46:47], v[30:31], v[70:71], v[46:47]
    v_cvt_pk_f16_f32 v80, v32, v33
    v_cvt_pk_f16_f32 v84, v40, v41
    v_cvt_pk_f16_f32 v81, v34, v35
    v_cvt_pk_f16_f32 v85, v42, v43
    v_cvt_pk_f16_f32 v82, v36, v37
    v_cvt_pk_f16_f32 v86, v44, v45
    v_cvt_pk_f16_f32 v83, v38, v39
    v_cvt_pk_f16_f32 v87, v46, v47
    s_nop 0
    v_mfma_f32_16x16x32_f16 v[16:19], v[80:83], v[120:123], 0
    v_mfma_f32_16x16x32_f16 v[24:27], v[84:87], v[120:123], 0
    v_mfma_f32_16x16x32_f16 v[20:23], v[80:83], v[124:127], 0
    v_mfma_f32_16x16x32_f16 v[28:31], v[84:87], v[124:127], 0
    v_mfma_f32_16x16x32_f16 v[16:19], v[84:87], v[128:131], v[16:19]
    v_mfma_f32_16x16x32_f16 v[24:27], v[80:83], v[136:139], v[24:27]
    v_mfma_f32_16x16x32_f16 v[20:23], v[84:87], v[132:135], v[20:23]
    v_mfma_f32_16x16x32_f16 v[28:31], v[80:83], v[140:143], v[28:31]
    s_nop 4
    v_pk_mul_f32 v[32:33], v[16:17], v[160:161] op_sel_hi:[1,0]
    v_pk_mul_f32 v[40:41], v[16:17], v[160:161] op_sel:[0,1] op_sel_hi:[1,1]
    v_pk_mul_f32 v[34:35], v[18:19], v[160:161] op_sel_hi:[1,0]
    v_pk_mul_f32 v[42:43], v[18:19], v[160:161] op_sel:[0,1] op_sel_hi:[1,1]
    v_pk_mul_f32 v[36:37], v[20:21], v[162:163] op_sel_hi:[1,0]
    v_pk_mul_f32 v[44:45], v[20:21], v[162:163] op_sel:[0,1] op_sel_hi:[1,1]
    v_pk_mul_f32 v[38:39], v[22:23], v[162:163] op_sel_hi:[1,0]
    v_pk_mul_f32 v[46:47], v[22:23], v[162:163] op_sel:[0,1] op_sel_hi:[1,1]
    v_pk_fma_f32 v[32:33], v[24:25], v[160:161], v[32:33] op_sel:[0,1,0] op_sel_hi:[1,1,1] neg_lo:[1,0,0] neg_hi:[1,0,0]
    v_pk_fma_f32 v[40:41], v[24:25], v[160:161], v[40:41] op_sel_hi:[1,0,1]
    v_pk_fma_f32 v[34:35], v[26:27], v[160:161], v[34:35] op_sel:[0,1,0] op_sel_hi:[1,1,1] neg_lo:[1,0,0] neg_hi:[1,0,0]
    v_pk_fma_f32 v[42:43], v[26:27], v[160:161], v[42:43] op_sel_hi:[1,0,1]
    v_pk_fma_f32 v[36:37], v[28:29], v[162:163], v[36:37] op_sel:[0,1,0] op_sel_hi:[1,1,1] neg_lo:[1,0,0] neg_hi:[1,0,0]
    v_pk_fma_f32 v[44:45], v[28:29], v[162:163], v[44:45] op_sel_hi:[1,0,1]
    v_pk_fma_f32 v[38:39], v[30:31], v[162:163], v[38:39] op_sel:[0,1,0] op_sel_hi:[1,1,1] neg_lo:[1,0,0] neg_hi:[1,0,0]
    v_pk_fma_f32 v[46:47], v[30:31], v[162:163], v[46:47] op_sel_hi:[1,0,1]
    v_permlane32_swap_b32 v32, v36
    v_permlane32_swap_b32 v40, v44
    v_permlane32_swap_b32 v33, v37
    v_permlane32_swap_b32 v41, v45
    v_permlane32_swap_b32 v34, v38
    v_permlane32_swap_b32 v42, v46
    v_permlane32_swap_b32 v35, v39
    v_permlane32_swap_b32 v43, v47
    s_cmp_eq_u32 s16, 0
    s_cbranch_scc1 K2_S0B
    v_pk_add_f32 v[48:49], v[32:33], v[36:37]
    v_pk_add_f32 v[52:53], v[40:41], v[44:45]
    v_pk_add_f32 v[56:57], v[44:45], v[40:41] neg_lo:[0,1] neg_hi:[0,1]
    v_pk_add_f32 v[60:61], v[32:33], v[36:37] neg_lo:[0,1] neg_hi:[0,1]
    v_pk_add_f32 v[50:51], v[34:35], v[38:39]
    v_pk_add_f32 v[54:55], v[42:43], v[46:47]
    v_pk_add_f32 v[58:59], v[46:47], v[42:43] neg_lo:[0,1] neg_hi:[0,1]
    v_pk_add_f32 v[62:63], v[34:35], v[38:39] neg_lo:[0,1] neg_hi:[0,1]
    s_branch K2_S0B_DONE
K2_S0B:
    v_mul_f32 v48, 2.0, v32
    v_mul_f32 v52, 2.0, v36
    v_mul_f32 v56, -2.0, v40
    v_mul_f32 v60, -2.0, v44
    v_mul_f32 v49, 2.0, v33
    v_mul_f32 v53, 2.0, v37
    v_mul_f32 v57, -2.0, v41
    v_mul_f32 v61, -2.0, v45
    v_mul_f32 v50, 2.0, v34
    v_mul_f32 v54, 2.0, v38
    v_mul_f32 v58, -2.0, v42
    v_mul_f32 v62, -2.0, v46
    v_mul_f32 v51, 2.0, v35
    v_mul_f32 v55, 2.0, v39
    v_mul_f32 v59, -2.0, v43
    v_mul_f32 v63, -2.0, v47
K2_S0B_DONE:
    v_cvt_pk_f16_f32 v16, v48, v49
    v_cvt_pk_f16_f32 v17, v50, v51
    v_cvt_pk_f16_f32 v18, v56, v57
    v_cvt_pk_f16_f32 v19, v58, v59
    v_cvt_pk_f16_f32 v20, v52, v53
    v_cvt_pk_f16_f32 v21, v54, v55
    v_cvt_pk_f16_f32 v22, v60, v61
    v_cvt_pk_f16_f32 v23, v62, v63
    s_cmp_eq_u32 s49, 0
    s_cbranch_scc1 K2_SPEC
    buffer_store_dwordx4 v[16:19], v11, s[8:11], 0 offen offset:0
    buffer_store_dwordx4 v[20:23], v11, s[8:11], 0 offen offset:16
    s_endpgm
K2_SPEC:
    v_cmp_eq_u32 vcc, 0, v12
    s_cmp_eq_u32 s20, 5
    s_cbranch_scc1 K2_SP10
    buffer_store_dwordx2 v[16:17], v11, s[8:11], 0 offen offset:0
    buffer_store_short_d16_hi v18, v11, s[8:11], 0 offen offset:10
    buffer_store_dword v19, v11, s[8:11], 0 offen offset:12
    buffer_store_dwordx2 v[20:21], v11, s[8:11], 0 offen offset:16
    buffer_store_short_d16_hi v22, v11, s[8:11], 0 offen offset:26
    buffer_store_dword v23, v11, s[8:11], 0 offen offset:28
    s_andn2_b64 exec, exec, vcc
    buffer_store_short v18, v11, s[8:11], 0 offen offset:8
    buffer_store_short v22, v11, s[8:11], 0 offen offset:24
    s_cmp_lg_u32 s2, 0
    s_cbranch_scc1 K2_END
    s_add_u32 s50, s40, s45
    s_sub_u32 s50, s50, 125
    s_lshl_b32 s50, s50, 23
    v_mov_b32 v66, s50
    v_mov_b32 v67, 0x4400
    buffer_store_dword v66, v67, s[8:11], 0 offen
    s_endpgm
K2_SP10:
    s_and_b64 exec, exec, vcc
    buffer_store_short v16, v11, s[8:11], 0 offen offset:8
    buffer_store_short v20, v11, s[8:11], 0 offen offset:24
    s_endpgm
K2_PREP:
    s_load_dwordx2 s[56:57], s[0:1], 32
    s_load_dwordx2 s[58:59], s[0:1], 40
    s_load_dwordx2 s[60:61], s[0:1], 48
    s_cmp_eq_u32 s20, 7
    s_cbranch_scc1 K2_H7
    v_cvt_f32_u32 v11, v1
    v_mul_f32 v11, 0x3d000000, v11
    v_lshlrev_b32 v12, 2, v2
    v_cvt_f32_u32 v12, v12
    v_mul_f32 v13, v12, v11
    v_fract_f32 v144, v13
    v_add_f32 v13, v13, v11
    v_fract_f32 v145, v13
    v_add_f32 v13, v13, v11
    v_fract_f32 v146, v13
    v_add_f32 v13, v13, v11
    v_fract_f32 v147, v13
    v_sin_f32 v148, v144
    v_cos_f32 v144, v144
    v_sin_f32 v149, v145
    v_cos_f32 v145, v145
    v_sin_f32 v150, v146
    v_cos_f32 v146, v146
    v_sin_f32 v151, v147
    v_cos_f32 v147, v147
    v_mul_f32 v144, 0x3e3504f3, v144
    v_mul_f32 v145, 0x3e3504f3, v145
    v_mul_f32 v146, 0x3e3504f3, v146
    v_mul_f32 v147, 0x3e3504f3, v147
    v_mul_f32 v148, 0x3e3504f3, v148
    v_mul_f32 v149, 0x3e3504f3, v149
    v_mul_f32 v150, 0x3e3504f3, v150
    v_mul_f32 v151, 0x3e3504f3, v151
    v_and_b32 v13, 1, v1
    s_mov_b32 s34, 0x80008000
    s_mov_b32 s35, 0x80000000
    v_mul_lo_u32 v13, v13, s34
    v_cvt_pk_f16_f32 v120, v144, v145
    v_cvt_pk_f16_f32 v121, v146, v147
    v_xor_b32 v122, v120, v13
    v_xor_b32 v123, v121, v13
    v_cvt_pk_f16_f32 v136, v148, v149
    v_cvt_pk_f16_f32 v137, v150, v151
    v_xor_b32 v138, v136, v13
    v_xor_b32 v139, v137, v13
    v_xor_b32 v124, s35, v120
    v_xor_b32 v140, s35, v136
    v_xor_b32 v128, s34, v136
    v_xor_b32 v132, s34, v140
    v_xor_b32 v125, s35, v121
    v_xor_b32 v141, s35, v137
    v_xor_b32 v129, s34, v137
    v_xor_b32 v133, s34, v141
    v_xor_b32 v126, s35, v122
    v_xor_b32 v142, s35, v138
    v_xor_b32 v130, s34, v138
    v_xor_b32 v134, s34, v142
    v_xor_b32 v127, s35, v123
    v_xor_b32 v143, s35, v139
    v_xor_b32 v131, s34, v139
    v_xor_b32 v135, s34, v143
    v_mov_b32 v11, s16
    v_mov_b32 v13, s36
    v_cndmask_b32 v11, v11, v13, s[26:27]
    v_cvt_f32_u32 v11, v11
    v_mul_f32 v11, 0xba000000, v11
    v_mov_b32 v13, s37
    v_cndmask_b32 v13, v13, 0, s[26:27]
    v_fma_f32 v13, v12, v11, v13
    v_mov_b32 v144, v13
    v_fmamk_f32 v145, v11, 0x3f800000, v13
    v_fmamk_f32 v146, v11, 0x40000000, v13
    v_fmamk_f32 v147, v11, 0x40400000, v13
    v_fmamk_f32 v148, v11, 0x41800000, v13
    v_fmamk_f32 v149, v11, 0x41880000, v13
    v_fmamk_f32 v150, v11, 0x41900000, v13
    v_fmamk_f32 v151, v11, 0x41980000, v13
    v_sin_f32 v152, v144
    v_cos_f32 v144, v144
    v_sin_f32 v153, v145
    v_cos_f32 v145, v145
    v_sin_f32 v154, v146
    v_cos_f32 v146, v146
    v_sin_f32 v155, v147
    v_cos_f32 v147, v147
    v_sin_f32 v156, v148
    v_cos_f32 v148, v148
    v_sin_f32 v157, v149
    v_cos_f32 v149, v149
    v_sin_f32 v158, v150
    v_cos_f32 v150, v150
    v_sin_f32 v159, v151
    v_cos_f32 v151, v151
    v_cmp_le_u32 s[38:39], 2, v2
    v_mov_b32 v11, s16
    v_mov_b32 v13, s36
    v_cndmask_b32 v11, v11, v13, s[38:39]
    v_cvt_f32_u32 v11, v11
    v_mul_f32 v11, 0x3a000000, v11
    v_cvt_f32_u32 v13, v1
    v_mul_f32 v13, v13, v11
    v_fmamk_f32 v14, v11, 0x41800000, v13
    v_cos_f32 v160, v13
    v_sin_f32 v161, v13
    v_cos_f32 v162, v14
    v_sin_f32 v163, v14
    v_lshlrev_b32 v9, 4, v3
    ds_write_b128 v9, v[120:123] offset:43008
    ds_write_b128 v9, v[124:127] offset:44032
    ds_write_b128 v9, v[128:131] offset:45056
    ds_write_b128 v9, v[132:135] offset:46080
    ds_write_b128 v9, v[136:139] offset:47104
    ds_write_b128 v9, v[140:143] offset:48128
    ds_write_b128 v9, v[144:147] offset:49152
    ds_write_b128 v9, v[148:151] offset:50176
    ds_write_b128 v9, v[152:155] offset:51200
    ds_write_b128 v9, v[156:159] offset:52224
    ds_write_b128 v9, v[160:163] offset:53248
    s_branch K2_H67
K2_H7:
    s_waitcnt vmcnt(18)
    v_max_u32_dpp v164, v164, v164 row_ror:1 row_mask:0xf bank_mask:0xf
    s_nop 1
    v_max_u32_dpp v164, v164, v164 row_ror:2 row_mask:0xf bank_mask:0xf
    s_nop 1
    v_max_u32_dpp v164, v164, v164 row_ror:4 row_mask:0xf bank_mask:0xf
    s_nop 1
    v_max_u32_dpp v164, v164, v164 row_ror:8 row_mask:0xf bank_mask:0xf
    s_nop 0
    v_readlane_b32 s40, v164, 0
    v_readlane_b32 s41, v164, 16
    s_nop 0
    s_max_u32 s40, s40, s41
    v_readlane_b32 s41, v164, 32
    s_nop 0
    s_max_u32 s40, s40, s41
    v_readlane_b32 s41, v164, 48
    s_nop 0
    s_max_u32 s40, s40, s41
    s_lshr_b32 s40, s40, 23
    s_max_u32 s40, s40, 64
    s_min_u32 s40, s40, 189
    s_sub_u32 s41, 253, s40
    s_lshl_b32 s41, s41, 23
    s_lshl_b32 s44, s18, 31
    s_xor_b32 s42, s44, s41
    s_waitcnt vmcnt(16)
    v_lshlrev_b32 v144, 16, v48
    v_and_b32 v145, 0xffff0000, v48
    v_mul_f32 v144, s41, v144
    v_mul_f32 v145, s41, v145
    v_cvt_pk_f16_f32 v48, v144, v145
    v_lshlrev_b32 v146, 16, v52
    v_and_b32 v147, 0xffff0000, v52
    v_mul_f32 v146, s42, v146
    v_mul_f32 v147, s42, v147
    v_cvt_pk_f16_f32 v52, v146, v147
    v_lshlrev_b32 v144, 16, v49
    v_and_b32 v145, 0xffff0000, v49
    v_mul_f32 v144, s41, v144
    v_mul_f32 v145, s41, v145
    v_cvt_pk_f16_f32 v49, v144, v145
    v_lshlrev_b32 v146, 16, v53
    v_and_b32 v147, 0xffff0000, v53
    v_mul_f32 v146, s42, v146
    v_mul_f32 v147, s42, v147
    v_cvt_pk_f16_f32 v53, v146, v147
    v_lshlrev_b32 v144, 16, v50
    v_and_b32 v145, 0xffff0000, v50
    v_mul_f32 v144, s41, v144
    v_mul_f32 v145, s41, v145
    v_cvt_pk_f16_f32 v50, v144, v145
    v_lshlrev_b32 v146, 16, v54
    v_and_b32 v147, 0xffff0000, v54
    v_mul_f32 v146, s42, v146
    v_mul_f32 v147, s42, v147
    v_cvt_pk_f16_f32 v54, v146, v147
    v_lshlrev_b32 v144, 16, v51
    v_and_b32 v145, 0xffff0000, v51
    v_mul_f32 v144, s41, v144
    v_mul_f32 v145, s41, v145
    v_cvt_pk_f16_f32 v51, v144, v145
    v_lshlrev_b32 v146, 16, v55
    v_and_b32 v147, 0xffff0000, v55
    v_mul_f32 v146, s42, v146
    v_mul_f32 v147, s42, v147
    v_cvt_pk_f16_f32 v55, v146, v147
    s_cmp_lg_u32 s16, 0
    s_cbranch_scc1 K2_NOSA2_2
    s_add_u32 s43, s41, 25165824
    v_cmp_gt_u32 vcc, 4, v6
    v_mov_b32 v150, s43
    s_nop 0
    v_cndmask_b32 v150, 0, v150, vcc
    v_xor_b32 v151, s44, v150
    v_lshlrev_b32 v146, 16, v56
    v_and_b32 v147, 0xffff0000, v56
    v_lshlrev_b32 v148, 16, v60
    v_and_b32 v149, 0xffff0000, v60
    v_mul_f32 v146, v150, v146
    v_mul_f32 v147, v150, v147
    v_fmac_f32 v146, v151, v148
    v_fmac_f32 v147, v151, v149
    v_cvt_pk_f16_f32 v56, v146, v147
    v_lshlrev_b32 v146, 16, v57
    v_and_b32 v147, 0xffff0000, v57
    v_lshlrev_b32 v148, 16, v61
    v_and_b32 v149, 0xffff0000, v61
    v_mul_f32 v146, v150, v146
    v_mul_f32 v147, v150, v147
    v_fmac_f32 v146, v151, v148
    v_fmac_f32 v147, v151, v149
    v_cvt_pk_f16_f32 v57, v146, v147
    v_lshlrev_b32 v146, 16, v58
    v_and_b32 v147, 0xffff0000, v58
    v_lshlrev_b32 v148, 16, v62
    v_and_b32 v149, 0xffff0000, v62
    v_mul_f32 v146, v150, v146
    v_mul_f32 v147, v150, v147
    v_fmac_f32 v146, v151, v148
    v_fmac_f32 v147, v151, v149
    v_cvt_pk_f16_f32 v58, v146, v147
    v_lshlrev_b32 v146, 16, v59
    v_and_b32 v147, 0xffff0000, v59
    v_lshlrev_b32 v148, 16, v63
    v_and_b32 v149, 0xffff0000, v63
    v_mul_f32 v146, v150, v146
    v_mul_f32 v147, v150, v147
    v_fmac_f32 v146, v151, v148
    v_fmac_f32 v147, v151, v149
    v_cvt_pk_f16_f32 v59, v146, v147
K2_NOSA2_2:
    s_waitcnt vmcnt(14)
    v_pk_fma_f16 v168, v168, v48, v56
    v_pk_fma_f16 v169, v169, v49, v57
    v_pk_fma_f16 v170, v170, v50, v58
    v_pk_fma_f16 v171, v171, v51, v59
    v_pk_fma_f16 v168, v172, v52, v168
    v_pk_fma_f16 v169, v173, v53, v169
    v_pk_fma_f16 v170, v174, v54, v170
    v_pk_fma_f16 v171, v175, v55, v171
    ds_write_b128 v10, v[168:171] offset:0
    s_waitcnt vmcnt(12)
    v_pk_fma_f16 v176, v176, v48, v56
    v_pk_fma_f16 v177, v177, v49, v57
    v_pk_fma_f16 v178, v178, v50, v58
    v_pk_fma_f16 v179, v179, v51, v59
    v_pk_fma_f16 v176, v180, v52, v176
    v_pk_fma_f16 v177, v181, v53, v177
    v_pk_fma_f16 v178, v182, v54, v178
    v_pk_fma_f16 v179, v183, v55, v179
    ds_write_b128 v10, v[176:179] offset:672
    s_waitcnt vmcnt(10)
    v_pk_fma_f16 v184, v184, v48, v56
    v_pk_fma_f16 v185, v185, v49, v57
    v_pk_fma_f16 v186, v186, v50, v58
    v_pk_fma_f16 v187, v187, v51, v59
    v_pk_fma_f16 v184, v188, v52, v184
    v_pk_fma_f16 v185, v189, v53, v185
    v_pk_fma_f16 v186, v190, v54, v186
    v_pk_fma_f16 v187, v191, v55, v187
    ds_write_b128 v10, v[184:187] offset:1344
    s_waitcnt vmcnt(8)
    v_pk_fma_f16 v192, v192, v48, v56
    v_pk_fma_f16 v193, v193, v49, v57
    v_pk_fma_f16 v194, v194, v50, v58
    v_pk_fma_f16 v195, v195, v51, v59
    v_pk_fma_f16 v192, v196, v52, v192
    v_pk_fma_f16 v193, v197, v53, v193
    v_pk_fma_f16 v194, v198, v54, v194
    v_pk_fma_f16 v195, v199, v55, v195
    ds_write_b128 v10, v[192:195] offset:2016
    s_waitcnt vmcnt(6)
    v_pk_fma_f16 v200, v200, v48, v56
    v_pk_fma_f16 v201, v201, v49, v57
    v_pk_fma_f16 v202, v202, v50, v58
    v_pk_fma_f16 v203, v203, v51, v59
    v_pk_fma_f16 v200, v204, v52, v200
    v_pk_fma_f16 v201, v205, v53, v201
    v_pk_fma_f16 v202, v206, v54, v202
    v_pk_fma_f16 v203, v207, v55, v203
    ds_write_b128 v10, v[200:203] offset:2688
    s_waitcnt vmcnt(4)
    v_pk_fma_f16 v208, v208, v48, v56
    v_pk_fma_f16 v209, v209, v49, v57
    v_pk_fma_f16 v210, v210, v50, v58
    v_pk_fma_f16 v211, v211, v51, v59
    v_pk_fma_f16 v208, v212, v52, v208
    v_pk_fma_f16 v209, v213, v53, v209
    v_pk_fma_f16 v210, v214, v54, v210
    v_pk_fma_f16 v211, v215, v55, v211
    ds_write_b128 v10, v[208:211] offset:3360
    s_waitcnt vmcnt(2)
    v_pk_fma_f16 v216, v216, v48, v56
    v_pk_fma_f16 v217, v217, v49, v57
    v_pk_fma_f16 v218, v218, v50, v58
    v_pk_fma_f16 v219, v219, v51, v59
    v_pk_fma_f16 v216, v220, v52, v216
    v_pk_fma_f16 v217, v221, v53, v217
    v_pk_fma_f16 v218, v222, v54, v218
    v_pk_fma_f16 v219, v223, v55, v219
    ds_write_b128 v10, v[216:219] offset:4032
    s_waitcnt vmcnt(0)
    v_pk_fma_f16 v224, v224, v48, v56
    v_pk_fma_f16 v225, v225, v49, v57
    v_pk_fma_f16 v226, v226, v50, v58
    v_pk_fma_f16 v227, v227, v51, v59
    v_pk_fma_f16 v224, v228, v52, v224
    v_pk_fma_f16 v225, v229, v53, v225
    v_pk_fma_f16 v226, v230, v54, v226
    v_pk_fma_f16 v227, v231, v55, v227
    ds_write_b128 v10, v[224:227] offset:4704
K2_H67:
    s_waitcnt lgkmcnt(0)
    s_and_b32 s9, s9, 0xffff
    s_mov_b32 s10, 0x10000000
    s_mov_b32 s11, 0x00020000
    s_cmp_lt_u32 s2, 240
    s_cbranch_scc1 K2_WP
    s_sub_u32 s35, s2, 16
    s_cmp_eq_u32 s20, 6
    s_cbranch_scc1 K2_WD
    s_endpgm
K2_WP:
    s_mov_b32 s40, s56
    s_mov_b32 s41, s57
    s_mov_b32 s42, s58
    s_mov_b32 s43, s59
    s_lshl_b32 s35, s2, 1
    s_add_u32 s35, s35, s20
    s_sub_u32 s35, s35, 6
    v_lshlrev_b32 v160, 4, v3
    s_barrier
    s_mul_i32 s56, s35, 205
    s_lshr_b32 s56, s56, 12
    s_mul_i32 s57, s56, 20
    s_sub_u32 s57, s35, s57
    v_lshrrev_b32 v4, 2, v1
    v_and_b32 v5, 1, v1
    v_lshl_add_u32 v4, v4, 1, v5
    s_lshl_b32 s22, s57, 2
    v_add_u32 v5, s22, v2
    v_mul_u32_u24 v6, 12288, v5
    v_lshl_add_u32 v6, v4, 4, v6
    s_lshl_b32 s22, s56, 7
    v_add_u32 v6, s22, v6
    v_lshlrev_b32 v5, 4, v5
    v_bfe_u32 v7, v1, 1, 1
    v_cmp_eq_u32 s[26:27], 1, v7
    v_mov_b32 v8, s40
    v_mov_b32 v9, s42
    v_cndmask_b32 v8, v8, v9, s[26:27]
    v_mov_b32 v9, s41
    v_mov_b32 v10, s43
    v_cndmask_b32 v9, v9, v10, s[26:27]
    v_add_co_u32 v8, vcc, v8, v6
    s_nop 1
    v_addc_co_u32 v9, vcc, 0, v9, vcc
    v_add_co_u32 v10, vcc, 0x1800, v8
    s_nop 1
    v_addc_co_u32 v11, vcc, 0, v9, vcc
    v_add_co_u32 v12, vcc, 0xf0000, v8
    s_nop 1
    v_addc_co_u32 v13, vcc, 0, v9, vcc
    v_add_co_u32 v14, vcc, 0xf1800, v8
    s_nop 1
    v_addc_co_u32 v15, vcc, 0, v9, vcc
    s_movk_i32 s22, 7680
    buffer_load_dwordx4 v[24:27], v5, s[8:11], s22 offen offset:0
    buffer_load_dwordx4 v[16:19], v5, s[8:11], s22 offen offset:2560
    buffer_load_dwordx4 v[28:31], v5, s[8:11], s22 offen offset:1280
    buffer_load_dwordx4 v[20:23], v5, s[8:11], s22 offen offset:3840
    global_load_dwordx4 v[32:35], v[8:9], off offset:0
    global_load_dwordx4 v[36:39], v[8:9], off offset:3072
    global_load_dwordx4 v[40:43], v[10:11], off offset:0
    global_load_dwordx4 v[44:47], v[10:11], off offset:3072
    global_load_dwordx4 v[48:51], v[12:13], off offset:0
    global_load_dwordx4 v[52:55], v[12:13], off offset:3072
    global_load_dwordx4 v[56:59], v[14:15], off offset:0
    global_load_dwordx4 v[60:63], v[14:15], off offset:3072
    s_mul_i32 s25, s57, 3
    s_lshl_b32 s22, s56, 3
    s_add_u32 s22, s22, 0
    s_mul_i32 s23, s22, 171
    s_lshr_b32 s23, s23, 9
    s_mul_i32 s23, s23, 57
    s_add_u32 s22, s22, s23
    s_add_u32 s22, s22, s25
    s_lshl_b32 s4, s22, 10
    s_lshl_b32 s22, s56, 3
    s_add_u32 s22, s22, 1
    s_mul_i32 s23, s22, 171
    s_lshr_b32 s23, s23, 9
    s_mul_i32 s23, s23, 57
    s_add_u32 s22, s22, s23
    s_add_u32 s22, s22, s25
    s_lshl_b32 s5, s22, 10
    s_lshl_b32 s22, s56, 3
    s_add_u32 s22, s22, 2
    s_mul_i32 s23, s22, 171
    s_lshr_b32 s23, s23, 9
    s_mul_i32 s23, s23, 57
    s_add_u32 s22, s22, s23
    s_add_u32 s22, s22, s25
    s_lshl_b32 s6, s22, 10
    s_lshl_b32 s22, s56, 3
    s_add_u32 s22, s22, 3
    s_mul_i32 s23, s22, 171
    s_lshr_b32 s23, s23, 9
    s_mul_i32 s23, s23, 57
    s_add_u32 s22, s22, s23
    s_add_u32 s22, s22, s25
    s_lshl_b32 s7, s22, 10
    s_lshl_b32 s22, s56, 3
    s_add_u32 s22, s22, 4
    s_mul_i32 s23, s22, 171
    s_lshr_b32 s23, s23, 9
    s_mul_i32 s23, s23, 57
    s_add_u32 s22, s22, s23
    s_add_u32 s22, s22, s25
    s_lshl_b32 s12, s22, 10
    s_lshl_b32 s22, s56, 3
    s_add_u32 s22, s22, 5
    s_mul_i32 s23, s22, 171
    s_lshr_b32 s23, s23, 9
    s_mul_i32 s23, s23, 57
    s_add_u32 s22, s22, s23
    s_add_u32 s22, s22, s25
    s_lshl_b32 s13, s22, 10
    s_lshl_b32 s22, s56, 3
    s_add_u32 s22, s22, 6
    s_mul_i32 s23, s22, 171
    s_lshr_b32 s23, s23, 9
    s_mul_i32 s23, s23, 57
    s_add_u32 s22, s22, s23
    s_add_u32 s22, s22, s25
    s_lshl_b32 s14, s22, 10
    s_lshl_b32 s22, s56, 3
    s_add_u32 s22, s22, 7
    s_mul_i32 s23, s22, 171
    s_lshr_b32 s23, s23, 9
    s_mul_i32 s23, s23, 57
    s_add_u32 s22, s22, s23
    s_add_u32 s22, s22, s25
    s_lshl_b32 s15, s22, 10
    s_waitcnt vmcnt(0)
    s_setprio 2
    s_mov_b32 s24, 0x3f803f80
    v_lshlrev_b32 v96, 16, v32
    v_and_b32 v97, 0xffff0000, v32
    v_pk_mul_f32 v[120:121], v[96:97], v[24:25] op_sel:[0,0] op_sel_hi:[1,0]
    v_pk_mul_f32 v[96:97], v[96:97], v[16:17] op_sel:[0,0] op_sel_hi:[1,0]
    v_lshlrev_b32 v98, 16, v33
    v_and_b32 v99, 0xffff0000, v33
    v_pk_mul_f32 v[122:123], v[98:99], v[24:25] op_sel:[0,0] op_sel_hi:[1,0]
    v_pk_mul_f32 v[98:99], v[98:99], v[16:17] op_sel:[0,0] op_sel_hi:[1,0]
    v_lshlrev_b32 v100, 16, v34
    v_and_b32 v101, 0xffff0000, v34
    v_pk_mul_f32 v[124:125], v[100:101], v[24:25] op_sel:[0,0] op_sel_hi:[1,0]
    v_pk_mul_f32 v[100:101], v[100:101], v[16:17] op_sel:[0,0] op_sel_hi:[1,0]
    v_lshlrev_b32 v102, 16, v35
    v_and_b32 v103, 0xffff0000, v35
    v_pk_mul_f32 v[126:127], v[102:103], v[24:25] op_sel:[0,0] op_sel_hi:[1,0]
    v_pk_mul_f32 v[102:103], v[102:103], v[16:17] op_sel:[0,0] op_sel_hi:[1,0]
    v_lshlrev_b32 v104, 16, v36
    v_and_b32 v105, 0xffff0000, v36
    v_pk_fma_f32 v[120:121], v[104:105], v[24:25], v[120:121] op_sel:[0,1,0] op_sel_hi:[1,1,1]
    v_pk_mul_f32 v[104:105], v[104:105], v[16:17] op_sel:[0,1] op_sel_hi:[1,1]
    v_lshlrev_b32 v106, 16, v37
    v_and_b32 v107, 0xffff0000, v37
    v_pk_fma_f32 v[122:123], v[106:107], v[24:25], v[122:123] op_sel:[0,1,0] op_sel_hi:[1,1,1]
    v_pk_mul_f32 v[106:107], v[106:107], v[16:17] op_sel:[0,1] op_sel_hi:[1,1]
    v_lshlrev_b32 v108, 16, v38
    v_and_b32 v109, 0xffff0000, v38
    v_pk_fma_f32 v[124:125], v[108:109], v[24:25], v[124:125] op_sel:[0,1,0] op_sel_hi:[1,1,1]
    v_pk_mul_f32 v[108:109], v[108:109], v[16:17] op_sel:[0,1] op_sel_hi:[1,1]
    v_lshlrev_b32 v110, 16, v39
    v_and_b32 v111, 0xffff0000, v39
    v_pk_fma_f32 v[126:127], v[110:111], v[24:25], v[126:127] op_sel:[0,1,0] op_sel_hi:[1,1,1]
    v_pk_mul_f32 v[110:111], v[110:111], v[16:17] op_sel:[0,1] op_sel_hi:[1,1]
    v_cvt_pk_bf16_f32 v64, v96, v104
    v_cvt_pk_bf16_f32 v68, v97, v105
    v_cvt_pk_bf16_f32 v72, v98, v106
    v_cvt_pk_bf16_f32 v76, v99, v107
    v_cvt_pk_bf16_f32 v80, v100, v108
    v_cvt_pk_bf16_f32 v84, v101, v109
    v_cvt_pk_bf16_f32 v88, v102, v110
    v_cvt_pk_bf16_f32 v92, v103, v111
    v_dot2_f32_bf16 v112, v64, s24, 0
    v_dot2_f32_bf16 v113, v68, s24, 0
    v_dot2_f32_bf16 v114, v72, s24, 0
    v_dot2_f32_bf16 v115, v76, s24, 0
    v_dot2_f32_bf16 v116, v80, s24, 0
    v_dot2_f32_bf16 v117, v84, s24, 0
    v_dot2_f32_bf16 v118, v88, s24, 0
    v_dot2_f32_bf16 v119, v92, s24, 0
    v_lshlrev_b32 v96, 16, v40
    v_and_b32 v97, 0xffff0000, v40
    v_pk_fma_f32 v[120:121], v[96:97], v[26:27], v[120:121] op_sel:[0,0,0] op_sel_hi:[1,0,1]
    v_pk_mul_f32 v[96:97], v[96:97], v[18:19] op_sel:[0,0] op_sel_hi:[1,0]
    v_lshlrev_b32 v98, 16, v41
    v_and_b32 v99, 0xffff0000, v41
    v_pk_fma_f32 v[122:123], v[98:99], v[26:27], v[122:123] op_sel:[0,0,0] op_sel_hi:[1,0,1]
    v_pk_mul_f32 v[98:99], v[98:99], v[18:19] op_sel:[0,0] op_sel_hi:[1,0]
    v_lshlrev_b32 v100, 16, v42
    v_and_b32 v101, 0xffff0000, v42
    v_pk_fma_f32 v[124:125], v[100:101], v[26:27], v[124:125] op_sel:[0,0,0] op_sel_hi:[1,0,1]
    v_pk_mul_f32 v[100:101], v[100:101], v[18:19] op_sel:[0,0] op_sel_hi:[1,0]
    v_lshlrev_b32 v102, 16, v43
    v_and_b32 v103, 0xffff0000, v43
    v_pk_fma_f32 v[126:127], v[102:103], v[26:27], v[126:127] op_sel:[0,0,0] op_sel_hi:[1,0,1]
    v_pk_mul_f32 v[102:103], v[102:103], v[18:19] op_sel:[0,0] op_sel_hi:[1,0]
    v_lshlrev_b32 v104, 16, v44
    v_and_b32 v105, 0xffff0000, v44
    v_pk_fma_f32 v[120:121], v[104:105], v[26:27], v[120:121] op_sel:[0,1,0] op_sel_hi:[1,1,1]
    v_pk_mul_f32 v[104:105], v[104:105], v[18:19] op_sel:[0,1] op_sel_hi:[1,1]
    v_lshlrev_b32 v106, 16, v45
    v_and_b32 v107, 0xffff0000, v45
    v_pk_fma_f32 v[122:123], v[106:107], v[26:27], v[122:123] op_sel:[0,1,0] op_sel_hi:[1,1,1]
    v_pk_mul_f32 v[106:107], v[106:107], v[18:19] op_sel:[0,1] op_sel_hi:[1,1]
    v_lshlrev_b32 v108, 16, v46
    v_and_b32 v109, 0xffff0000, v46
    v_pk_fma_f32 v[124:125], v[108:109], v[26:27], v[124:125] op_sel:[0,1,0] op_sel_hi:[1,1,1]
    v_pk_mul_f32 v[108:109], v[108:109], v[18:19] op_sel:[0,1] op_sel_hi:[1,1]
    v_lshlrev_b32 v110, 16, v47
    v_and_b32 v111, 0xffff0000, v47
    v_pk_fma_f32 v[126:127], v[110:111], v[26:27], v[126:127] op_sel:[0,1,0] op_sel_hi:[1,1,1]
    v_pk_mul_f32 v[110:111], v[110:111], v[18:19] op_sel:[0,1] op_sel_hi:[1,1]
    v_cvt_pk_bf16_f32 v65, v96, v104
    v_cvt_pk_bf16_f32 v69, v97, v105
    v_cvt_pk_bf16_f32 v73, v98, v106
    v_cvt_pk_bf16_f32 v77, v99, v107
    v_cvt_pk_bf16_f32 v81, v100, v108
    v_cvt_pk_bf16_f32 v85, v101, v109
    v_cvt_pk_bf16_f32 v89, v102, v110
    v_cvt_pk_bf16_f32 v93, v103, v111
    v_dot2_f32_bf16 v112, v65, s24, v112
    v_dot2_f32_bf16 v113, v69, s24, v113
    v_dot2_f32_bf16 v114, v73, s24, v114
    v_dot2_f32_bf16 v115, v77, s24, v115
    v_dot2_f32_bf16 v116, v81, s24, v116
    v_dot2_f32_bf16 v117, v85, s24, v117
    v_dot2_f32_bf16 v118, v89, s24, v118
    v_dot2_f32_bf16 v119, v93, s24, v119
    v_lshlrev_b32 v96, 16, v48
    v_and_b32 v97, 0xffff0000, v48
    v_pk_fma_f32 v[120:121], v[96:97], v[28:29], v[120:121] op_sel:[0,0,0] op_sel_hi:[1,0,1]
    v_pk_mul_f32 v[96:97], v[96:97], v[20:21] op_sel:[0,0] op_sel_hi:[1,0]
    v_lshlrev_b32 v98, 16, v49
    v_and_b32 v99, 0xffff0000, v49
    v_pk_fma_f32 v[122:123], v[98:99], v[28:29], v[122:123] op_sel:[0,0,0] op_sel_hi:[1,0,1]
    v_pk_mul_f32 v[98:99], v[98:99], v[20:21] op_sel:[0,0] op_sel_hi:[1,0]
    v_lshlrev_b32 v100, 16, v50
    v_and_b32 v101, 0xffff0000, v50
    v_pk_fma_f32 v[124:125], v[100:101], v[28:29], v[124:125] op_sel:[0,0,0] op_sel_hi:[1,0,1]
    v_pk_mul_f32 v[100:101], v[100:101], v[20:21] op_sel:[0,0] op_sel_hi:[1,0]
    v_lshlrev_b32 v102, 16, v51
    v_and_b32 v103, 0xffff0000, v51
    v_pk_fma_f32 v[126:127], v[102:103], v[28:29], v[126:127] op_sel:[0,0,0] op_sel_hi:[1,0,1]
    v_pk_mul_f32 v[102:103], v[102:103], v[20:21] op_sel:[0,0] op_sel_hi:[1,0]
    v_lshlrev_b32 v104, 16, v52
    v_and_b32 v105, 0xffff0000, v52
    v_pk_fma_f32 v[120:121], v[104:105], v[28:29], v[120:121] op_sel:[0,1,0] op_sel_hi:[1,1,1]
    v_pk_mul_f32 v[104:105], v[104:105], v[20:21] op_sel:[0,1] op_sel_hi:[1,1]
    v_lshlrev_b32 v106, 16, v53
    v_and_b32 v107, 0xffff0000, v53
    v_pk_fma_f32 v[122:123], v[106:107], v[28:29], v[122:123] op_sel:[0,1,0] op_sel_hi:[1,1,1]
    v_pk_mul_f32 v[106:107], v[106:107], v[20:21] op_sel:[0,1] op_sel_hi:[1,1]
    v_lshlrev_b32 v108, 16, v54
    v_and_b32 v109, 0xffff0000, v54
    v_pk_fma_f32 v[124:125], v[108:109], v[28:29], v[124:125] op_sel:[0,1,0] op_sel_hi:[1,1,1]
    v_pk_mul_f32 v[108:109], v[108:109], v[20:21] op_sel:[0,1] op_sel_hi:[1,1]
    v_lshlrev_b32 v110, 16, v55
    v_and_b32 v111, 0xffff0000, v55
    v_pk_fma_f32 v[126:127], v[110:111], v[28:29], v[126:127] op_sel:[0,1,0] op_sel_hi:[1,1,1]
    v_pk_mul_f32 v[110:111], v[110:111], v[20:21] op_sel:[0,1] op_sel_hi:[1,1]
    v_cvt_pk_bf16_f32 v66, v96, v104
    v_cvt_pk_bf16_f32 v70, v97, v105
    v_cvt_pk_bf16_f32 v74, v98, v106
    v_cvt_pk_bf16_f32 v78, v99, v107
    v_cvt_pk_bf16_f32 v82, v100, v108
    v_cvt_pk_bf16_f32 v86, v101, v109
    v_cvt_pk_bf16_f32 v90, v102, v110
    v_cvt_pk_bf16_f32 v94, v103, v111
    v_dot2_f32_bf16 v112, v66, s24, v112
    v_dot2_f32_bf16 v113, v70, s24, v113
    v_dot2_f32_bf16 v114, v74, s24, v114
    v_dot2_f32_bf16 v115, v78, s24, v115
    v_dot2_f32_bf16 v116, v82, s24, v116
    v_dot2_f32_bf16 v117, v86, s24, v117
    v_dot2_f32_bf16 v118, v90, s24, v118
    v_dot2_f32_bf16 v119, v94, s24, v119
    v_lshlrev_b32 v96, 16, v56
    v_and_b32 v97, 0xffff0000, v56
    v_pk_fma_f32 v[120:121], v[96:97], v[30:31], v[120:121] op_sel:[0,0,0] op_sel_hi:[1,0,1]
    v_pk_mul_f32 v[96:97], v[96:97], v[22:23] op_sel:[0,0] op_sel_hi:[1,0]
    v_lshlrev_b32 v98, 16, v57
    v_and_b32 v99, 0xffff0000, v57
    v_pk_fma_f32 v[122:123], v[98:99], v[30:31], v[122:123] op_sel:[0,0,0] op_sel_hi:[1,0,1]
    v_pk_mul_f32 v[98:99], v[98:99], v[22:23] op_sel:[0,0] op_sel_hi:[1,0]
    v_lshlrev_b32 v100, 16, v58
    v_and_b32 v101, 0xffff0000, v58
    v_pk_fma_f32 v[124:125], v[100:101], v[30:31], v[124:125] op_sel:[0,0,0] op_sel_hi:[1,0,1]
    v_pk_mul_f32 v[100:101], v[100:101], v[22:23] op_sel:[0,0] op_sel_hi:[1,0]
    v_lshlrev_b32 v102, 16, v59
    v_and_b32 v103, 0xffff0000, v59
    v_pk_fma_f32 v[126:127], v[102:103], v[30:31], v[126:127] op_sel:[0,0,0] op_sel_hi:[1,0,1]
    v_pk_mul_f32 v[102:103], v[102:103], v[22:23] op_sel:[0,0] op_sel_hi:[1,0]
    v_lshlrev_b32 v104, 16, v60
    v_and_b32 v105, 0xffff0000, v60
    v_pk_fma_f32 v[120:121], v[104:105], v[30:31], v[120:121] op_sel:[0,1,0] op_sel_hi:[1,1,1]
    v_pk_mul_f32 v[104:105], v[104:105], v[22:23] op_sel:[0,1] op_sel_hi:[1,1]
    v_lshlrev_b32 v106, 16, v61
    v_and_b32 v107, 0xffff0000, v61
    v_pk_fma_f32 v[122:123], v[106:107], v[30:31], v[122:123] op_sel:[0,1,0] op_sel_hi:[1,1,1]
    v_pk_mul_f32 v[106:107], v[106:107], v[22:23] op_sel:[0,1] op_sel_hi:[1,1]
    v_lshlrev_b32 v108, 16, v62
    v_and_b32 v109, 0xffff0000, v62
    v_pk_fma_f32 v[124:125], v[108:109], v[30:31], v[124:125] op_sel:[0,1,0] op_sel_hi:[1,1,1]
    v_pk_mul_f32 v[108:109], v[108:109], v[22:23] op_sel:[0,1] op_sel_hi:[1,1]
    v_lshlrev_b32 v110, 16, v63
    v_and_b32 v111, 0xffff0000, v63
    v_pk_fma_f32 v[126:127], v[110:111], v[30:31], v[126:127] op_sel:[0,1,0] op_sel_hi:[1,1,1]
    v_pk_mul_f32 v[110:111], v[110:111], v[22:23] op_sel:[0,1] op_sel_hi:[1,1]
    v_cvt_pk_bf16_f32 v67, v96, v104
    v_cvt_pk_bf16_f32 v71, v97, v105
    v_cvt_pk_bf16_f32 v75, v98, v106
    v_cvt_pk_bf16_f32 v79, v99, v107
    v_cvt_pk_bf16_f32 v83, v100, v108
    v_cvt_pk_bf16_f32 v87, v101, v109
    v_cvt_pk_bf16_f32 v91, v102, v110
    v_cvt_pk_bf16_f32 v95, v103, v111
    v_dot2_f32_bf16 v112, v67, s24, v112
    v_dot2_f32_bf16 v113, v71, s24, v113
    v_dot2_f32_bf16 v114, v75, s24, v114
    v_dot2_f32_bf16 v115, v79, s24, v115
    v_dot2_f32_bf16 v116, v83, s24, v116
    v_dot2_f32_bf16 v117, v87, s24, v117
    v_dot2_f32_bf16 v118, v91, s24, v118
    v_dot2_f32_bf16 v119, v95, s24, v119
    v_add_u32 v6, 0xb00000, v160
    buffer_store_dwordx4 v[64:67], v6, s[8:11], s4 offen sc1
    buffer_store_dwordx4 v[68:71], v6, s[8:11], s5 offen sc1
    buffer_store_dwordx4 v[72:75], v6, s[8:11], s6 offen sc1
    buffer_store_dwordx4 v[76:79], v6, s[8:11], s7 offen sc1
    buffer_store_dwordx4 v[80:83], v6, s[8:11], s12 offen sc1
    buffer_store_dwordx4 v[84:87], v6, s[8:11], s13 offen sc1
    buffer_store_dwordx4 v[88:91], v6, s[8:11], s14 offen sc1
    buffer_store_dwordx4 v[92:95], v6, s[8:11], s15 offen sc1
    v_permlane32_swap_b32 v112, v116
    v_permlane32_swap_b32 v113, v117
    v_permlane32_swap_b32 v114, v118
    v_permlane32_swap_b32 v115, v119
    v_permlane32_swap_b32 v120, v124
    v_permlane32_swap_b32 v121, v125
    v_permlane32_swap_b32 v122, v126
    v_permlane32_swap_b32 v123, v127
    v_add_f32 v112, v112, v116
    v_add_f32 v113, v113, v117
    v_add_f32 v114, v114, v118
    v_add_f32 v115, v115, v119
    v_add_f32 v120, v120, v124
    v_add_f32 v121, v121, v125
    v_add_f32 v122, v122, v126
    v_add_f32 v123, v123, v127
    v_permlane16_swap_b32 v112, v114
    v_permlane16_swap_b32 v113, v115
    v_permlane16_swap_b32 v120, v122
    v_permlane16_swap_b32 v121, v123
    v_add_f32 v8, v112, v114
    v_add_f32 v9, v120, v122
    v_add_f32 v10, v113, v115
    v_add_f32 v11, v121, v123
    s_mul_i32 s22, s56, 20
    s_add_u32 s22, s22, s57
    s_lshl_b32 s22, s22, 10
    s_add_u32 s22, s22, 0xf00000
    buffer_store_dwordx4 v[8:11], v160, s[8:11], s22 offen sc1
    s_endpgm
K2_WD:
    s_load_dwordx2 s[44:45], s[0:1], 48
    s_waitcnt lgkmcnt(0)
    s_and_b32 s9, s9, 0xffff
    s_mov_b32 s10, 0x10000000
    s_mov_b32 s11, 0x00020000
    s_and_b32 s45, s45, 0xffff
    s_mov_b32 s46, 0x1e0000
    s_mov_b32 s47, 0x00020000
    s_barrier
    s_mul_i32 s22, s35, 205
    s_lshr_b32 s22, s22, 10
    s_mul_i32 s23, s22, 5
    s_sub_u32 s23, s35, s23
    s_lshl_b32 s23, s23, 4
    v_add_u32 v13, s23, v1
    s_lshl_b32 s22, s22, 2
    v_add_u32 v14, s22, v2
    v_lshrrev_b32 v4, 3, v14
    v_lshlrev_b32 v4, 6, v4
    v_and_b32 v5, 7, v14
    v_add_u32 v4, v4, v5
    v_mul_u32_u24 v4, 1280, v4
    v_lshl_add_u32 v4, v13, 4, v4
    s_mov_b32 s22, 0
    buffer_load_dwordx4 v[20:23], v4, s[44:47], s22 offen
    s_mov_b32 s22, 10240
    buffer_load_dwordx4 v[24:27], v4, s[44:47], s22 offen
    s_mov_b32 s22, 20480
    buffer_load_dwordx4 v[28:31], v4, s[44:47], s22 offen
    s_mov_b32 s22, 30720
    buffer_load_dwordx4 v[32:35], v4, s[44:47], s22 offen
    s_mov_b32 s22, 40960
    buffer_load_dwordx4 v[36:39], v4, s[44:47], s22 offen
    s_mov_b32 s22, 51200
    buffer_load_dwordx4 v[40:43], v4, s[44:47], s22 offen
    s_mov_b32 s22, 61440
    buffer_load_dwordx4 v[44:47], v4, s[44:47], s22 offen
    s_mov_b32 s22, 71680
    buffer_load_dwordx4 v[48:51], v4, s[44:47], s22 offen
    v_mul_u32_u24 v4, 171, v14
    v_lshrrev_b32 v4, 11, v4
    v_mul_u32_u24 v5, 12, v4
    v_sub_u32 v5, v14, v5
    v_mul_u32_u24 v6, 11, v5
    v_lshrrev_b32 v6, 5, v6
    v_mul_u32_u24 v7, 3, v6
    v_sub_u32 v7, v5, v7
    v_mad_u32_u24 v7, v4, 3, v7
    v_mul_u32_u24 v7, 5120, v7
    v_lshl_add_u32 v7, v6, 8, v7
    v_add_u32 v7, 0x1000000, v7
    v_lshlrev_b32 v8, 1, v13
    v_mul_u32_u24 v9, 205, v8
    v_lshrrev_b32 v9, 12, v9
    v_mul_u32_u24 v10, 20, v9
    v_sub_u32 v10, v8, v10
    v_mul_u32_u24 v11, 13, v10
    v_lshrrev_b32 v11, 6, v11
    v_mul_u32_u24 v12, 5, v11
    v_sub_u32 v12, v10, v12
    v_mul_u32_u24 v9, 245760, v9
    v_lshl_add_u32 v9, v12, 10, v9
    v_lshl_add_u32 v9, v11, 6, v9
    v_add_u32 v16, v9, v7
    v_lshlrev_b32 v8, 1, v13
    v_add_u32 v8, 1, v8
    v_mul_u32_u24 v9, 205, v8
    v_lshrrev_b32 v9, 12, v9
    v_mul_u32_u24 v10, 20, v9
    v_sub_u32 v10, v8, v10
    v_mul_u32_u24 v11, 13, v10
    v_lshrrev_b32 v11, 6, v11
    v_mul_u32_u24 v12, 5, v11
    v_sub_u32 v12, v10, v12
    v_mul_u32_u24 v9, 245760, v9
    v_lshl_add_u32 v9, v12, 10, v9
    v_lshl_add_u32 v9, v11, 6, v9
    v_add_u32 v17, v9, v7
    s_waitcnt vmcnt(0)
    s_mov_b32 s22, 0x05040100
    s_mov_b32 s23, 0x07060302
    v_perm_b32 v64, v24, v20, s22
    v_perm_b32 v65, v32, v28, s22
    v_perm_b32 v66, v40, v36, s22
    v_perm_b32 v67, v48, v44, s22
    buffer_store_dwordx4 v[64:67], v16, s[8:11], 0 offen offset:0
    v_perm_b32 v68, v24, v20, s23
    v_perm_b32 v69, v32, v28, s23
    v_perm_b32 v70, v40, v36, s23
    v_perm_b32 v71, v48, v44, s23
    buffer_store_dwordx4 v[68:71], v16, s[8:11], 0 offen offset:16
    v_perm_b32 v72, v25, v21, s22
    v_perm_b32 v73, v33, v29, s22
    v_perm_b32 v74, v41, v37, s22
    v_perm_b32 v75, v49, v45, s22
    buffer_store_dwordx4 v[72:75], v16, s[8:11], 0 offen offset:32
    v_perm_b32 v76, v25, v21, s23
    v_perm_b32 v77, v33, v29, s23
    v_perm_b32 v78, v41, v37, s23
    v_perm_b32 v79, v49, v45, s23
    buffer_store_dwordx4 v[76:79], v16, s[8:11], 0 offen offset:48
    v_perm_b32 v80, v26, v22, s22
    v_perm_b32 v81, v34, v30, s22
    v_perm_b32 v82, v42, v38, s22
    v_perm_b32 v83, v50, v46, s22
    buffer_store_dwordx4 v[80:83], v17, s[8:11], 0 offen offset:0
    v_perm_b32 v84, v26, v22, s23
    v_perm_b32 v85, v34, v30, s23
    v_perm_b32 v86, v42, v38, s23
    v_perm_b32 v87, v50, v46, s23
    buffer_store_dwordx4 v[84:87], v17, s[8:11], 0 offen offset:16
    v_perm_b32 v88, v27, v23, s22
    v_perm_b32 v89, v35, v31, s22
    v_perm_b32 v90, v43, v39, s22
    v_perm_b32 v91, v51, v47, s22
    buffer_store_dwordx4 v[88:91], v17, s[8:11], 0 offen offset:32
    v_perm_b32 v92, v27, v23, s23
    v_perm_b32 v93, v35, v31, s23
    v_perm_b32 v94, v43, v39, s23
    v_perm_b32 v95, v51, v47, s23
    buffer_store_dwordx4 v[92:95], v17, s[8:11], 0 offen offset:48
K2_END:
    s_endpgm
.text
.globl kf_kernel
.p2align 8
.type kf_kernel,@function
kf_kernel:
    s_load_dwordx2 s[8:9], s[0:1], 88
    s_load_dwordx2 s[4:5], s[0:1], 0
    s_load_dwordx2 s[12:13], s[0:1], 72
    s_cmp_ge_u32 s2, 256
    s_cbranch_scc1 KF_END
    v_lshrrev_b32 v3, 6, v0
    s_and_b32 s50, s2, 7
    s_lshr_b32 s51, s2, 3
    v_readfirstlane_b32 s20, v3
    s_and_b32 s22, s50, 3
    s_lshl_b32 s22, s22, 2
    s_and_b32 s23, s51, 3
    s_add_u32 s52, s22, s23
    s_lshr_b32 s22, s50, 2
    s_lshl_b32 s22, s22, 3
    s_lshr_b32 s23, s51, 2
    s_add_u32 s53, s22, s23
    s_and_b32 s55, s51, 7
    s_lshl_b32 s22, s50, 2
    s_lshr_b32 s23, s51, 3
    s_add_u32 s54, s22, s23
    s_and_b32 s16, s2, 31
    s_lshr_b32 s17, s2, 5
    v_and_b32 v1, 15, v0
    v_bfe_u32 v2, v0, 4, 2
    v_and_b32 v3, 63, v0
    v_lshlrev_b32 v255, 4, v3
    s_lshl_b32 s22, s53, 2
    s_add_u32 s22, s22, s20
    s_mul_i32 s22, s22, 61440
    s_add_u32 s22, s22, 0xb00000
    v_add_u32 v254, s22, v255
    s_mul_i32 s18, s17, 3
    s_lshl_b32 s22, s17, 1
    s_add_u32 s22, s22, 4
    s_cmp_lt_u32 s17, 4
    s_cselect_b32 s31, s18, s22
    s_cselect_b32 s30, 3, 2
    s_add_u32 s18, s31, s20
    s_lshl_b32 s19, s18, 4
    s_mul_i32 s21, s16, 81920
    s_lshr_b32 s22, s16, 1
    s_mul_i32 s22, s22, 4352
    s_and_b32 s23, s16, 1
    s_lshl_b32 s23, s23, 3
    s_add_u32 s23, s23, s17
    s_lshl_b32 s23, s23, 2
    s_add_u32 s22, s22, s23
    s_add_u32 s34, s22, 0x40000
    s_cmp_lt_u32 s20, s30
    s_cbranch_scc1 KF_P3
    v_lshrrev_b32 v4, 3, v3
    v_bfe_u32 v5, v4, 1, 1
    v_and_b32 v6, 7, v3
    v_xor_b32 v5, v5, v6
    v_xor_b32 v7, v6, v4
    v_mul_u32_u24 v8, 2560, v4
    s_add_u32 s22, s21, 0x400000
    v_add_u32 v8, s22, v8
    v_xor_b32 v6, 6, v5
    v_lshl_add_u32 v6, v6, 4, v8
    v_add_u32 v6, 19456, v6
    v_lshl_add_u32 v5, v5, 4, v8
    s_mul_i32 s22, s16, 1280
    s_lshl_b32 s23, s31, 5
    s_add_u32 s22, s22, s23
    v_mul_u32_u24 v4, 40960, v4
    v_lshl_add_u32 v4, v7, 4, v4
    v_add_u32 v4, s22, v4
    s_waitcnt lgkmcnt(0)
    s_and_b32 s5, s5, 0xffff
    s_mov_b32 s6, 0x280000
    s_mov_b32 s7, 0x00020000
    s_and_b32 s9, s9, 0xffff
    s_mov_b32 s10, 0x10000000
    s_mov_b32 s11, 0x00020000
    s_and_b32 s13, s13, 0xffff
    s_mov_b32 s14, 0x280000
    s_mov_b32 s15, 0x00020000
    s_cmp_eq_u32 s20, 3
    s_cbranch_scc1 KF_DMA
    s_branch KF_NODMA
KF_DMA:
    s_movk_i32 m0, 0
    s_mov_b32 s22, 0
    buffer_load_dwordx4 v5, s[8:11], s22 offen lds
    buffer_load_dwordx4 v6, s[8:11], s22 offen offset:1024 lds
    s_movk_i32 m0, 2048
    s_mov_b32 s22, 40960
    buffer_load_dwordx4 v5, s[8:11], s22 offen lds
    buffer_load_dwordx4 v6, s[8:11], s22 offen offset:1024 lds
    s_movk_i32 m0, 4096
    s_mov_b32 s22, 128
    buffer_load_dwordx4 v5, s[8:11], s22 offen lds
    buffer_load_dwordx4 v6, s[8:11], s22 offen offset:1024 lds
    s_movk_i32 m0, 6144
    s_mov_b32 s22, 41088
    buffer_load_dwordx4 v5, s[8:11], s22 offen lds
    buffer_load_dwordx4 v6, s[8:11], s22 offen offset:1024 lds
    s_movk_i32 m0, 8192
    s_mov_b32 s22, 256
    buffer_load_dwordx4 v5, s[8:11], s22 offen lds
    buffer_load_dwordx4 v6, s[8:11], s22 offen offset:1024 lds
    s_movk_i32 m0, 10240
    s_mov_b32 s22, 41216
    buffer_load_dwordx4 v5, s[8:11], s22 offen lds
    buffer_load_dwordx4 v6, s[8:11], s22 offen offset:1024 lds
    s_movk_i32 m0, 12288
    s_mov_b32 s22, 384
    buffer_load_dwordx4 v5, s[8:11], s22 offen lds
    buffer_load_dwordx4 v6, s[8:11], s22 offen offset:1024 lds
    s_movk_i32 m0, 14336
    s_mov_b32 s22, 41344
    buffer_load_dwordx4 v5, s[8:11], s22 offen lds
    buffer_load_dwordx4 v6, s[8:11], s22 offen offset:1024 lds
    s_movk_i32 m0, 16384
    s_mov_b32 s22, 512
    buffer_load_dwordx4 v5, s[8:11], s22 offen lds
    buffer_load_dwordx4 v6, s[8:11], s22 offen offset:1024 lds
    s_movk_i32 m0, 18432
    s_mov_b32 s22, 41472
    buffer_load_dwordx4 v5, s[8:11], s22 offen lds
    buffer_load_dwordx4 v6, s[8:11], s22 offen offset:1024 lds
    s_movk_i32 m0, 20480
    s_mov_b32 s22, 640
    buffer_load_dwordx4 v5, s[8:11], s22 offen lds
    buffer_load_dwordx4 v6, s[8:11], s22 offen offset:1024 lds
    s_movk_i32 m0, 22528
    s_mov_b32 s22, 41600
    buffer_load_dwordx4 v5, s[8:11], s22 offen lds
    buffer_load_dwordx4 v6, s[8:11], s22 offen offset:1024 lds
    s_movk_i32 m0, 24576
    s_mov_b32 s22, 768
    buffer_load_dwordx4 v5, s[8:11], s22 offen lds
    buffer_load_dwordx4 v6, s[8:11], s22 offen offset:1024 lds
    s_movk_i32 m0, 26624
    s_mov_b32 s22, 41728
    buffer_load_dwordx4 v5, s[8:11], s22 offen lds
    buffer_load_dwordx4 v6, s[8:11], s22 offen offset:1024 lds
    s_movk_i32 m0, 28672
    s_mov_b32 s22, 896
    buffer_load_dwordx4 v5, s[8:11], s22 offen lds
    buffer_load_dwordx4 v6, s[8:11], s22 offen offset:1024 lds
    s_movk_i32 m0, 30720
    s_mov_b32 s22, 41856
    buffer_load_dwordx4 v5, s[8:11], s22 offen lds
    buffer_load_dwordx4 v6, s[8:11], s22 offen offset:1024 lds
    s_mov_b32 m0, 32768
    s_mov_b32 s22, 1024
    buffer_load_dwordx4 v5, s[8:11], s22 offen lds
    buffer_load_dwordx4 v6, s[8:11], s22 offen offset:1024 lds
    s_mov_b32 m0, 34816
    s_mov_b32 s22, 41984
    buffer_load_dwordx4 v5, s[8:11], s22 offen lds
    buffer_load_dwordx4 v6, s[8:11], s22 offen offset:1024 lds
    s_mov_b32 m0, 36864
    s_mov_b32 s22, 1152
    buffer_load_dwordx4 v5, s[8:11], s22 offen lds
    buffer_load_dwordx4 v6, s[8:11], s22 offen offset:1024 lds
    s_mov_b32 m0, 38912
    s_mov_b32 s22, 42112
    buffer_load_dwordx4 v5, s[8:11], s22 offen lds
    buffer_load_dwordx4 v6, s[8:11], s22 offen offset:1024 lds
    s_mov_b32 m0, 40960
    s_mov_b32 s22, 1280
    buffer_load_dwordx4 v5, s[8:11], s22 offen lds
    buffer_load_dwordx4 v6, s[8:11], s22 offen offset:1024 lds
    s_mov_b32 m0, 43008
    s_mov_b32 s22, 42240
    buffer_load_dwordx4 v5, s[8:11], s22 offen lds
    buffer_load_dwordx4 v6, s[8:11], s22 offen offset:1024 lds
    s_mov_b32 m0, 45056
    s_mov_b32 s22, 1408
    buffer_load_dwordx4 v5, s[8:11], s22 offen lds
    buffer_load_dwordx4 v6, s[8:11], s22 offen offset:1024 lds
    s_mov_b32 m0, 47104
    s_mov_b32 s22, 42368
    buffer_load_dwordx4 v5, s[8:11], s22 offen lds
    buffer_load_dwordx4 v6, s[8:11], s22 offen offset:1024 lds
    s_mov_b32 m0, 49152
    s_mov_b32 s22, 1536
    buffer_load_dwordx4 v5, s[8:11], s22 offen lds
    buffer_load_dwordx4 v6, s[8:11], s22 offen offset:1024 lds
    s_mov_b32 m0, 51200
    s_mov_b32 s22, 42496
    buffer_load_dwordx4 v5, s[8:11], s22 offen lds
    buffer_load_dwordx4 v6, s[8:11], s22 offen offset:1024 lds
    s_mov_b32 m0, 53248
    s_mov_b32 s22, 1664
    buffer_load_dwordx4 v5, s[8:11], s22 offen lds
    buffer_load_dwordx4 v6, s[8:11], s22 offen offset:1024 lds
    s_mov_b32 m0, 55296
    s_mov_b32 s22, 42624
    buffer_load_dwordx4 v5, s[8:11], s22 offen lds
    buffer_load_dwordx4 v6, s[8:11], s22 offen offset:1024 lds
    s_mov_b32 m0, 57344
    s_mov_b32 s22, 1792
    buffer_load_dwordx4 v5, s[8:11], s22 offen lds
    buffer_load_dwordx4 v6, s[8:11], s22 offen offset:1024 lds
    s_mov_b32 m0, 59392
    s_mov_b32 s22, 42752
    buffer_load_dwordx4 v5, s[8:11], s22 offen lds
    buffer_load_dwordx4 v6, s[8:11], s22 offen offset:1024 lds
    s_mov_b32 m0, 61440
    s_mov_b32 s22, 1920
    buffer_load_dwordx4 v5, s[8:11], s22 offen lds
    buffer_load_dwordx4 v6, s[8:11], s22 offen offset:1024 lds
    s_mov_b32 m0, 63488
    s_mov_b32 s22, 42880
    buffer_load_dwordx4 v5, s[8:11], s22 offen lds
    buffer_load_dwordx4 v6, s[8:11], s22 offen offset:1024 lds
    s_mov_b32 m0, 65536
    s_mov_b32 s22, 2048
    buffer_load_dwordx4 v5, s[8:11], s22 offen lds
    buffer_load_dwordx4 v6, s[8:11], s22 offen offset:1024 lds
    s_mov_b32 m0, 67584
    s_mov_b32 s22, 43008
    buffer_load_dwordx4 v5, s[8:11], s22 offen lds
    buffer_load_dwordx4 v6, s[8:11], s22 offen offset:1024 lds
    s_mov_b32 m0, 69632
    s_mov_b32 s22, 2176
    buffer_load_dwordx4 v5, s[8:11], s22 offen lds
    buffer_load_dwordx4 v6, s[8:11], s22 offen offset:1024 lds
    s_mov_b32 m0, 71680
    s_mov_b32 s22, 43136
    buffer_load_dwordx4 v5, s[8:11], s22 offen lds
    buffer_load_dwordx4 v6, s[8:11], s22 offen offset:1024 lds
    s_mov_b32 m0, 73728
    s_mov_b32 s22, 2304
    buffer_load_dwordx4 v5, s[8:11], s22 offen lds
    buffer_load_dwordx4 v6, s[8:11], s22 offen offset:1024 lds
    s_mov_b32 m0, 75776
    s_mov_b32 s22, 43264
    buffer_load_dwordx4 v5, s[8:11], s22 offen lds
    buffer_load_dwordx4 v6, s[8:11], s22 offen offset:1024 lds
    s_mov_b32 m0, 77824
    s_mov_b32 s22, 2432
    buffer_load_dwordx4 v5, s[8:11], s22 offen lds
    buffer_load_dwordx4 v6, s[8:11], s22 offen offset:1024 lds
    s_mov_b32 m0, 79872
    s_mov_b32 s22, 43392
    buffer_load_dwordx4 v5, s[8:11], s22 offen lds
    buffer_load_dwordx4 v6, s[8:11], s22 offen offset:1024 lds
    s_mov_b32 m0, 81920
    s_mov_b32 s22, 0
    buffer_load_dwordx4 v4, s[4:7], s22 offen lds
    s_mov_b32 m0, 82944
    s_mov_b32 s22, 327680
    buffer_load_dwordx4 v4, s[4:7], s22 offen lds
    s_mov_b32 m0, 83968
    s_mov_b32 s22, 655360
    buffer_load_dwordx4 v4, s[4:7], s22 offen lds
    s_mov_b32 m0, 84992
    s_mov_b32 s22, 983040
    buffer_load_dwordx4 v4, s[4:7], s22 offen lds
    s_mov_b32 m0, 86016
    s_mov_b32 s22, 1310720
    buffer_load_dwordx4 v4, s[4:7], s22 offen lds
    s_mov_b32 m0, 87040
    s_mov_b32 s22, 1638400
    buffer_load_dwordx4 v4, s[4:7], s22 offen lds
    s_mov_b32 m0, 88064
    s_mov_b32 s22, 1966080
    buffer_load_dwordx4 v4, s[4:7], s22 offen lds
    s_mov_b32 m0, 89088
    s_mov_b32 s22, 2293760
    buffer_load_dwordx4 v4, s[4:7], s22 offen lds
    s_mov_b32 m0, 90112
    s_mov_b32 s22, 640
    buffer_load_dwordx4 v4, s[4:7], s22 offen lds
    s_mov_b32 m0, 91136
    s_mov_b32 s22, 328320
    buffer_load_dwordx4 v4, s[4:7], s22 offen lds
    s_mov_b32 m0, 92160
    s_mov_b32 s22, 656000
    buffer_load_dwordx4 v4, s[4:7], s22 offen lds
    s_mov_b32 m0, 93184
    s_mov_b32 s22, 983680
    buffer_load_dwordx4 v4, s[4:7], s22 offen lds
    s_mov_b32 m0, 94208
    s_mov_b32 s22, 1311360
    buffer_load_dwordx4 v4, s[4:7], s22 offen lds
    s_mov_b32 m0, 95232
    s_mov_b32 s22, 1639040
    buffer_load_dwordx4 v4, s[4:7], s22 offen lds
    s_mov_b32 m0, 96256
    s_mov_b32 s22, 1966720
    buffer_load_dwordx4 v4, s[4:7], s22 offen lds
    s_mov_b32 m0, 97280
    s_mov_b32 s22, 2294400
    buffer_load_dwordx4 v4, s[4:7], s22 offen lds
KF_NODMA:
    s_waitcnt vmcnt(0)
    s_barrier
    s_mov_b32 s60, 0
    buffer_load_dwordx4 a[0:3], v254, s[8:11], s60 offen offset:0
    buffer_load_dwordx4 a[4:7], v254, s[8:11], s60 offen offset:1024
    buffer_load_dwordx4 a[8:11], v254, s[8:11], s60 offen offset:2048
    s_mov_b32 s60, 3072
    buffer_load_dwordx4 a[12:15], v254, s[8:11], s60 offen offset:0
    buffer_load_dwordx4 a[16:19], v254, s[8:11], s60 offen offset:1024
    buffer_load_dwordx4 a[20:23], v254, s[8:11], s60 offen offset:2048
    s_mov_b32 s60, 6144
    buffer_load_dwordx4 a[24:27], v254, s[8:11], s60 offen offset:0
    buffer_load_dwordx4 a[28:31], v254, s[8:11], s60 offen offset:1024
    buffer_load_dwordx4 a[32:35], v254, s[8:11], s60 offen offset:2048
    s_mov_b32 s60, 9216
    buffer_load_dwordx4 a[36:39], v254, s[8:11], s60 offen offset:0
    buffer_load_dwordx4 a[40:43], v254, s[8:11], s60 offen offset:1024
    buffer_load_dwordx4 a[44:47], v254, s[8:11], s60 offen offset:2048
    s_mov_b32 s60, 12288
    buffer_load_dwordx4 a[48:51], v254, s[8:11], s60 offen offset:0
    buffer_load_dwordx4 a[52:55], v254, s[8:11], s60 offen offset:1024
    buffer_load_dwordx4 a[56:59], v254, s[8:11], s60 offen offset:2048
    s_mov_b32 s60, 15360
    buffer_load_dwordx4 a[60:63], v254, s[8:11], s60 offen offset:0
    buffer_load_dwordx4 a[64:67], v254, s[8:11], s60 offen offset:1024
    buffer_load_dwordx4 a[68:71], v254, s[8:11], s60 offen offset:2048
    s_mov_b32 s60, 18432
    buffer_load_dwordx4 a[72:75], v254, s[8:11], s60 offen offset:0
    buffer_load_dwordx4 a[76:79], v254, s[8:11], s60 offen offset:1024
    buffer_load_dwordx4 a[80:83], v254, s[8:11], s60 offen offset:2048
    s_mov_b32 s60, 21504
    buffer_load_dwordx4 a[84:87], v254, s[8:11], s60 offen offset:0
    buffer_load_dwordx4 a[88:91], v254, s[8:11], s60 offen offset:1024
    buffer_load_dwordx4 a[92:95], v254, s[8:11], s60 offen offset:2048
    s_mov_b32 s60, 24576
    buffer_load_dwordx4 a[96:99], v254, s[8:11], s60 offen offset:0
    buffer_load_dwordx4 a[100:103], v254, s[8:11], s60 offen offset:1024
    buffer_load_dwordx4 a[104:107], v254, s[8:11], s60 offen offset:2048
    s_mov_b32 s60, 27648
    buffer_load_dwordx4 a[108:111], v254, s[8:11], s60 offen offset:0
    buffer_load_dwordx4 a[112:115], v254, s[8:11], s60 offen offset:1024
    buffer_load_dwordx4 a[116:119], v254, s[8:11], s60 offen offset:2048
    s_mov_b32 s60, 30720
    buffer_load_dwordx4 a[120:123], v254, s[8:11], s60 offen offset:0
    buffer_load_dwordx4 a[124:127], v254, s[8:11], s60 offen offset:1024
    buffer_load_dwordx4 a[128:131], v254, s[8:11], s60 offen offset:2048
    s_mov_b32 s60, 33792
    buffer_load_dwordx4 a[132:135], v254, s[8:11], s60 offen offset:0
    buffer_load_dwordx4 a[136:139], v254, s[8:11], s60 offen offset:1024
    buffer_load_dwordx4 a[140:143], v254, s[8:11], s60 offen offset:2048
    s_branch KF_S3_BAR
KF_P3:
    s_lshl_b32 s22, s19, 2
    s_add_u32 s22, s22, 5120
    v_lshl_add_u32 v6, v2, 4, s22
    v_mov_b32 v7, 0x4400
    v_add_u32 v8, s19, v1
    v_cvt_f32_u32 v9, v8
    v_lshlrev_b32 v10, 3, v2
    v_cvt_f32_u32 v10, v10
    v_mul_f32 v10, v10, v9
    v_add_f32 v11, v9, v9
    s_mov_b32 s32, 0x3acccccd
    s_mov_b32 s33, 0xc4200000
    v_mul_f32 v12, s32, v10
    v_floor_f32 v12, v12
    v_fma_f32 v12, v12, s33, v10
    v_mul_f32 v156, s32, v12
    v_add_f32 v10, v10, v11
    v_mul_f32 v12, s32, v10
    v_floor_f32 v12, v12
    v_fma_f32 v12, v12, s33, v10
    v_mul_f32 v157, s32, v12
    v_add_f32 v10, v10, v11
    v_mul_f32 v12, s32, v10
    v_floor_f32 v12, v12
    v_fma_f32 v12, v12, s33, v10
    v_mul_f32 v158, s32, v12
    v_add_f32 v10, v10, v11
    v_mul_f32 v12, s32, v10
    v_floor_f32 v12, v12
    v_fma_f32 v12, v12, s33, v10
    v_mul_f32 v159, s32, v12
    v_fmamk_f32 v10, v9, 0x41d00000, v10
    v_mul_f32 v12, s32, v10
    v_floor_f32 v12, v12
    v_fma_f32 v12, v12, s33, v10
    v_mul_f32 v164, s32, v12
    v_add_f32 v10, v10, v11
    v_mul_f32 v12, s32, v10
    v_floor_f32 v12, v12
    v_fma_f32 v12, v12, s33, v10
    v_mul_f32 v165, s32, v12
    v_add_f32 v10, v10, v11
    v_mul_f32 v12, s32, v10
    v_floor_f32 v12, v12
    v_fma_f32 v12, v12, s33, v10
    v_mul_f32 v166, s32, v12
    v_add_f32 v10, v10, v11
    v_mul_f32 v12, s32, v10
    v_floor_f32 v12, v12
    v_fma_f32 v12, v12, s33, v10
    v_mul_f32 v167, s32, v12
    v_sin_f32 v160, v156
    v_cos_f32 v156, v156
    v_sin_f32 v161, v157
    v_cos_f32 v157, v157
    v_sin_f32 v162, v158
    v_cos_f32 v158, v158
    v_sin_f32 v163, v159
    v_cos_f32 v159, v159
    v_sin_f32 v168, v164
    v_cos_f32 v164, v164
    v_sin_f32 v169, v165
    v_cos_f32 v165, v165
    v_sin_f32 v170, v166
    v_cos_f32 v166, v166
    v_sin_f32 v171, v167
    v_cos_f32 v167, v167
    s_waitcnt lgkmcnt(0)
    s_and_b32 s5, s5, 0xffff
    s_mov_b32 s6, 0x280000
    s_mov_b32 s7, 0x00020000
    s_and_b32 s9, s9, 0xffff
    s_mov_b32 s10, 0x10000000
    s_mov_b32 s11, 0x00020000
    s_and_b32 s13, s13, 0xffff
    s_mov_b32 s14, 0x280000
    s_mov_b32 s15, 0x00020000
    buffer_load_dwordx4 v[32:35], v6, s[8:11], 0 offen offset:0
    buffer_load_dwordx4 v[36:39], v6, s[8:11], 0 offen offset:1280
    buffer_load_dword v40, v7, s[8:11], 0 offen
    v_mul_f32 v12, s32, v9
    v_cos_f32 v13, v12
    v_sin_f32 v14, v12
    v_mul_f32 v12, 0x3d4ccccd, v9
    v_floor_f32 v12, v12
    v_fmamk_f32 v12, v12, 0xc1a00000, v9
    v_mul_f32 v12, 0x3d4ccccd, v12
    v_cos_f32 v12, v12
    v_mov_b32 v4, 0x3d21e89b
    v_mov_b32 v5, 0x3d21e89b
    v_pk_mul_f32 v[156:157], v[156:157], v[4:5]
    v_pk_mul_f32 v[158:159], v[158:159], v[4:5]
    v_pk_mul_f32 v[160:161], v[160:161], v[4:5]
    v_pk_mul_f32 v[162:163], v[162:163], v[4:5]
    v_pk_mul_f32 v[164:165], v[164:165], v[4:5]
    v_pk_mul_f32 v[166:167], v[166:167], v[4:5]
    v_pk_mul_f32 v[168:169], v[168:169], v[4:5]
    v_pk_mul_f32 v[170:171], v[170:171], v[4:5]
    v_add_f32 v10, v12, v12
    v_add_f32 v11, v12, v12
    v_mul_f32 v172, v156, v13
    v_mul_f32 v176, v160, v13
    v_fma_f32 v172, -v160, v14, v172
    v_fmac_f32 v176, v156, v14
    v_mul_f32 v173, v157, v13
    v_mul_f32 v177, v161, v13
    v_fma_f32 v173, -v161, v14, v173
    v_fmac_f32 v177, v157, v14
    v_mul_f32 v174, v158, v13
    v_mul_f32 v178, v162, v13
    v_fma_f32 v174, -v162, v14, v174
    v_fmac_f32 v178, v158, v14
    v_mul_f32 v175, v159, v13
    v_mul_f32 v179, v163, v13
    v_fma_f32 v175, -v163, v14, v175
    v_fmac_f32 v179, v159, v14
    v_mul_f32 v180, v164, v13
    v_mul_f32 v184, v168, v13
    v_fma_f32 v180, -v168, v14, v180
    v_fmac_f32 v184, v164, v14
    v_mul_f32 v181, v165, v13
    v_mul_f32 v185, v169, v13
    v_fma_f32 v181, -v169, v14, v181
    v_fmac_f32 v185, v165, v14
    v_mul_f32 v182, v166, v13
    v_mul_f32 v186, v170, v13
    v_fma_f32 v182, -v170, v14, v182
    v_fmac_f32 v186, v166, v14
    v_mul_f32 v183, v167, v13
    v_mul_f32 v187, v171, v13
    v_fma_f32 v183, -v171, v14, v183
    v_fmac_f32 v187, v167, v14
    v_cmp_eq_u32 s[26:27], 0, v2
    v_lshlrev_b32 v13, 31, v8
    v_xor_b32 v13, 0x3ca1e89b, v13
    v_mov_b32 v14, 0x3ca1e89b
    v_cndmask_b32 v14, v156, v14, s[26:27]
    v_cndmask_b32 v13, v160, v13, s[26:27]
    v_cvt_pk_f16_f32 v44, v14, v157
    v_cvt_pk_f16_f32 v45, v158, v159
    v_cvt_pk_f16_f32 v46, v13, v161
    v_cvt_pk_f16_f32 v47, v162, v163
    v_cvt_pk_f16_f32 v84, v172, v173
    v_cvt_pk_f16_f32 v85, v174, v175
    v_cvt_pk_f16_f32 v86, v176, v177
    v_cvt_pk_f16_f32 v87, v178, v179
    v_cvt_pk_f16_f32 v48, v164, v165
    v_cvt_pk_f16_f32 v49, v166, v167
    v_cvt_pk_f16_f32 v50, v168, v169
    v_cvt_pk_f16_f32 v51, v170, v171
    v_cvt_pk_f16_f32 v88, v180, v181
    v_cvt_pk_f16_f32 v89, v182, v183
    v_cvt_pk_f16_f32 v90, v184, v185
    v_cvt_pk_f16_f32 v91, v186, v187
    v_pk_fma_f32 v[156:157], v[10:11], v[164:165], v[156:157] neg_lo:[0,0,1] neg_hi:[0,0,1]
    v_pk_fma_f32 v[158:159], v[10:11], v[166:167], v[158:159] neg_lo:[0,0,1] neg_hi:[0,0,1]
    v_pk_fma_f32 v[160:161], v[10:11], v[168:169], v[160:161] neg_lo:[0,0,1] neg_hi:[0,0,1]
    v_pk_fma_f32 v[162:163], v[10:11], v[170:171], v[162:163] neg_lo:[0,0,1] neg_hi:[0,0,1]
    v_pk_fma_f32 v[172:173], v[10:11], v[180:181], v[172:173] neg_lo:[0,0,1] neg_hi:[0,0,1]
    v_pk_fma_f32 v[174:175], v[10:11], v[182:183], v[174:175] neg_lo:[0,0,1] neg_hi:[0,0,1]
    v_pk_fma_f32 v[176:177], v[10:11], v[184:185], v[176:177] neg_lo:[0,0,1] neg_hi:[0,0,1]
    v_pk_fma_f32 v[178:179], v[10:11], v[186:187], v[178:179] neg_lo:[0,0,1] neg_hi:[0,0,1]
    v_cvt_pk_f16_f32 v52, v156, v157
    v_cvt_pk_f16_f32 v53, v158, v159
    v_cvt_pk_f16_f32 v54, v160, v161
    v_cvt_pk_f16_f32 v55, v162, v163
    v_cvt_pk_f16_f32 v92, v172, v173
    v_cvt_pk_f16_f32 v93, v174, v175
    v_cvt_pk_f16_f32 v94, v176, v177
    v_cvt_pk_f16_f32 v95, v178, v179
    v_pk_fma_f32 v[164:165], v[10:11], v[156:157], v[164:165] neg_lo:[0,0,1] neg_hi:[0,0,1]
    v_pk_fma_f32 v[166:167], v[10:11], v[158:159], v[166:167] neg_lo:[0,0,1] neg_hi:[0,0,1]
    v_pk_fma_f32 v[168:169], v[10:11], v[160:161], v[168:169] neg_lo:[0,0,1] neg_hi:[0,0,1]
    v_pk_fma_f32 v[170:171], v[10:11], v[162:163], v[170:171] neg_lo:[0,0,1] neg_hi:[0,0,1]
    v_pk_fma_f32 v[180:181], v[10:11], v[172:173], v[180:181] neg_lo:[0,0,1] neg_hi:[0,0,1]
    v_pk_fma_f32 v[182:183], v[10:11], v[174:175], v[182:183] neg_lo:[0,0,1] neg_hi:[0,0,1]
    v_pk_fma_f32 v[184:185], v[10:11], v[176:177], v[184:185] neg_lo:[0,0,1] neg_hi:[0,0,1]
    v_pk_fma_f32 v[186:187], v[10:11], v[178:179], v[186:187] neg_lo:[0,0,1] neg_hi:[0,0,1]
    v_cvt_pk_f16_f32 v56, v164, v165
    v_cvt_pk_f16_f32 v57, v166, v167
    v_cvt_pk_f16_f32 v58, v168, v169
    v_cvt_pk_f16_f32 v59, v170, v171
    v_cvt_pk_f16_f32 v96, v180, v181
    v_cvt_pk_f16_f32 v97, v182, v183
    v_cvt_pk_f16_f32 v98, v184, v185
    v_cvt_pk_f16_f32 v99, v186, v187
    v_pk_fma_f32 v[156:157], v[10:11], v[164:165], v[156:157] neg_lo:[0,0,1] neg_hi:[0,0,1]
    v_pk_fma_f32 v[158:159], v[10:11], v[166:167], v[158:159] neg_lo:[0,0,1] neg_hi:[0,0,1]
    v_pk_fma_f32 v[160:161], v[10:11], v[168:169], v[160:161] neg_lo:[0,0,1] neg_hi:[0,0,1]
    v_pk_fma_f32 v[162:163], v[10:11], v[170:171], v[162:163] neg_lo:[0,0,1] neg_hi:[0,0,1]
    v_pk_fma_f32 v[172:173], v[10:11], v[180:181], v[172:173] neg_lo:[0,0,1] neg_hi:[0,0,1]
    v_pk_fma_f32 v[174:175], v[10:11], v[182:183], v[174:175] neg_lo:[0,0,1] neg_hi:[0,0,1]
    v_pk_fma_f32 v[176:177], v[10:11], v[184:185], v[176:177] neg_lo:[0,0,1] neg_hi:[0,0,1]
    v_pk_fma_f32 v[178:179], v[10:11], v[186:187], v[178:179] neg_lo:[0,0,1] neg_hi:[0,0,1]
    v_cvt_pk_f16_f32 v60, v156, v157
    v_cvt_pk_f16_f32 v61, v158, v159
    v_cvt_pk_f16_f32 v62, v160, v161
    v_cvt_pk_f16_f32 v63, v162, v163
    v_cvt_pk_f16_f32 v100, v172, v173
    v_cvt_pk_f16_f32 v101, v174, v175
    v_cvt_pk_f16_f32 v102, v176, v177
    v_cvt_pk_f16_f32 v103, v178, v179
    v_pk_fma_f32 v[164:165], v[10:11], v[156:157], v[164:165] neg_lo:[0,0,1] neg_hi:[0,0,1]
    v_pk_fma_f32 v[166:167], v[10:11], v[158:159], v[166:167] neg_lo:[0,0,1] neg_hi:[0,0,1]
    v_pk_fma_f32 v[168:169], v[10:11], v[160:161], v[168:169] neg_lo:[0,0,1] neg_hi:[0,0,1]
    v_pk_fma_f32 v[170:171], v[10:11], v[162:163], v[170:171] neg_lo:[0,0,1] neg_hi:[0,0,1]
    v_pk_fma_f32 v[180:181], v[10:11], v[172:173], v[180:181] neg_lo:[0,0,1] neg_hi:[0,0,1]
    v_pk_fma_f32 v[182:183], v[10:11], v[174:175], v[182:183] neg_lo:[0,0,1] neg_hi:[0,0,1]
    v_pk_fma_f32 v[184:185], v[10:11], v[176:177], v[184:185] neg_lo:[0,0,1] neg_hi:[0,0,1]
    v_pk_fma_f32 v[186:187], v[10:11], v[178:179], v[186:187] neg_lo:[0,0,1] neg_hi:[0,0,1]
    v_cvt_pk_f16_f32 v64, v164, v165
    v_cvt_pk_f16_f32 v65, v166, v167
    v_cvt_pk_f16_f32 v66, v168, v169
    v_cvt_pk_f16_f32 v67, v170, v171
    v_cvt_pk_f16_f32 v104, v180, v181
    v_cvt_pk_f16_f32 v105, v182, v183
    v_cvt_pk_f16_f32 v106, v184, v185
    v_cvt_pk_f16_f32 v107, v186, v187
    v_pk_fma_f32 v[156:157], v[10:11], v[164:165], v[156:157] neg_lo:[0,0,1] neg_hi:[0,0,1]
    v_pk_fma_f32 v[158:159], v[10:11], v[166:167], v[158:159] neg_lo:[0,0,1] neg_hi:[0,0,1]
    v_pk_fma_f32 v[160:161], v[10:11], v[168:169], v[160:161] neg_lo:[0,0,1] neg_hi:[0,0,1]
    v_pk_fma_f32 v[162:163], v[10:11], v[170:171], v[162:163] neg_lo:[0,0,1] neg_hi:[0,0,1]
    v_pk_fma_f32 v[172:173], v[10:11], v[180:181], v[172:173] neg_lo:[0,0,1] neg_hi:[0,0,1]
    v_pk_fma_f32 v[174:175], v[10:11], v[182:183], v[174:175] neg_lo:[0,0,1] neg_hi:[0,0,1]
    v_pk_fma_f32 v[176:177], v[10:11], v[184:185], v[176:177] neg_lo:[0,0,1] neg_hi:[0,0,1]
    v_pk_fma_f32 v[178:179], v[10:11], v[186:187], v[178:179] neg_lo:[0,0,1] neg_hi:[0,0,1]
    v_cvt_pk_f16_f32 v68, v156, v157
    v_cvt_pk_f16_f32 v69, v158, v159
    v_cvt_pk_f16_f32 v70, v160, v161
    v_cvt_pk_f16_f32 v71, v162, v163
    v_cvt_pk_f16_f32 v108, v172, v173
    v_cvt_pk_f16_f32 v109, v174, v175
    v_cvt_pk_f16_f32 v110, v176, v177
    v_cvt_pk_f16_f32 v111, v178, v179
    v_pk_fma_f32 v[164:165], v[10:11], v[156:157], v[164:165] neg_lo:[0,0,1] neg_hi:[0,0,1]
    v_pk_fma_f32 v[166:167], v[10:11], v[158:159], v[166:167] neg_lo:[0,0,1] neg_hi:[0,0,1]
    v_pk_fma_f32 v[168:169], v[10:11], v[160:161], v[168:169] neg_lo:[0,0,1] neg_hi:[0,0,1]
    v_pk_fma_f32 v[170:171], v[10:11], v[162:163], v[170:171] neg_lo:[0,0,1] neg_hi:[0,0,1]
    v_pk_fma_f32 v[180:181], v[10:11], v[172:173], v[180:181] neg_lo:[0,0,1] neg_hi:[0,0,1]
    v_pk_fma_f32 v[182:183], v[10:11], v[174:175], v[182:183] neg_lo:[0,0,1] neg_hi:[0,0,1]
    v_pk_fma_f32 v[184:185], v[10:11], v[176:177], v[184:185] neg_lo:[0,0,1] neg_hi:[0,0,1]
    v_pk_fma_f32 v[186:187], v[10:11], v[178:179], v[186:187] neg_lo:[0,0,1] neg_hi:[0,0,1]
    v_cvt_pk_f16_f32 v72, v164, v165
    v_cvt_pk_f16_f32 v73, v166, v167
    v_cvt_pk_f16_f32 v74, v168, v169
    v_cvt_pk_f16_f32 v75, v170, v171
    v_cvt_pk_f16_f32 v112, v180, v181
    v_cvt_pk_f16_f32 v113, v182, v183
    v_cvt_pk_f16_f32 v114, v184, v185
    v_cvt_pk_f16_f32 v115, v186, v187
    v_pk_fma_f32 v[156:157], v[10:11], v[164:165], v[156:157] neg_lo:[0,0,1] neg_hi:[0,0,1]
    v_pk_fma_f32 v[158:159], v[10:11], v[166:167], v[158:159] neg_lo:[0,0,1] neg_hi:[0,0,1]
    v_pk_fma_f32 v[160:161], v[10:11], v[168:169], v[160:161] neg_lo:[0,0,1] neg_hi:[0,0,1]
    v_pk_fma_f32 v[162:163], v[10:11], v[170:171], v[162:163] neg_lo:[0,0,1] neg_hi:[0,0,1]
    v_pk_fma_f32 v[172:173], v[10:11], v[180:181], v[172:173] neg_lo:[0,0,1] neg_hi:[0,0,1]
    v_pk_fma_f32 v[174:175], v[10:11], v[182:183], v[174:175] neg_lo:[0,0,1] neg_hi:[0,0,1]
    v_pk_fma_f32 v[176:177], v[10:11], v[184:185], v[176:177] neg_lo:[0,0,1] neg_hi:[0,0,1]
    v_pk_fma_f32 v[178:179], v[10:11], v[186:187], v[178:179] neg_lo:[0,0,1] neg_hi:[0,0,1]
    v_cvt_pk_f16_f32 v76, v156, v157
    v_cvt_pk_f16_f32 v77, v158, v159
    v_cvt_pk_f16_f32 v78, v160, v161
    v_cvt_pk_f16_f32 v79, v162, v163
    v_cvt_pk_f16_f32 v116, v172, v173
    v_cvt_pk_f16_f32 v117, v174, v175
    v_cvt_pk_f16_f32 v118, v176, v177
    v_cvt_pk_f16_f32 v119, v178, v179
    v_pk_fma_f32 v[164:165], v[10:11], v[156:157], v[164:165] neg_lo:[0,0,1] neg_hi:[0,0,1]
    v_pk_fma_f32 v[166:167], v[10:11], v[158:159], v[166:167] neg_lo:[0,0,1] neg_hi:[0,0,1]
    v_pk_fma_f32 v[168:169], v[10:11], v[160:161], v[168:169] neg_lo:[0,0,1] neg_hi:[0,0,1]
    v_pk_fma_f32 v[170:171], v[10:11], v[162:163], v[170:171] neg_lo:[0,0,1] neg_hi:[0,0,1]
    v_pk_fma_f32 v[180:181], v[10:11], v[172:173], v[180:181] neg_lo:[0,0,1] neg_hi:[0,0,1]
    v_pk_fma_f32 v[182:183], v[10:11], v[174:175], v[182:183] neg_lo:[0,0,1] neg_hi:[0,0,1]
    v_pk_fma_f32 v[184:185], v[10:11], v[176:177], v[184:185] neg_lo:[0,0,1] neg_hi:[0,0,1]
    v_pk_fma_f32 v[186:187], v[10:11], v[178:179], v[186:187] neg_lo:[0,0,1] neg_hi:[0,0,1]
    v_cvt_pk_f16_f32 v80, v164, v165
    v_cvt_pk_f16_f32 v81, v166, v167
    v_cvt_pk_f16_f32 v82, v168, v169
    v_cvt_pk_f16_f32 v83, v170, v171
    v_cvt_pk_f16_f32 v120, v180, v181
    v_cvt_pk_f16_f32 v121, v182, v183
    v_cvt_pk_f16_f32 v122, v184, v185
    v_cvt_pk_f16_f32 v123, v186, v187
    v_cvt_f32_u32 v9, v1
    v_mul_f32 v9, 0x3c800000, v9
    v_lshlrev_b32 v10, 2, v2
    v_cvt_f32_u32 v10, v10
    v_mul_f32 v10, v10, v9
    v_fract_f32 v156, v10
    v_fmamk_f32 v157, v9, 0x3f800000, v10
    v_fract_f32 v157, v157
    v_fmamk_f32 v158, v9, 0x40000000, v10
    v_fract_f32 v158, v158
    v_fmamk_f32 v159, v9, 0x40400000, v10
    v_fract_f32 v159, v159
    v_fmamk_f32 v160, v9, 0x41800000, v10
    v_fract_f32 v160, v160
    v_fmamk_f32 v161, v9, 0x41880000, v10
    v_fract_f32 v161, v161
    v_fmamk_f32 v162, v9, 0x41900000, v10
    v_fract_f32 v162, v162
    v_fmamk_f32 v163, v9, 0x41980000, v10
    v_fract_f32 v163, v163
    v_sin_f32 v164, v156
    v_cos_f32 v156, v156
    v_sin_f32 v165, v157
    v_cos_f32 v157, v157
    v_sin_f32 v166, v158
    v_cos_f32 v158, v158
    v_sin_f32 v167, v159
    v_cos_f32 v159, v159
    v_sin_f32 v168, v160
    v_cos_f32 v160, v160
    v_sin_f32 v169, v161
    v_cos_f32 v161, v161
    v_sin_f32 v170, v162
    v_cos_f32 v162, v162
    v_sin_f32 v171, v163
    v_cos_f32 v163, v163
    v_cndmask_b32 v156, v156, 0.5, s[26:27]
    v_lshlrev_b32 v13, 31, v1
    v_xor_b32 v13, 0xbf000000, v13
    v_cndmask_b32 v164, v164, v13, s[26:27]
    v_cvt_pk_f16_f32 v124, v156, v157
    v_cvt_pk_f16_f32 v125, v158, v159
    v_cvt_pk_f16_f32 v126, v160, v161
    v_cvt_pk_f16_f32 v127, v162, v163
    v_cvt_pk_f16_f32 v128, v156, -v165
    v_cvt_pk_f16_f32 v129, -v158, v167
    v_cvt_pk_f16_f32 v130, v160, -v169
    v_cvt_pk_f16_f32 v131, -v162, v171
    v_cvt_pk_f16_f32 v132, v156, -v157
    v_cvt_pk_f16_f32 v133, v158, -v159
    v_cvt_pk_f16_f32 v134, v160, -v161
    v_cvt_pk_f16_f32 v135, v162, -v163
    v_cvt_pk_f16_f32 v136, v156, v165
    v_cvt_pk_f16_f32 v137, -v158, -v167
    v_cvt_pk_f16_f32 v138, v160, v169
    v_cvt_pk_f16_f32 v139, -v162, -v171
    v_cvt_pk_f16_f32 v140, -v164, -v165
    v_cvt_pk_f16_f32 v141, -v166, -v167
    v_cvt_pk_f16_f32 v142, -v168, -v169
    v_cvt_pk_f16_f32 v143, -v170, -v171
    v_cvt_pk_f16_f32 v144, -v164, -v157
    v_cvt_pk_f16_f32 v145, v166, v159
    v_cvt_pk_f16_f32 v146, -v168, -v161
    v_cvt_pk_f16_f32 v147, v170, v163
    v_cvt_pk_f16_f32 v148, -v164, v165
    v_cvt_pk_f16_f32 v149, -v166, v167
    v_cvt_pk_f16_f32 v150, -v168, v169
    v_cvt_pk_f16_f32 v151, -v170, v171
    v_cvt_pk_f16_f32 v152, -v164, v157
    v_cvt_pk_f16_f32 v153, v166, -v159
    v_cvt_pk_f16_f32 v154, -v168, v161
    v_cvt_pk_f16_f32 v155, v170, -v163
    v_bfe_u32 v9, v1, 3, 1
    v_mul_u32_u24 v9, 6, v9
    v_bfe_u32 v10, v1, 1, 1
    v_or_b32 v9, v9, v10
    v_lshlrev_b32 v10, 1, v2
    v_xor_b32 v9, v9, v10
    v_lshlrev_b32 v9, 4, v9
    v_lshl_add_u32 v9, v1, 7, v9
    v_xor_b32 v10, 16, v9
    v_add_u32 v11, 40960, v9
    v_add_u32 v12, 40960, v10
    v_lshrrev_b32 v13, 1, v2
    s_lshl_b32 s22, s20, 1
    v_add_u32 v13, s22, v13
    v_and_b32 v14, 7, v1
    v_xor_b32 v13, v13, v14
    v_lshlrev_b32 v13, 4, v13
    v_and_b32 v14, 1, v2
    v_lshl_add_u32 v13, v14, 3, v13
    v_lshl_add_u32 v13, v1, 7, v13
    v_add_u32 v13, 81920, v13
    s_lshl_b32 s22, s18, 10
    s_add_u32 s22, s22, s21
    s_add_u32 s22, s22, 0x700000
    v_add_u32 v4, s22, v255
    s_mul_i32 s22, s16, 10240
    s_lshl_b32 s23, s18, 9
    s_add_u32 s22, s22, s23
    s_add_u32 s22, s22, 0xa00000
    v_lshl_add_u32 v5, v3, 3, s22
    s_waitcnt vmcnt(0)
    v_mul_f32 v40, 0x3e800000, v40
    v_mul_f32 v32, v32, v40
    v_mul_f32 v33, v33, v40
    v_mul_f32 v34, v34, v40
    v_mul_f32 v35, v35, v40
    v_mul_f32 v36, v36, v40
    v_mul_f32 v37, v37, v40
    v_mul_f32 v38, v38, v40
    v_mul_f32 v39, v39, v40
    s_barrier
    ds_read_b128 v[188:191], v9 offset:0
    ds_read_b128 v[192:195], v9 offset:2048
    ds_read_b128 v[196:199], v10 offset:0
    ds_read_b128 v[200:203], v10 offset:2048
    ds_read_b128 v[204:207], v9 offset:4096
    ds_read_b128 v[208:211], v9 offset:6144
    ds_read_b128 v[212:215], v10 offset:4096
    ds_read_b128 v[216:219], v10 offset:6144
    ds_read_b128 v[220:223], v9 offset:8192
    ds_read_b128 v[224:227], v9 offset:10240
    ds_read_b128 v[228:231], v10 offset:8192
    ds_read_b128 v[232:235], v10 offset:10240
    s_waitcnt lgkmcnt(11)
    v_mfma_f32_16x16x32_f16 v[156:159], v[188:191], v[44:47], 0
    s_waitcnt lgkmcnt(10)
    v_mfma_f32_16x16x32_f16 v[160:163], v[192:195], v[44:47], 0
    s_waitcnt lgkmcnt(9)
    v_mfma_f32_16x16x32_f16 v[164:167], v[196:199], v[44:47], 0
    s_waitcnt lgkmcnt(8)
    v_mfma_f32_16x16x32_f16 v[168:171], v[200:203], v[44:47], 0
    ds_read_b128 v[188:191], v9 offset:12288
    ds_read_b128 v[192:195], v9 offset:14336
    ds_read_b128 v[196:199], v10 offset:12288
    ds_read_b128 v[200:203], v10 offset:14336
    s_waitcnt lgkmcnt(11)
    v_mfma_f32_16x16x32_f16 v[156:159], v[204:207], v[48:51], v[156:159]
    s_waitcnt lgkmcnt(10)
    v_mfma_f32_16x16x32_f16 v[160:163], v[208:211], v[48:51], v[160:163]
    s_waitcnt lgkmcnt(9)
    v_mfma_f32_16x16x32_f16 v[164:167], v[212:215], v[48:51], v[164:167]
    s_waitcnt lgkmcnt(8)
    v_mfma_f32_16x16x32_f16 v[168:171], v[216:219], v[48:51], v[168:171]
    ds_read_b128 v[204:207], v9 offset:16384
    ds_read_b128 v[208:211], v9 offset:18432
    ds_read_b128 v[212:215], v10 offset:16384
    ds_read_b128 v[216:219], v10 offset:18432
    s_waitcnt lgkmcnt(11)
    v_mfma_f32_16x16x32_f16 v[156:159], v[220:223], v[52:55], v[156:159]
    s_waitcnt lgkmcnt(10)
    v_mfma_f32_16x16x32_f16 v[160:163], v[224:227], v[52:55], v[160:163]
    s_waitcnt lgkmcnt(9)
    v_mfma_f32_16x16x32_f16 v[164:167], v[228:231], v[52:55], v[164:167]
    s_waitcnt lgkmcnt(8)
    v_mfma_f32_16x16x32_f16 v[168:171], v[232:235], v[52:55], v[168:171]
    ds_read_b128 v[220:223], v9 offset:20480
    ds_read_b128 v[224:227], v9 offset:22528
    ds_read_b128 v[228:231], v10 offset:20480
    ds_read_b128 v[232:235], v10 offset:22528
    s_waitcnt lgkmcnt(11)
    v_mfma_f32_16x16x32_f16 v[156:159], v[188:191], v[56:59], v[156:159]
    s_waitcnt lgkmcnt(10)
    v_mfma_f32_16x16x32_f16 v[160:163], v[192:195], v[56:59], v[160:163]
    s_waitcnt lgkmcnt(9)
    v_mfma_f32_16x16x32_f16 v[164:167], v[196:199], v[56:59], v[164:167]
    s_waitcnt lgkmcnt(8)
    v_mfma_f32_16x16x32_f16 v[168:171], v[200:203], v[56:59], v[168:171]
    ds_read_b128 v[188:191], v9 offset:24576
    ds_read_b128 v[192:195], v9 offset:26624
    ds_read_b128 v[196:199], v10 offset:24576
    ds_read_b128 v[200:203], v10 offset:26624
    s_waitcnt lgkmcnt(11)
    v_mfma_f32_16x16x32_f16 v[156:159], v[204:207], v[60:63], v[156:159]
    s_waitcnt lgkmcnt(10)
    v_mfma_f32_16x16x32_f16 v[160:163], v[208:211], v[60:63], v[160:163]
    s_waitcnt lgkmcnt(9)
    v_mfma_f32_16x16x32_f16 v[164:167], v[212:215], v[60:63], v[164:167]
    s_waitcnt lgkmcnt(8)
    v_mfma_f32_16x16x32_f16 v[168:171], v[216:219], v[60:63], v[168:171]
    ds_read_b128 v[204:207], v9 offset:28672
    ds_read_b128 v[208:211], v9 offset:30720
    ds_read_b128 v[212:215], v10 offset:28672
    ds_read_b128 v[216:219], v10 offset:30720
    s_waitcnt lgkmcnt(11)
    v_mfma_f32_16x16x32_f16 v[156:159], v[220:223], v[64:67], v[156:159]
    s_waitcnt lgkmcnt(10)
    v_mfma_f32_16x16x32_f16 v[160:163], v[224:227], v[64:67], v[160:163]
    s_waitcnt lgkmcnt(9)
    v_mfma_f32_16x16x32_f16 v[164:167], v[228:231], v[64:67], v[164:167]
    s_waitcnt lgkmcnt(8)
    v_mfma_f32_16x16x32_f16 v[168:171], v[232:235], v[64:67], v[168:171]
    ds_read_b128 v[220:223], v9 offset:32768
    ds_read_b128 v[224:227], v9 offset:34816
    ds_read_b128 v[228:231], v10 offset:32768
    ds_read_b128 v[232:235], v10 offset:34816
    s_waitcnt lgkmcnt(11)
    v_mfma_f32_16x16x32_f16 v[156:159], v[188:191], v[68:71], v[156:159]
    s_waitcnt lgkmcnt(10)
    v_mfma_f32_16x16x32_f16 v[160:163], v[192:195], v[68:71], v[160:163]
    s_waitcnt lgkmcnt(9)
    v_mfma_f32_16x16x32_f16 v[164:167], v[196:199], v[68:71], v[164:167]
    s_waitcnt lgkmcnt(8)
    v_mfma_f32_16x16x32_f16 v[168:171], v[200:203], v[68:71], v[168:171]
    ds_read_b128 v[188:191], v9 offset:36864
    ds_read_b128 v[192:195], v9 offset:38912
    ds_read_b128 v[196:199], v10 offset:36864
    ds_read_b128 v[200:203], v10 offset:38912
    s_waitcnt lgkmcnt(11)
    v_mfma_f32_16x16x32_f16 v[156:159], v[204:207], v[72:75], v[156:159]
    s_waitcnt lgkmcnt(10)
    v_mfma_f32_16x16x32_f16 v[160:163], v[208:211], v[72:75], v[160:163]
    s_waitcnt lgkmcnt(9)
    v_mfma_f32_16x16x32_f16 v[164:167], v[212:215], v[72:75], v[164:167]
    s_waitcnt lgkmcnt(8)
    v_mfma_f32_16x16x32_f16 v[168:171], v[216:219], v[72:75], v[168:171]
    ds_read_b128 v[204:207], v11 offset:0
    ds_read_b128 v[208:211], v11 offset:2048
    ds_read_b128 v[212:215], v12 offset:0
    ds_read_b128 v[216:219], v12 offset:2048
    s_waitcnt lgkmcnt(11)
    v_mfma_f32_16x16x32_f16 v[156:159], v[220:223], v[76:79], v[156:159]
    s_waitcnt lgkmcnt(10)
    v_mfma_f32_16x16x32_f16 v[160:163], v[224:227], v[76:79], v[160:163]
    s_waitcnt lgkmcnt(9)
    v_mfma_f32_16x16x32_f16 v[164:167], v[228:231], v[76:79], v[164:167]
    s_waitcnt lgkmcnt(8)
    v_mfma_f32_16x16x32_f16 v[168:171], v[232:235], v[76:79], v[168:171]
    ds_read_b128 v[220:223], v11 offset:4096
    ds_read_b128 v[224:227], v11 offset:6144
    ds_read_b128 v[228:231], v12 offset:4096
    ds_read_b128 v[232:235], v12 offset:6144
    s_waitcnt lgkmcnt(11)
    v_mfma_f32_16x16x32_f16 v[156:159], v[188:191], v[80:83], v[156:159]
    s_waitcnt lgkmcnt(10)
    v_mfma_f32_16x16x32_f16 v[160:163], v[192:195], v[80:83], v[160:163]
    s_waitcnt lgkmcnt(9)
    v_mfma_f32_16x16x32_f16 v[164:167], v[196:199], v[80:83], v[164:167]
    s_waitcnt lgkmcnt(8)
    v_mfma_f32_16x16x32_f16 v[168:171], v[200:203], v[80:83], v[168:171]
    ds_read_b128 v[188:191], v11 offset:8192
    ds_read_b128 v[192:195], v11 offset:10240
    ds_read_b128 v[196:199], v12 offset:8192
    ds_read_b128 v[200:203], v12 offset:10240
    s_waitcnt lgkmcnt(11)
    v_mfma_f32_16x16x32_f16 v[172:175], v[204:207], v[84:87], 0
    s_waitcnt lgkmcnt(10)
    v_mfma_f32_16x16x32_f16 v[176:179], v[208:211], v[84:87], 0
    s_waitcnt lgkmcnt(9)
    v_mfma_f32_16x16x32_f16 v[180:183], v[212:215], v[84:87], 0
    s_waitcnt lgkmcnt(8)
    v_mfma_f32_16x16x32_f16 v[184:187], v[216:219], v[84:87], 0
    ds_read_b128 v[204:207], v11 offset:12288
    ds_read_b128 v[208:211], v11 offset:14336
    ds_read_b128 v[212:215], v12 offset:12288
    ds_read_b128 v[216:219], v12 offset:14336
    s_waitcnt lgkmcnt(11)
    v_mfma_f32_16x16x32_f16 v[172:175], v[220:223], v[88:91], v[172:175]
    s_waitcnt lgkmcnt(10)
    v_mfma_f32_16x16x32_f16 v[176:179], v[224:227], v[88:91], v[176:179]
    s_waitcnt lgkmcnt(9)
    v_mfma_f32_16x16x32_f16 v[180:183], v[228:231], v[88:91], v[180:183]
    s_waitcnt lgkmcnt(8)
    v_mfma_f32_16x16x32_f16 v[184:187], v[232:235], v[88:91], v[184:187]
    ds_read_b128 v[220:223], v11 offset:16384
    ds_read_b128 v[224:227], v11 offset:18432
    ds_read_b128 v[228:231], v12 offset:16384
    ds_read_b128 v[232:235], v12 offset:18432
    s_waitcnt lgkmcnt(11)
    v_mfma_f32_16x16x32_f16 v[172:175], v[188:191], v[92:95], v[172:175]
    s_waitcnt lgkmcnt(10)
    v_mfma_f32_16x16x32_f16 v[176:179], v[192:195], v[92:95], v[176:179]
    s_waitcnt lgkmcnt(9)
    v_mfma_f32_16x16x32_f16 v[180:183], v[196:199], v[92:95], v[180:183]
    s_waitcnt lgkmcnt(8)
    v_mfma_f32_16x16x32_f16 v[184:187], v[200:203], v[92:95], v[184:187]
    ds_read_b128 v[188:191], v11 offset:20480
    ds_read_b128 v[192:195], v11 offset:22528
    ds_read_b128 v[196:199], v12 offset:20480
    ds_read_b128 v[200:203], v12 offset:22528
    s_waitcnt lgkmcnt(11)
    v_mfma_f32_16x16x32_f16 v[172:175], v[204:207], v[96:99], v[172:175]
    s_waitcnt lgkmcnt(10)
    v_mfma_f32_16x16x32_f16 v[176:179], v[208:211], v[96:99], v[176:179]
    s_waitcnt lgkmcnt(9)
    v_mfma_f32_16x16x32_f16 v[180:183], v[212:215], v[96:99], v[180:183]
    s_waitcnt lgkmcnt(8)
    v_mfma_f32_16x16x32_f16 v[184:187], v[216:219], v[96:99], v[184:187]
    ds_read_b128 v[204:207], v11 offset:24576
    ds_read_b128 v[208:211], v11 offset:26624
    ds_read_b128 v[212:215], v12 offset:24576
    ds_read_b128 v[216:219], v12 offset:26624
    s_waitcnt lgkmcnt(11)
    v_mfma_f32_16x16x32_f16 v[172:175], v[220:223], v[100:103], v[172:175]
    s_waitcnt lgkmcnt(10)
    v_mfma_f32_16x16x32_f16 v[176:179], v[224:227], v[100:103], v[176:179]
    s_waitcnt lgkmcnt(9)
    v_mfma_f32_16x16x32_f16 v[180:183], v[228:231], v[100:103], v[180:183]
    s_waitcnt lgkmcnt(8)
    v_mfma_f32_16x16x32_f16 v[184:187], v[232:235], v[100:103], v[184:187]
    ds_read_b128 v[220:223], v11 offset:28672
    ds_read_b128 v[224:227], v11 offset:30720
    ds_read_b128 v[228:231], v12 offset:28672
    ds_read_b128 v[232:235], v12 offset:30720
    s_waitcnt lgkmcnt(11)
    v_mfma_f32_16x16x32_f16 v[172:175], v[188:191], v[104:107], v[172:175]
    s_waitcnt lgkmcnt(10)
    v_mfma_f32_16x16x32_f16 v[176:179], v[192:195], v[104:107], v[176:179]
    s_waitcnt lgkmcnt(9)
    v_mfma_f32_16x16x32_f16 v[180:183], v[196:199], v[104:107], v[180:183]
    s_waitcnt lgkmcnt(8)
    v_mfma_f32_16x16x32_f16 v[184:187], v[200:203], v[104:107], v[184:187]
    ds_read_b128 v[188:191], v11 offset:32768
    ds_read_b128 v[192:195], v11 offset:34816
    ds_read_b128 v[196:199], v12 offset:32768
    ds_read_b128 v[200:203], v12 offset:34816
    s_waitcnt lgkmcnt(11)
    v_mfma_f32_16x16x32_f16 v[172:175], v[204:207], v[108:111], v[172:175]
    s_waitcnt lgkmcnt(10)
    v_mfma_f32_16x16x32_f16 v[176:179], v[208:211], v[108:111], v[176:179]
    s_waitcnt lgkmcnt(9)
    v_mfma_f32_16x16x32_f16 v[180:183], v[212:215], v[108:111], v[180:183]
    s_waitcnt lgkmcnt(8)
    v_mfma_f32_16x16x32_f16 v[184:187], v[216:219], v[108:111], v[184:187]
    ds_read_b128 v[204:207], v11 offset:36864
    ds_read_b128 v[208:211], v11 offset:38912
    ds_read_b128 v[212:215], v12 offset:36864
    ds_read_b128 v[216:219], v12 offset:38912
    s_waitcnt lgkmcnt(11)
    v_mfma_f32_16x16x32_f16 v[172:175], v[220:223], v[112:115], v[172:175]
    s_waitcnt lgkmcnt(10)
    v_mfma_f32_16x16x32_f16 v[176:179], v[224:227], v[112:115], v[176:179]
    s_waitcnt lgkmcnt(9)
    v_mfma_f32_16x16x32_f16 v[180:183], v[228:231], v[112:115], v[180:183]
    s_waitcnt lgkmcnt(8)
    v_mfma_f32_16x16x32_f16 v[184:187], v[232:235], v[112:115], v[184:187]
    ds_read_b64 v[16:17], v13 offset:0
    ds_read_b64 v[18:19], v13 offset:8192
    ds_read_b64 v[20:21], v13 offset:2048
    ds_read_b64 v[22:23], v13 offset:10240
    ds_read_b64 v[24:25], v13 offset:4096
    ds_read_b64 v[26:27], v13 offset:12288
    ds_read_b64 v[28:29], v13 offset:6144
    ds_read_b64 v[30:31], v13 offset:14336
    s_waitcnt lgkmcnt(15)
    v_mfma_f32_16x16x32_f16 v[172:175], v[188:191], v[116:119], v[172:175]
    s_waitcnt lgkmcnt(14)
    v_mfma_f32_16x16x32_f16 v[176:179], v[192:195], v[116:119], v[176:179]
    s_waitcnt lgkmcnt(13)
    v_mfma_f32_16x16x32_f16 v[180:183], v[196:199], v[116:119], v[180:183]
    s_waitcnt lgkmcnt(12)
    v_mfma_f32_16x16x32_f16 v[184:187], v[200:203], v[116:119], v[184:187]
    s_waitcnt lgkmcnt(11)
    v_mfma_f32_16x16x32_f16 v[172:175], v[204:207], v[120:123], v[172:175]
    s_waitcnt lgkmcnt(10)
    v_mfma_f32_16x16x32_f16 v[176:179], v[208:211], v[120:123], v[176:179]
    s_waitcnt lgkmcnt(9)
    v_mfma_f32_16x16x32_f16 v[180:183], v[212:215], v[120:123], v[180:183]
    s_waitcnt lgkmcnt(8)
    v_mfma_f32_16x16x32_f16 v[184:187], v[216:219], v[120:123], v[184:187]
    s_nop 1
    v_pk_add_f32 v[44:45], v[156:157], v[172:173]
    v_pk_add_f32 v[60:61], v[156:157], v[172:173] neg_lo:[0,1] neg_hi:[0,1]
    v_pk_add_f32 v[46:47], v[158:159], v[174:175]
    v_pk_add_f32 v[62:63], v[158:159], v[174:175] neg_lo:[0,1] neg_hi:[0,1]
    v_pk_add_f32 v[48:49], v[160:161], v[176:177]
    v_pk_add_f32 v[64:65], v[160:161], v[176:177] neg_lo:[0,1] neg_hi:[0,1]
    v_pk_add_f32 v[50:51], v[162:163], v[178:179]
    v_pk_add_f32 v[66:67], v[162:163], v[178:179] neg_lo:[0,1] neg_hi:[0,1]
    v_pk_add_f32 v[52:53], v[164:165], v[180:181]
    v_pk_add_f32 v[68:69], v[164:165], v[180:181] neg_lo:[0,1] neg_hi:[0,1]
    v_pk_add_f32 v[54:55], v[166:167], v[182:183]
    v_pk_add_f32 v[70:71], v[166:167], v[182:183] neg_lo:[0,1] neg_hi:[0,1]
    v_pk_add_f32 v[56:57], v[168:169], v[184:185]
    v_pk_add_f32 v[72:73], v[168:169], v[184:185] neg_lo:[0,1] neg_hi:[0,1]
    v_pk_add_f32 v[58:59], v[170:171], v[186:187]
    v_pk_add_f32 v[74:75], v[170:171], v[186:187] neg_lo:[0,1] neg_hi:[0,1]
    v_cvt_pk_f16_f32 v76, v44, v45
    v_cvt_pk_f16_f32 v84, v60, v61
    v_cvt_pk_f16_f32 v77, v46, v47
    v_cvt_pk_f16_f32 v85, v62, v63
    v_cvt_pk_f16_f32 v78, v48, v49
    v_cvt_pk_f16_f32 v86, v64, v65
    v_cvt_pk_f16_f32 v79, v50, v51
    v_cvt_pk_f16_f32 v87, v66, v67
    v_cvt_pk_f16_f32 v80, v52, v53
    v_cvt_pk_f16_f32 v88, v68, v69
    v_cvt_pk_f16_f32 v81, v54, v55
    v_cvt_pk_f16_f32 v89, v70, v71
    v_cvt_pk_f16_f32 v82, v56, v57
    v_cvt_pk_f16_f32 v90, v72, v73
    v_cvt_pk_f16_f32 v83, v58, v59
    v_cvt_pk_f16_f32 v91, v74, v75
    v_mfma_f32_16x16x32_f16 v[188:191], v[76:79], v[124:127], 0
    s_waitcnt lgkmcnt(0)
    v_lshlrev_b32 v92, 16, v16
    v_and_b32 v93, 0xffff0000, v16
    v_mfma_f32_16x16x32_f16 v[192:195], v[84:87], v[124:127], 0
    v_lshlrev_b32 v94, 16, v17
    v_and_b32 v95, 0xffff0000, v17
    v_mfma_f32_16x16x32_f16 v[188:191], v[80:83], v[140:143], v[188:191]
    v_lshlrev_b32 v96, 16, v18
    v_and_b32 v97, 0xffff0000, v18
    v_mfma_f32_16x16x32_f16 v[192:195], v[88:91], v[140:143], v[192:195]
    v_lshlrev_b32 v98, 16, v19
    v_and_b32 v99, 0xffff0000, v19
    v_mfma_f32_16x16x32_f16 v[196:199], v[76:79], v[128:131], 0
    v_lshlrev_b32 v100, 16, v20
    v_and_b32 v101, 0xffff0000, v20
    v_mfma_f32_16x16x32_f16 v[200:203], v[84:87], v[128:131], 0
    v_lshlrev_b32 v102, 16, v21
    v_and_b32 v103, 0xffff0000, v21
    v_mfma_f32_16x16x32_f16 v[196:199], v[80:83], v[144:147], v[196:199]
    v_lshlrev_b32 v104, 16, v22
    v_and_b32 v105, 0xffff0000, v22
    v_mfma_f32_16x16x32_f16 v[200:203], v[88:91], v[144:147], v[200:203]
    v_lshlrev_b32 v106, 16, v23
    v_and_b32 v107, 0xffff0000, v23
    v_mfma_f32_16x16x32_f16 v[204:207], v[76:79], v[132:135], 0
    v_lshlrev_b32 v108, 16, v24
    v_and_b32 v109, 0xffff0000, v24
    v_mfma_f32_16x16x32_f16 v[208:211], v[84:87], v[132:135], 0
    v_lshlrev_b32 v110, 16, v25
    v_and_b32 v111, 0xffff0000, v25
    v_mfma_f32_16x16x32_f16 v[204:207], v[80:83], v[148:151], v[204:207]
    v_lshlrev_b32 v112, 16, v26
    v_and_b32 v113, 0xffff0000, v26
    v_mfma_f32_16x16x32_f16 v[208:211], v[88:91], v[148:151], v[208:211]
    v_lshlrev_b32 v114, 16, v27
    v_and_b32 v115, 0xffff0000, v27
    v_mfma_f32_16x16x32_f16 v[212:215], v[76:79], v[136:139], 0
    v_lshlrev_b32 v116, 16, v28
    v_and_b32 v117, 0xffff0000, v28
    v_mfma_f32_16x16x32_f16 v[216:219], v[84:87], v[136:139], 0
    v_lshlrev_b32 v118, 16, v29
    v_and_b32 v119, 0xffff0000, v29
    v_mfma_f32_16x16x32_f16 v[212:215], v[80:83], v[152:155], v[212:215]
    v_lshlrev_b32 v120, 16, v30
    v_and_b32 v121, 0xffff0000, v30
    v_mfma_f32_16x16x32_f16 v[216:219], v[88:91], v[152:155], v[216:219]
    v_lshlrev_b32 v122, 16, v31
    v_and_b32 v123, 0xffff0000, v31
    s_mov_b32 s24, 0x3f803f80
    v_pk_fma_f32 v[92:93], v[188:189], v[32:33], v[92:93]
    v_pk_fma_f32 v[94:95], v[190:191], v[34:35], v[94:95]
    v_pk_fma_f32 v[96:97], v[192:193], v[36:37], v[96:97]
    v_pk_fma_f32 v[98:99], v[194:195], v[38:39], v[98:99]
    v_cvt_pk_bf16_f32 v44, v92, v93
    v_cvt_pk_bf16_f32 v45, v94, v95
    v_cvt_pk_bf16_f32 v46, v96, v97
    v_cvt_pk_bf16_f32 v47, v98, v99
    s_mov_b32 s22, 0
    buffer_store_dwordx4 v[44:47], v4, s[8:11], s22 offen sc1
    v_pk_fma_f32 v[100:101], v[196:197], v[32:33], v[100:101]
    v_pk_fma_f32 v[102:103], v[198:199], v[34:35], v[102:103]
    v_pk_fma_f32 v[104:105], v[200:201], v[36:37], v[104:105]
    v_pk_fma_f32 v[106:107], v[202:203], v[38:39], v[106:107]
    v_cvt_pk_bf16_f32 v48, v100, v101
    v_cvt_pk_bf16_f32 v49, v102, v103
    v_cvt_pk_bf16_f32 v50, v104, v105
    v_cvt_pk_bf16_f32 v51, v106, v107
    s_mov_b32 s22, 20480
    buffer_store_dwordx4 v[48:51], v4, s[8:11], s22 offen sc1
    v_pk_fma_f32 v[108:109], v[204:205], v[32:33], v[108:109]
    v_pk_fma_f32 v[110:111], v[206:207], v[34:35], v[110:111]
    v_pk_fma_f32 v[112:113], v[208:209], v[36:37], v[112:113]
    v_pk_fma_f32 v[114:115], v[210:211], v[38:39], v[114:115]
    v_cvt_pk_bf16_f32 v52, v108, v109
    v_cvt_pk_bf16_f32 v53, v110, v111
    v_cvt_pk_bf16_f32 v54, v112, v113
    v_cvt_pk_bf16_f32 v55, v114, v115
    s_mov_b32 s22, 40960
    buffer_store_dwordx4 v[52:55], v4, s[8:11], s22 offen sc1
    v_pk_fma_f32 v[116:117], v[212:213], v[32:33], v[116:117]
    v_pk_fma_f32 v[118:119], v[214:215], v[34:35], v[118:119]
    v_pk_fma_f32 v[120:121], v[216:217], v[36:37], v[120:121]
    v_pk_fma_f32 v[122:123], v[218:219], v[38:39], v[122:123]
    v_cvt_pk_bf16_f32 v56, v116, v117
    v_cvt_pk_bf16_f32 v57, v118, v119
    v_cvt_pk_bf16_f32 v58, v120, v121
    v_cvt_pk_bf16_f32 v59, v122, v123
    s_mov_b32 s22, 61440
    buffer_store_dwordx4 v[56:59], v4, s[8:11], s22 offen sc1
    v_dot2_f32_bf16 v60, v44, s24, 0
    v_dot2_f32_bf16 v64, v44, v44, 0
    v_dot2_f32_bf16 v61, v48, s24, 0
    v_dot2_f32_bf16 v65, v48, v48, 0
    v_dot2_f32_bf16 v62, v52, s24, 0
    v_dot2_f32_bf16 v66, v52, v52, 0
    v_dot2_f32_bf16 v63, v56, s24, 0
    v_dot2_f32_bf16 v67, v56, v56, 0
    v_dot2_f32_bf16 v60, v45, s24, v60
    v_dot2_f32_bf16 v64, v45, v45, v64
    v_dot2_f32_bf16 v61, v49, s24, v61
    v_dot2_f32_bf16 v65, v49, v49, v65
    v_dot2_f32_bf16 v62, v53, s24, v62
    v_dot2_f32_bf16 v66, v53, v53, v66
    v_dot2_f32_bf16 v63, v57, s24, v63
    v_dot2_f32_bf16 v67, v57, v57, v67
    v_dot2_f32_bf16 v60, v46, s24, v60
    v_dot2_f32_bf16 v64, v46, v46, v64
    v_dot2_f32_bf16 v61, v50, s24, v61
    v_dot2_f32_bf16 v65, v50, v50, v65
    v_dot2_f32_bf16 v62, v54, s24, v62
    v_dot2_f32_bf16 v66, v54, v54, v66
    v_dot2_f32_bf16 v63, v58, s24, v63
    v_dot2_f32_bf16 v67, v58, v58, v67
    v_dot2_f32_bf16 v60, v47, s24, v60
    v_dot2_f32_bf16 v64, v47, v47, v64
    v_dot2_f32_bf16 v61, v51, s24, v61
    v_dot2_f32_bf16 v65, v51, v51, v65
    v_dot2_f32_bf16 v62, v55, s24, v62
    v_dot2_f32_bf16 v66, v55, v55, v66
    v_dot2_f32_bf16 v63, v59, s24, v63
    v_dot2_f32_bf16 v67, v59, v59, v67
    v_permlane32_swap_b32 v60, v62
    s_nop 0
    v_permlane32_swap_b32 v61, v63
    v_permlane32_swap_b32 v64, v66
    v_permlane32_swap_b32 v65, v67
    v_add_f32 v60, v60, v62
    v_add_f32 v61, v61, v63
    v_add_f32 v64, v64, v66
    v_add_f32 v65, v65, v67
    v_permlane16_swap_b32 v60, v61
    s_nop 0
    v_permlane16_swap_b32 v64, v65
    v_add_f32 v12, v60, v61
    v_add_f32 v13, v64, v65
    buffer_store_dwordx2 v[12:13], v5, s[8:11], 0 offen sc1
    s_waitcnt vmcnt(0)
KF_S3_BAR:
    s_barrier
    s_cmp_lg_u32 s20, 0
    s_cbranch_scc1 KF_S3_SIG
    v_mov_b32 v8, s34
    v_mov_b32 v9, 1
    s_mov_b64 s[26:27], exec
    s_mov_b64 exec, 1
    buffer_store_dword v9, v8, s[8:11], 0 offen sc1
    s_mov_b64 exec, s[26:27]
KF_S3_SIG:
    s_cmp_ge_u32 s20, s30
    s_cbranch_scc1 KF_P4
    s_mov_b32 s60, 0
    s_mov_b32 s60, 0
    buffer_load_dwordx4 a[0:3], v254, s[8:11], s60 offen offset:0
    buffer_load_dwordx4 a[4:7], v254, s[8:11], s60 offen offset:1024
    buffer_load_dwordx4 a[8:11], v254, s[8:11], s60 offen offset:2048
    s_mov_b32 s60, 3072
    buffer_load_dwordx4 a[12:15], v254, s[8:11], s60 offen offset:0
    buffer_load_dwordx4 a[16:19], v254, s[8:11], s60 offen offset:1024
    buffer_load_dwordx4 a[20:23], v254, s[8:11], s60 offen offset:2048
    s_mov_b32 s60, 6144
    buffer_load_dwordx4 a[24:27], v254, s[8:11], s60 offen offset:0
    buffer_load_dwordx4 a[28:31], v254, s[8:11], s60 offen offset:1024
    buffer_load_dwordx4 a[32:35], v254, s[8:11], s60 offen offset:2048
    s_mov_b32 s60, 9216
    buffer_load_dwordx4 a[36:39], v254, s[8:11], s60 offen offset:0
    buffer_load_dwordx4 a[40:43], v254, s[8:11], s60 offen offset:1024
    buffer_load_dwordx4 a[44:47], v254, s[8:11], s60 offen offset:2048
    s_mov_b32 s60, 12288
    buffer_load_dwordx4 a[48:51], v254, s[8:11], s60 offen offset:0
    buffer_load_dwordx4 a[52:55], v254, s[8:11], s60 offen offset:1024
    buffer_load_dwordx4 a[56:59], v254, s[8:11], s60 offen offset:2048
    s_mov_b32 s60, 15360
    buffer_load_dwordx4 a[60:63], v254, s[8:11], s60 offen offset:0
    buffer_load_dwordx4 a[64:67], v254, s[8:11], s60 offen offset:1024
    buffer_load_dwordx4 a[68:71], v254, s[8:11], s60 offen offset:2048
    s_mov_b32 s60, 18432
    buffer_load_dwordx4 a[72:75], v254, s[8:11], s60 offen offset:0
    buffer_load_dwordx4 a[76:79], v254, s[8:11], s60 offen offset:1024
    buffer_load_dwordx4 a[80:83], v254, s[8:11], s60 offen offset:2048
    s_mov_b32 s60, 21504
    buffer_load_dwordx4 a[84:87], v254, s[8:11], s60 offen offset:0
    buffer_load_dwordx4 a[88:91], v254, s[8:11], s60 offen offset:1024
    buffer_load_dwordx4 a[92:95], v254, s[8:11], s60 offen offset:2048
    s_mov_b32 s60, 24576
    buffer_load_dwordx4 a[96:99], v254, s[8:11], s60 offen offset:0
    buffer_load_dwordx4 a[100:103], v254, s[8:11], s60 offen offset:1024
    buffer_load_dwordx4 a[104:107], v254, s[8:11], s60 offen offset:2048
    s_mov_b32 s60, 27648
    buffer_load_dwordx4 a[108:111], v254, s[8:11], s60 offen offset:0
    buffer_load_dwordx4 a[112:115], v254, s[8:11], s60 offen offset:1024
    buffer_load_dwordx4 a[116:119], v254, s[8:11], s60 offen offset:2048
    s_mov_b32 s60, 30720
    buffer_load_dwordx4 a[120:123], v254, s[8:11], s60 offen offset:0
    buffer_load_dwordx4 a[124:127], v254, s[8:11], s60 offen offset:1024
    buffer_load_dwordx4 a[128:131], v254, s[8:11], s60 offen offset:2048
    s_mov_b32 s60, 33792
    buffer_load_dwordx4 a[132:135], v254, s[8:11], s60 offen offset:0
    buffer_load_dwordx4 a[136:139], v254, s[8:11], s60 offen offset:1024
    buffer_load_dwordx4 a[140:143], v254, s[8:11], s60 offen offset:2048
KF_P4:
    v_min_u32 v10, 191, v0
    s_mul_i32 s22, s53, 12
    v_lshrrev_b32 v11, 4, v10
    v_add_u32 v11, s22, v11
    v_lshrrev_b32 v12, 3, v11
    v_mul_u32_u24 v12, 20480, v12
    v_bfe_u32 v13, v11, 1, 2
    v_lshl_add_u32 v12, v13, 8, v12
    v_and_b32 v13, 1, v11
    v_lshl_add_u32 v12, v13, 3, v12
    v_and_b32 v13, 15, v10
    v_lshl_add_u32 v12, v13, 4, v12
    v_add_u32 v11, 0xf00000, v12
    s_lshl_b32 s22, s52, 3
    s_lshl_b32 s23, s20, 1
    s_add_u32 s22, s22, s23
    s_mul_i32 s22, s22, 20480
    s_add_u32 s22, s22, 0x700000
    v_add_u32 v4, s22, v255
    v_add_u32 v5, 19456, v4
    s_mul_i32 s22, s52, 20480
    s_add_u32 s22, s22, 0xa00000
    s_lshr_b32 s23, s20, 1
    s_mul_i32 s23, s23, 10240
    s_add_u32 s22, s22, s23
    s_and_b32 s23, s20, 1
    s_lshl_b32 s23, s23, 8
    s_add_u32 s22, s22, s23
    v_lshrrev_b32 v7, 5, v3
    v_mul_u32_u24 v7, 5120, v7
    v_and_b32 v12, 31, v3
    v_lshl_add_u32 v7, v12, 3, v7
    v_add_u32 v7, s22, v7
    v_add_u32 v6, 4096, v7
    s_lshl_b32 s23, s20, 8
    v_lshl_add_u32 v15, v12, 3, s23
    s_lshl_b32 s21, s20, 11
    s_mul_i32 s22, s55, 48
    s_mul_i32 s23, s20, 12
    s_add_u32 s22, s22, s23
    s_mul_i32 s22, s22, 5120
    s_add_u32 s22, s22, 0x1000000
    v_add_u32 v253, s22, v255
    v_add_u32 v13, 65536, v255
    v_add_u32 v14, 131072, v255
    s_movk_i32 s61, 0
    buffer_load_dwordx2 v[196:197], v11, s[8:11], s61 offen offset:0
    s_movk_i32 s61, 0
    buffer_load_dwordx2 v[198:199], v11, s[8:11], s61 offen offset:1024
    s_movk_i32 s61, 0
    buffer_load_dwordx2 v[200:201], v11, s[8:11], s61 offen offset:2048
    s_movk_i32 s61, 0
    buffer_load_dwordx2 v[202:203], v11, s[8:11], s61 offen offset:3072
    s_movk_i32 s61, 4096
    buffer_load_dwordx2 v[204:205], v11, s[8:11], s61 offen offset:0
    s_movk_i32 s61, 4096
    buffer_load_dwordx2 v[206:207], v11, s[8:11], s61 offen offset:1024
    s_movk_i32 s61, 4096
    buffer_load_dwordx2 v[208:209], v11, s[8:11], s61 offen offset:2048
    s_movk_i32 s61, 4096
    buffer_load_dwordx2 v[210:211], v11, s[8:11], s61 offen offset:3072
    s_movk_i32 s61, 8192
    buffer_load_dwordx2 v[212:213], v11, s[8:11], s61 offen offset:0
    s_movk_i32 s61, 8192
    buffer_load_dwordx2 v[214:215], v11, s[8:11], s61 offen offset:1024
    s_movk_i32 s61, 8192
    buffer_load_dwordx2 v[216:217], v11, s[8:11], s61 offen offset:2048
    s_movk_i32 s61, 8192
    buffer_load_dwordx2 v[218:219], v11, s[8:11], s61 offen offset:3072
    s_movk_i32 s61, 12288
    buffer_load_dwordx2 v[220:221], v11, s[8:11], s61 offen offset:0
    s_movk_i32 s61, 12288
    buffer_load_dwordx2 v[222:223], v11, s[8:11], s61 offen offset:1024
    s_movk_i32 s61, 12288
    buffer_load_dwordx2 v[224:225], v11, s[8:11], s61 offen offset:2048
    s_movk_i32 s61, 12288
    buffer_load_dwordx2 v[226:227], v11, s[8:11], s61 offen offset:3072
    s_movk_i32 s61, 16384
    buffer_load_dwordx2 v[228:229], v11, s[8:11], s61 offen offset:0
    s_movk_i32 s61, 16384
    buffer_load_dwordx2 v[230:231], v11, s[8:11], s61 offen offset:1024
    s_movk_i32 s61, 16384
    buffer_load_dwordx2 v[232:233], v11, s[8:11], s61 offen offset:2048
    s_movk_i32 s61, 16384
    buffer_load_dwordx2 v[234:235], v11, s[8:11], s61 offen offset:3072
    s_mul_i32 s22, s52, 4352
    s_add_u32 s22, s22, 0x40000
    s_cmp_lg_u32 s20, 0
    s_cbranch_scc1 KF_W3_DONE
    v_min_u32 v8, 15, v3
    v_lshl_add_u32 v8, v8, 2, s22
    s_mov_b32 s28, 0
KF_W3_LOOP:
    buffer_load_dword v250, v8, s[8:11], 0 offen sc1
    s_add_u32 s28, s28, 1
    s_waitcnt vmcnt(0)
    v_cmp_eq_u32 vcc, 0, v250
    s_cmp_ge_u32 s28, 200000
    s_cbranch_scc1 KF_W3_DONE
    s_cbranch_vccz KF_W3_DONE
    s_sleep 2
    s_branch KF_W3_LOOP
KF_W3_DONE:
    s_barrier
    s_add_u32 m0, s21, 0
    s_movk_i32 s62, 0
    buffer_load_dwordx4 v4, s[8:11], s62 offen sc1 lds
    buffer_load_dwordx4 v5, s[8:11], s62 offen offset:1024 sc1 lds
    s_add_u32 m0, s21, 8192
    s_movk_i32 s62, 1024
    buffer_load_dwordx4 v4, s[8:11], s62 offen sc1 lds
    buffer_load_dwordx4 v5, s[8:11], s62 offen offset:1024 sc1 lds
    s_add_u32 m0, s21, 16384
    s_movk_i32 s62, 2048
    buffer_load_dwordx4 v4, s[8:11], s62 offen sc1 lds
    buffer_load_dwordx4 v5, s[8:11], s62 offen offset:1024 sc1 lds
    s_add_u32 m0, s21, 24576
    s_movk_i32 s62, 3072
    buffer_load_dwordx4 v4, s[8:11], s62 offen sc1 lds
    buffer_load_dwordx4 v5, s[8:11], s62 offen offset:1024 sc1 lds
    s_add_u32 m0, s21, 32768
    s_movk_i32 s62, 4096
    buffer_load_dwordx4 v4, s[8:11], s62 offen sc1 lds
    buffer_load_dwordx4 v5, s[8:11], s62 offen offset:1024 sc1 lds
    s_add_u32 m0, s21, 40960
    s_movk_i32 s62, 5120
    buffer_load_dwordx4 v4, s[8:11], s62 offen sc1 lds
    buffer_load_dwordx4 v5, s[8:11], s62 offen offset:1024 sc1 lds
    s_waitcnt vmcnt(8)
    s_barrier
    ds_read_b128 v[112:115], v255 offset:0
    ds_read_b128 v[116:119], v255 offset:1024
    ds_read_b128 v[120:123], v255 offset:2048
    ds_read_b128 v[124:127], v255 offset:3072
    ds_read_b128 v[128:131], v255 offset:4096
    ds_read_b128 v[132:135], v255 offset:5120
    ds_read_b128 v[136:139], v255 offset:6144
    ds_read_b128 v[140:143], v255 offset:7168
    s_waitcnt lgkmcnt(7)
    v_mfma_f32_16x16x32_bf16 v[16:19], a[0:3], v[112:115], 0
    ds_read_b128 v[144:147], v255 offset:8192
    v_mfma_f32_16x16x32_bf16 v[20:23], a[4:7], v[112:115], 0
    s_add_u32 m0, s21, 49152
    s_movk_i32 s62, 6144
    buffer_load_dwordx4 v4, s[8:11], s62 offen sc1 lds
    v_mfma_f32_16x16x32_bf16 v[24:27], a[8:11], v[112:115], 0
    s_waitcnt lgkmcnt(7)
    v_mfma_f32_16x16x32_bf16 v[28:31], a[0:3], v[116:119], 0
    ds_read_b128 v[148:151], v255 offset:9216
    v_mfma_f32_16x16x32_bf16 v[32:35], a[4:7], v[116:119], 0
    s_add_u32 m0, s21, 49152
    s_nop 0
    buffer_load_dwordx4 v5, s[8:11], s62 offen offset:1024 sc1 lds
    v_mfma_f32_16x16x32_bf16 v[36:39], a[8:11], v[116:119], 0
    s_waitcnt lgkmcnt(7)
    v_mfma_f32_16x16x32_bf16 v[40:43], a[0:3], v[120:123], 0
    ds_read_b128 v[152:155], v255 offset:10240
    v_mfma_f32_16x16x32_bf16 v[44:47], a[4:7], v[120:123], 0
    s_add_u32 m0, s21, 57344
    s_movk_i32 s62, 7168
    buffer_load_dwordx4 v4, s[8:11], s62 offen sc1 lds
    v_mfma_f32_16x16x32_bf16 v[48:51], a[8:11], v[120:123], 0
    s_waitcnt lgkmcnt(7)
    v_mfma_f32_16x16x32_bf16 v[52:55], a[0:3], v[124:127], 0
    ds_read_b128 v[156:159], v255 offset:11264
    v_mfma_f32_16x16x32_bf16 v[56:59], a[4:7], v[124:127], 0
    s_add_u32 m0, s21, 57344
    s_nop 0
    buffer_load_dwordx4 v5, s[8:11], s62 offen offset:1024 sc1 lds
    v_mfma_f32_16x16x32_bf16 v[60:63], a[8:11], v[124:127], 0
    s_waitcnt lgkmcnt(7)
    v_mfma_f32_16x16x32_bf16 v[64:67], a[0:3], v[128:131], 0
    ds_read_b128 v[160:163], v255 offset:12288
    v_mfma_f32_16x16x32_bf16 v[68:71], a[4:7], v[128:131], 0
    s_add_u32 m0, s21, 65536
    s_movk_i32 s62, 8192
    buffer_load_dwordx4 v4, s[8:11], s62 offen sc1 lds
    v_mfma_f32_16x16x32_bf16 v[72:75], a[8:11], v[128:131], 0
    s_waitcnt lgkmcnt(7)
    v_mfma_f32_16x16x32_bf16 v[76:79], a[0:3], v[132:135], 0
    ds_read_b128 v[164:167], v255 offset:13312
    v_mfma_f32_16x16x32_bf16 v[80:83], a[4:7], v[132:135], 0
    s_add_u32 m0, s21, 65536
    s_nop 0
    buffer_load_dwordx4 v5, s[8:11], s62 offen offset:1024 sc1 lds
    v_mfma_f32_16x16x32_bf16 v[84:87], a[8:11], v[132:135], 0
    s_waitcnt lgkmcnt(7)
    v_mfma_f32_16x16x32_bf16 v[88:91], a[0:3], v[136:139], 0
    ds_read_b128 v[168:171], v255 offset:14336
    v_mfma_f32_16x16x32_bf16 v[92:95], a[4:7], v[136:139], 0
    v_mfma_f32_16x16x32_bf16 v[96:99], a[8:11], v[136:139], 0
    s_waitcnt lgkmcnt(7)
    v_mfma_f32_16x16x32_bf16 v[100:103], a[0:3], v[140:143], 0
    ds_read_b128 v[172:175], v255 offset:15360
    v_mfma_f32_16x16x32_bf16 v[104:107], a[4:7], v[140:143], 0
    v_mfma_f32_16x16x32_bf16 v[108:111], a[8:11], v[140:143], 0
    s_waitcnt vmcnt(10)
    s_barrier
    s_waitcnt lgkmcnt(7)
    v_mfma_f32_16x16x32_bf16 v[16:19], a[12:15], v[144:147], v[16:19]
    ds_read_b128 v[112:115], v255 offset:16384
    v_mfma_f32_16x16x32_bf16 v[20:23], a[16:19], v[144:147], v[20:23]
    s_add_u32 m0, s21, 73728
    s_movk_i32 s62, 9216
    buffer_load_dwordx4 v4, s[8:11], s62 offen sc1 lds
    v_mfma_f32_16x16x32_bf16 v[24:27], a[20:23], v[144:147], v[24:27]
    s_waitcnt lgkmcnt(7)
    v_mfma_f32_16x16x32_bf16 v[28:31], a[12:15], v[148:151], v[28:31]
    ds_read_b128 v[116:119], v255 offset:17408
    v_mfma_f32_16x16x32_bf16 v[32:35], a[16:19], v[148:151], v[32:35]
    s_add_u32 m0, s21, 73728
    s_nop 0
    buffer_load_dwordx4 v5, s[8:11], s62 offen offset:1024 sc1 lds
    v_mfma_f32_16x16x32_bf16 v[36:39], a[20:23], v[148:151], v[36:39]
    s_waitcnt lgkmcnt(7)
    v_mfma_f32_16x16x32_bf16 v[40:43], a[12:15], v[152:155], v[40:43]
    ds_read_b128 v[120:123], v255 offset:18432
    v_mfma_f32_16x16x32_bf16 v[44:47], a[16:19], v[152:155], v[44:47]
    s_add_u32 m0, s21, 81920
    s_movk_i32 s62, 10240
    buffer_load_dwordx4 v4, s[8:11], s62 offen sc1 lds
    v_mfma_f32_16x16x32_bf16 v[48:51], a[20:23], v[152:155], v[48:51]
    s_waitcnt lgkmcnt(7)
    v_mfma_f32_16x16x32_bf16 v[52:55], a[12:15], v[156:159], v[52:55]
    ds_read_b128 v[124:127], v255 offset:19456
    v_mfma_f32_16x16x32_bf16 v[56:59], a[16:19], v[156:159], v[56:59]
    s_add_u32 m0, s21, 81920
    s_nop 0
    buffer_load_dwordx4 v5, s[8:11], s62 offen offset:1024 sc1 lds
    v_mfma_f32_16x16x32_bf16 v[60:63], a[20:23], v[156:159], v[60:63]
    s_waitcnt lgkmcnt(7)
    v_mfma_f32_16x16x32_bf16 v[64:67], a[12:15], v[160:163], v[64:67]
    ds_read_b128 v[128:131], v255 offset:20480
    v_mfma_f32_16x16x32_bf16 v[68:71], a[16:19], v[160:163], v[68:71]
    s_add_u32 m0, s21, 90112
    s_movk_i32 s62, 11264
    buffer_load_dwordx4 v4, s[8:11], s62 offen sc1 lds
    v_mfma_f32_16x16x32_bf16 v[72:75], a[20:23], v[160:163], v[72:75]
    s_waitcnt lgkmcnt(7)
    v_mfma_f32_16x16x32_bf16 v[76:79], a[12:15], v[164:167], v[76:79]
    ds_read_b128 v[132:135], v255 offset:21504
    v_mfma_f32_16x16x32_bf16 v[80:83], a[16:19], v[164:167], v[80:83]
    s_add_u32 m0, s21, 90112
    s_nop 0
    buffer_load_dwordx4 v5, s[8:11], s62 offen offset:1024 sc1 lds
    v_mfma_f32_16x16x32_bf16 v[84:87], a[20:23], v[164:167], v[84:87]
    s_waitcnt lgkmcnt(7)
    v_mfma_f32_16x16x32_bf16 v[88:91], a[12:15], v[168:171], v[88:91]
    ds_read_b128 v[136:139], v255 offset:22528
    v_mfma_f32_16x16x32_bf16 v[92:95], a[16:19], v[168:171], v[92:95]
    v_mfma_f32_16x16x32_bf16 v[96:99], a[20:23], v[168:171], v[96:99]
    s_waitcnt lgkmcnt(7)
    v_mfma_f32_16x16x32_bf16 v[100:103], a[12:15], v[172:175], v[100:103]
    ds_read_b128 v[140:143], v255 offset:23552
    v_mfma_f32_16x16x32_bf16 v[104:107], a[16:19], v[172:175], v[104:107]
    v_mfma_f32_16x16x32_bf16 v[108:111], a[20:23], v[172:175], v[108:111]
    s_waitcnt lgkmcnt(7)
    v_mfma_f32_16x16x32_bf16 v[16:19], a[24:27], v[112:115], v[16:19]
    ds_read_b128 v[144:147], v255 offset:24576
    v_mfma_f32_16x16x32_bf16 v[20:23], a[28:31], v[112:115], v[20:23]
    s_add_u32 m0, s21, 98304
    s_movk_i32 s62, 12288
    buffer_load_dwordx4 v4, s[8:11], s62 offen sc1 lds
    v_mfma_f32_16x16x32_bf16 v[24:27], a[32:35], v[112:115], v[24:27]
    s_waitcnt lgkmcnt(7)
    v_mfma_f32_16x16x32_bf16 v[28:31], a[24:27], v[116:119], v[28:31]
    ds_read_b128 v[148:151], v255 offset:25600
    v_mfma_f32_16x16x32_bf16 v[32:35], a[28:31], v[116:119], v[32:35]
    s_add_u32 m0, s21, 98304
    s_nop 0
    buffer_load_dwordx4 v5, s[8:11], s62 offen offset:1024 sc1 lds
    v_mfma_f32_16x16x32_bf16 v[36:39], a[32:35], v[116:119], v[36:39]
    s_waitcnt lgkmcnt(7)
    v_mfma_f32_16x16x32_bf16 v[40:43], a[24:27], v[120:123], v[40:43]
    ds_read_b128 v[152:155], v255 offset:26624
    v_mfma_f32_16x16x32_bf16 v[44:47], a[28:31], v[120:123], v[44:47]
    s_add_u32 m0, s21, 106496
    s_movk_i32 s62, 13312
    buffer_load_dwordx4 v4, s[8:11], s62 offen sc1 lds
    v_mfma_f32_16x16x32_bf16 v[48:51], a[32:35], v[120:123], v[48:51]
    s_waitcnt lgkmcnt(7)
    v_mfma_f32_16x16x32_bf16 v[52:55], a[24:27], v[124:127], v[52:55]
    ds_read_b128 v[156:159], v255 offset:27648
    v_mfma_f32_16x16x32_bf16 v[56:59], a[28:31], v[124:127], v[56:59]
    s_add_u32 m0, s21, 106496
    s_nop 0
    buffer_load_dwordx4 v5, s[8:11], s62 offen offset:1024 sc1 lds
    v_mfma_f32_16x16x32_bf16 v[60:63], a[32:35], v[124:127], v[60:63]
    s_waitcnt lgkmcnt(7)
    v_mfma_f32_16x16x32_bf16 v[64:67], a[24:27], v[128:131], v[64:67]
    ds_read_b128 v[160:163], v255 offset:28672
    v_mfma_f32_16x16x32_bf16 v[68:71], a[28:31], v[128:131], v[68:71]
    s_add_u32 m0, s21, 114688
    s_movk_i32 s62, 14336
    buffer_load_dwordx4 v4, s[8:11], s62 offen sc1 lds
    v_mfma_f32_16x16x32_bf16 v[72:75], a[32:35], v[128:131], v[72:75]
    s_waitcnt lgkmcnt(7)
    v_mfma_f32_16x16x32_bf16 v[76:79], a[24:27], v[132:135], v[76:79]
    ds_read_b128 v[164:167], v255 offset:29696
    v_mfma_f32_16x16x32_bf16 v[80:83], a[28:31], v[132:135], v[80:83]
    s_add_u32 m0, s21, 114688
    s_nop 0
    buffer_load_dwordx4 v5, s[8:11], s62 offen offset:1024 sc1 lds
    v_mfma_f32_16x16x32_bf16 v[84:87], a[32:35], v[132:135], v[84:87]
    s_waitcnt lgkmcnt(7)
    v_mfma_f32_16x16x32_bf16 v[88:91], a[24:27], v[136:139], v[88:91]
    ds_read_b128 v[168:171], v255 offset:30720
    v_mfma_f32_16x16x32_bf16 v[92:95], a[28:31], v[136:139], v[92:95]
    v_mfma_f32_16x16x32_bf16 v[96:99], a[32:35], v[136:139], v[96:99]
    s_waitcnt lgkmcnt(7)
    v_mfma_f32_16x16x32_bf16 v[100:103], a[24:27], v[140:143], v[100:103]
    ds_read_b128 v[172:175], v255 offset:31744
    v_mfma_f32_16x16x32_bf16 v[104:107], a[28:31], v[140:143], v[104:107]
    v_mfma_f32_16x16x32_bf16 v[108:111], a[32:35], v[140:143], v[108:111]
    s_waitcnt vmcnt(14)
    s_barrier
    s_waitcnt lgkmcnt(7)
    v_mfma_f32_16x16x32_bf16 v[16:19], a[36:39], v[144:147], v[16:19]
    ds_read_b128 v[112:115], v255 offset:32768
    v_mfma_f32_16x16x32_bf16 v[20:23], a[40:43], v[144:147], v[20:23]
    s_add_u32 m0, s21, 122880
    s_movk_i32 s62, 15360
    buffer_load_dwordx4 v4, s[8:11], s62 offen sc1 lds
    v_mfma_f32_16x16x32_bf16 v[24:27], a[44:47], v[144:147], v[24:27]
    s_waitcnt lgkmcnt(7)
    v_mfma_f32_16x16x32_bf16 v[28:31], a[36:39], v[148:151], v[28:31]
    ds_read_b128 v[116:119], v255 offset:33792
    v_mfma_f32_16x16x32_bf16 v[32:35], a[40:43], v[148:151], v[32:35]
    s_add_u32 m0, s21, 122880
    s_nop 0
    buffer_load_dwordx4 v5, s[8:11], s62 offen offset:1024 sc1 lds
    v_mfma_f32_16x16x32_bf16 v[36:39], a[44:47], v[148:151], v[36:39]
    s_waitcnt lgkmcnt(7)
    v_mfma_f32_16x16x32_bf16 v[40:43], a[36:39], v[152:155], v[40:43]
    ds_read_b128 v[120:123], v255 offset:34816
    v_mfma_f32_16x16x32_bf16 v[44:47], a[40:43], v[152:155], v[44:47]
    s_add_u32 m0, s21, 131072
    s_movk_i32 s62, 16384
    buffer_load_dwordx4 v4, s[8:11], s62 offen sc1 lds
    v_mfma_f32_16x16x32_bf16 v[48:51], a[44:47], v[152:155], v[48:51]
    s_waitcnt lgkmcnt(7)
    v_mfma_f32_16x16x32_bf16 v[52:55], a[36:39], v[156:159], v[52:55]
    ds_read_b128 v[124:127], v255 offset:35840
    v_mfma_f32_16x16x32_bf16 v[56:59], a[40:43], v[156:159], v[56:59]
    s_add_u32 m0, s21, 131072
    s_nop 0
    buffer_load_dwordx4 v5, s[8:11], s62 offen offset:1024 sc1 lds
    v_mfma_f32_16x16x32_bf16 v[60:63], a[44:47], v[156:159], v[60:63]
    s_waitcnt lgkmcnt(7)
    v_mfma_f32_16x16x32_bf16 v[64:67], a[36:39], v[160:163], v[64:67]
    ds_read_b128 v[128:131], v255 offset:36864
    v_mfma_f32_16x16x32_bf16 v[68:71], a[40:43], v[160:163], v[68:71]
    s_add_u32 m0, s21, 139264
    s_movk_i32 s62, 17408
    buffer_load_dwordx4 v4, s[8:11], s62 offen sc1 lds
    v_mfma_f32_16x16x32_bf16 v[72:75], a[44:47], v[160:163], v[72:75]
    s_waitcnt lgkmcnt(7)
    v_mfma_f32_16x16x32_bf16 v[76:79], a[36:39], v[164:167], v[76:79]
    ds_read_b128 v[132:135], v255 offset:37888
    v_mfma_f32_16x16x32_bf16 v[80:83], a[40:43], v[164:167], v[80:83]
    s_add_u32 m0, s21, 139264
    s_nop 0
    buffer_load_dwordx4 v5, s[8:11], s62 offen offset:1024 sc1 lds
    v_mfma_f32_16x16x32_bf16 v[84:87], a[44:47], v[164:167], v[84:87]
    s_waitcnt lgkmcnt(7)
    v_mfma_f32_16x16x32_bf16 v[88:91], a[36:39], v[168:171], v[88:91]
    ds_read_b128 v[136:139], v255 offset:38912
    v_mfma_f32_16x16x32_bf16 v[92:95], a[40:43], v[168:171], v[92:95]
    v_mfma_f32_16x16x32_bf16 v[96:99], a[44:47], v[168:171], v[96:99]
    s_waitcnt lgkmcnt(7)
    v_mfma_f32_16x16x32_bf16 v[100:103], a[36:39], v[172:175], v[100:103]
    ds_read_b128 v[140:143], v255 offset:39936
    v_mfma_f32_16x16x32_bf16 v[104:107], a[40:43], v[172:175], v[104:107]
    v_mfma_f32_16x16x32_bf16 v[108:111], a[44:47], v[172:175], v[108:111]
    s_waitcnt vmcnt(36)
    s_waitcnt lgkmcnt(7)
    v_mfma_f32_16x16x32_bf16 v[16:19], a[48:51], v[112:115], v[16:19]
    ds_read_b128 v[144:147], v255 offset:40960
    v_mfma_f32_16x16x32_bf16 v[20:23], a[52:55], v[112:115], v[20:23]
    s_add_u32 m0, s21, 147456
    s_movk_i32 s62, 18432
    buffer_load_dwordx4 v4, s[8:11], s62 offen sc1 lds
    v_mfma_f32_16x16x32_bf16 v[24:27], a[56:59], v[112:115], v[24:27]
    v_add_f32 v196, v196, v216
    s_waitcnt lgkmcnt(7)
    v_mfma_f32_16x16x32_bf16 v[28:31], a[48:51], v[116:119], v[28:31]
    ds_read_b128 v[148:151], v255 offset:41984
    v_mfma_f32_16x16x32_bf16 v[32:35], a[52:55], v[116:119], v[32:35]
    s_add_u32 m0, s21, 147456
    s_nop 0
    buffer_load_dwordx4 v5, s[8:11], s62 offen offset:1024 sc1 lds
    v_mfma_f32_16x16x32_bf16 v[36:39], a[56:59], v[116:119], v[36:39]
    v_add_f32 v197, v197, v217
    s_waitcnt lgkmcnt(7)
    v_mfma_f32_16x16x32_bf16 v[40:43], a[48:51], v[120:123], v[40:43]
    ds_read_b128 v[152:155], v255 offset:43008
    v_mfma_f32_16x16x32_bf16 v[44:47], a[52:55], v[120:123], v[44:47]
    s_add_u32 m0, s21, 155648
    s_movk_i32 s62, 19456
    buffer_load_dwordx4 v4, s[8:11], s62 offen sc1 lds
    v_mfma_f32_16x16x32_bf16 v[48:51], a[56:59], v[120:123], v[48:51]
    v_add_f32 v198, v198, v218
    s_waitcnt lgkmcnt(7)
    v_mfma_f32_16x16x32_bf16 v[52:55], a[48:51], v[124:127], v[52:55]
    ds_read_b128 v[156:159], v255 offset:44032
    v_mfma_f32_16x16x32_bf16 v[56:59], a[52:55], v[124:127], v[56:59]
    s_add_u32 m0, s21, 155648
    s_nop 0
    buffer_load_dwordx4 v5, s[8:11], s62 offen offset:1024 sc1 lds
    v_mfma_f32_16x16x32_bf16 v[60:63], a[56:59], v[124:127], v[60:63]
    v_add_f32 v199, v199, v219
    s_waitcnt lgkmcnt(7)
    v_mfma_f32_16x16x32_bf16 v[64:67], a[48:51], v[128:131], v[64:67]
    ds_read_b128 v[160:163], v255 offset:45056
    v_mfma_f32_16x16x32_bf16 v[68:71], a[52:55], v[128:131], v[68:71]
    s_mov_b32 s60, 36864
    buffer_load_dwordx4 a[144:147], v254, s[8:11], s60 offen offset:0
    v_mfma_f32_16x16x32_bf16 v[72:75], a[56:59], v[128:131], v[72:75]
    v_add_f32 v200, v200, v220
    s_waitcnt lgkmcnt(7)
    v_mfma_f32_16x16x32_bf16 v[76:79], a[48:51], v[132:135], v[76:79]
    ds_read_b128 v[164:167], v255 offset:46080
    v_mfma_f32_16x16x32_bf16 v[80:83], a[52:55], v[132:135], v[80:83]
    buffer_load_dwordx4 a[148:151], v254, s[8:11], s60 offen offset:1024
    v_mfma_f32_16x16x32_bf16 v[84:87], a[56:59], v[132:135], v[84:87]
    v_add_f32 v201, v201, v221
    s_waitcnt lgkmcnt(7)
    v_mfma_f32_16x16x32_bf16 v[88:91], a[48:51], v[136:139], v[88:91]
    ds_read_b128 v[168:171], v255 offset:47104
    v_mfma_f32_16x16x32_bf16 v[92:95], a[52:55], v[136:139], v[92:95]
    buffer_load_dwordx4 a[152:155], v254, s[8:11], s60 offen offset:2048
    v_mfma_f32_16x16x32_bf16 v[96:99], a[56:59], v[136:139], v[96:99]
    v_add_f32 v202, v202, v222
    s_waitcnt lgkmcnt(7)
    v_mfma_f32_16x16x32_bf16 v[100:103], a[48:51], v[140:143], v[100:103]
    ds_read_b128 v[172:175], v255 offset:48128
    v_mfma_f32_16x16x32_bf16 v[104:107], a[52:55], v[140:143], v[104:107]
    v_add_f32 v203, v203, v223
    v_mfma_f32_16x16x32_bf16 v[108:111], a[56:59], v[140:143], v[108:111]
    v_add_f32 v204, v204, v224
    s_waitcnt lgkmcnt(7)
    v_mfma_f32_16x16x32_bf16 v[16:19], a[60:63], v[144:147], v[16:19]
    ds_read_b128 v[112:115], v255 offset:49152
    v_mfma_f32_16x16x32_bf16 v[20:23], a[64:67], v[144:147], v[20:23]
    buffer_load_dwordx2 v[176:177], v7, s[8:11], 0 offen offset:0 sc1
    v_mfma_f32_16x16x32_bf16 v[24:27], a[68:71], v[144:147], v[24:27]
    v_add_f32 v205, v205, v225
    s_waitcnt lgkmcnt(7)
    v_mfma_f32_16x16x32_bf16 v[28:31], a[60:63], v[148:151], v[28:31]
    ds_read_b128 v[116:119], v255 offset:50176
    v_mfma_f32_16x16x32_bf16 v[32:35], a[64:67], v[148:151], v[32:35]
    buffer_load_dwordx2 v[178:179], v7, s[8:11], 0 offen offset:512 sc1
    v_mfma_f32_16x16x32_bf16 v[36:39], a[68:71], v[148:151], v[36:39]
    v_add_f32 v206, v206, v226
    s_waitcnt lgkmcnt(7)
    v_mfma_f32_16x16x32_bf16 v[40:43], a[60:63], v[152:155], v[40:43]
    ds_read_b128 v[120:123], v255 offset:51200
    v_mfma_f32_16x16x32_bf16 v[44:47], a[64:67], v[152:155], v[44:47]
    buffer_load_dwordx2 v[180:181], v7, s[8:11], 0 offen offset:1024 sc1
    v_mfma_f32_16x16x32_bf16 v[48:51], a[68:71], v[152:155], v[48:51]
    v_add_f32 v207, v207, v227
    s_waitcnt lgkmcnt(7)
    v_mfma_f32_16x16x32_bf16 v[52:55], a[60:63], v[156:159], v[52:55]
    ds_read_b128 v[124:127], v255 offset:52224
    v_mfma_f32_16x16x32_bf16 v[56:59], a[64:67], v[156:159], v[56:59]
    buffer_load_dwordx2 v[182:183], v7, s[8:11], 0 offen offset:1536 sc1
    v_mfma_f32_16x16x32_bf16 v[60:63], a[68:71], v[156:159], v[60:63]
    v_add_f32 v208, v208, v228
    s_waitcnt lgkmcnt(7)
    v_mfma_f32_16x16x32_bf16 v[64:67], a[60:63], v[160:163], v[64:67]
    ds_read_b128 v[128:131], v255 offset:53248
    v_mfma_f32_16x16x32_bf16 v[68:71], a[64:67], v[160:163], v[68:71]
    buffer_load_dwordx2 v[184:185], v7, s[8:11], 0 offen offset:2048 sc1
    v_mfma_f32_16x16x32_bf16 v[72:75], a[68:71], v[160:163], v[72:75]
    v_add_f32 v209, v209, v229
    s_waitcnt lgkmcnt(7)
    v_mfma_f32_16x16x32_bf16 v[76:79], a[60:63], v[164:167], v[76:79]
    ds_read_b128 v[132:135], v255 offset:54272
    v_mfma_f32_16x16x32_bf16 v[80:83], a[64:67], v[164:167], v[80:83]
    s_mov_b32 s60, 39936
    buffer_load_dwordx4 a[156:159], v254, s[8:11], s60 offen offset:0
    v_mfma_f32_16x16x32_bf16 v[84:87], a[68:71], v[164:167], v[84:87]
    v_add_f32 v210, v210, v230
    s_waitcnt lgkmcnt(7)
    v_mfma_f32_16x16x32_bf16 v[88:91], a[60:63], v[168:171], v[88:91]
    ds_read_b128 v[136:139], v255 offset:55296
    v_mfma_f32_16x16x32_bf16 v[92:95], a[64:67], v[168:171], v[92:95]
    buffer_load_dwordx4 a[160:163], v254, s[8:11], s60 offen offset:1024
    v_mfma_f32_16x16x32_bf16 v[96:99], a[68:71], v[168:171], v[96:99]
    v_add_f32 v211, v211, v231
    s_waitcnt lgkmcnt(7)
    v_mfma_f32_16x16x32_bf16 v[100:103], a[60:63], v[172:175], v[100:103]
    ds_read_b128 v[140:143], v255 offset:56320
    v_mfma_f32_16x16x32_bf16 v[104:107], a[64:67], v[172:175], v[104:107]
    buffer_load_dwordx4 a[164:167], v254, s[8:11], s60 offen offset:2048
    v_mfma_f32_16x16x32_bf16 v[108:111], a[68:71], v[172:175], v[108:111]
    v_add_f32 v212, v212, v232
    s_waitcnt lgkmcnt(7)
    v_mfma_f32_16x16x32_bf16 v[16:19], a[72:75], v[112:115], v[16:19]
    ds_read_b128 v[144:147], v255 offset:57344
    v_mfma_f32_16x16x32_bf16 v[20:23], a[76:79], v[112:115], v[20:23]
    buffer_load_dwordx2 v[186:187], v7, s[8:11], 0 offen offset:2560 sc1
    v_mfma_f32_16x16x32_bf16 v[24:27], a[80:83], v[112:115], v[24:27]
    v_add_f32 v213, v213, v233
    s_waitcnt lgkmcnt(7)
    v_mfma_f32_16x16x32_bf16 v[28:31], a[72:75], v[116:119], v[28:31]
    ds_read_b128 v[148:151], v255 offset:58368
    v_mfma_f32_16x16x32_bf16 v[32:35], a[76:79], v[116:119], v[32:35]
    buffer_load_dwordx2 v[188:189], v7, s[8:11], 0 offen offset:3072 sc1
    v_mfma_f32_16x16x32_bf16 v[36:39], a[80:83], v[116:119], v[36:39]
    v_add_f32 v214, v214, v234
    s_waitcnt lgkmcnt(7)
    v_mfma_f32_16x16x32_bf16 v[40:43], a[72:75], v[120:123], v[40:43]
    ds_read_b128 v[152:155], v255 offset:59392
    v_mfma_f32_16x16x32_bf16 v[44:47], a[76:79], v[120:123], v[44:47]
    buffer_load_dwordx2 v[190:191], v7, s[8:11], 0 offen offset:3584 sc1
    v_mfma_f32_16x16x32_bf16 v[48:51], a[80:83], v[120:123], v[48:51]
    v_add_f32 v215, v215, v235
    s_waitcnt lgkmcnt(7)
    v_mfma_f32_16x16x32_bf16 v[52:55], a[72:75], v[124:127], v[52:55]
    ds_read_b128 v[156:159], v255 offset:60416
    v_mfma_f32_16x16x32_bf16 v[56:59], a[76:79], v[124:127], v[56:59]
    buffer_load_dwordx2 v[192:193], v6, s[8:11], 0 offen offset:0 sc1
    v_mfma_f32_16x16x32_bf16 v[60:63], a[80:83], v[124:127], v[60:63]
    v_add_f32 v196, v196, v206
    s_waitcnt lgkmcnt(7)
    v_mfma_f32_16x16x32_bf16 v[64:67], a[72:75], v[128:131], v[64:67]
    ds_read_b128 v[160:163], v255 offset:61440
    v_mfma_f32_16x16x32_bf16 v[68:71], a[76:79], v[128:131], v[68:71]
    buffer_load_dwordx2 v[194:195], v6, s[8:11], 0 offen offset:512 sc1
    v_mfma_f32_16x16x32_bf16 v[72:75], a[80:83], v[128:131], v[72:75]
    v_add_f32 v197, v197, v207
    s_waitcnt lgkmcnt(7)
    v_mfma_f32_16x16x32_bf16 v[76:79], a[72:75], v[132:135], v[76:79]
    ds_read_b128 v[164:167], v255 offset:62464
    v_mfma_f32_16x16x32_bf16 v[80:83], a[76:79], v[132:135], v[80:83]
    s_mov_b32 s60, 43008
    buffer_load_dwordx4 a[168:171], v254, s[8:11], s60 offen offset:0
    v_mfma_f32_16x16x32_bf16 v[84:87], a[80:83], v[132:135], v[84:87]
    v_add_f32 v198, v198, v208
    s_waitcnt lgkmcnt(7)
    v_mfma_f32_16x16x32_bf16 v[88:91], a[72:75], v[136:139], v[88:91]
    ds_read_b128 v[168:171], v255 offset:63488
    v_mfma_f32_16x16x32_bf16 v[92:95], a[76:79], v[136:139], v[92:95]
    buffer_load_dwordx4 a[172:175], v254, s[8:11], s60 offen offset:1024
    v_mfma_f32_16x16x32_bf16 v[96:99], a[80:83], v[136:139], v[96:99]
    v_add_f32 v199, v199, v209
    s_waitcnt lgkmcnt(7)
    v_mfma_f32_16x16x32_bf16 v[100:103], a[72:75], v[140:143], v[100:103]
    ds_read_b128 v[172:175], v255 offset:64512
    v_mfma_f32_16x16x32_bf16 v[104:107], a[76:79], v[140:143], v[104:107]
    buffer_load_dwordx4 a[176:179], v254, s[8:11], s60 offen offset:2048
    v_mfma_f32_16x16x32_bf16 v[108:111], a[80:83], v[140:143], v[108:111]
    v_add_f32 v200, v200, v210
    s_waitcnt vmcnt(31)
    s_barrier
    s_waitcnt lgkmcnt(7)
    v_mfma_f32_16x16x32_bf16 v[16:19], a[84:87], v[144:147], v[16:19]
    ds_read_b128 v[112:115], v13 offset:0
    v_mfma_f32_16x16x32_bf16 v[20:23], a[88:91], v[144:147], v[20:23]
    s_mov_b32 s60, 46080
    buffer_load_dwordx4 a[180:183], v254, s[8:11], s60 offen offset:0
    v_mfma_f32_16x16x32_bf16 v[24:27], a[92:95], v[144:147], v[24:27]
    v_add_f32 v201, v201, v211
    s_waitcnt lgkmcnt(7)
    v_mfma_f32_16x16x32_bf16 v[28:31], a[84:87], v[148:151], v[28:31]
    ds_read_b128 v[116:119], v13 offset:1024
    v_mfma_f32_16x16x32_bf16 v[32:35], a[88:91], v[148:151], v[32:35]
    buffer_load_dwordx4 a[184:187], v254, s[8:11], s60 offen offset:1024
    v_mfma_f32_16x16x32_bf16 v[36:39], a[92:95], v[148:151], v[36:39]
    v_add_f32 v202, v202, v212
    s_waitcnt lgkmcnt(7)
    v_mfma_f32_16x16x32_bf16 v[40:43], a[84:87], v[152:155], v[40:43]
    ds_read_b128 v[120:123], v13 offset:2048
    v_mfma_f32_16x16x32_bf16 v[44:47], a[88:91], v[152:155], v[44:47]
    buffer_load_dwordx4 a[188:191], v254, s[8:11], s60 offen offset:2048
    v_mfma_f32_16x16x32_bf16 v[48:51], a[92:95], v[152:155], v[48:51]
    v_add_f32 v203, v203, v213
    s_waitcnt lgkmcnt(7)
    v_mfma_f32_16x16x32_bf16 v[52:55], a[84:87], v[156:159], v[52:55]
    ds_read_b128 v[124:127], v13 offset:3072
    v_mfma_f32_16x16x32_bf16 v[56:59], a[88:91], v[156:159], v[56:59]
    v_add_f32 v204, v204, v214
    v_mfma_f32_16x16x32_bf16 v[60:63], a[92:95], v[156:159], v[60:63]
    v_add_f32 v205, v205, v215
    s_waitcnt lgkmcnt(7)
    v_mfma_f32_16x16x32_bf16 v[64:67], a[84:87], v[160:163], v[64:67]
    ds_read_b128 v[128:131], v13 offset:4096
    v_mfma_f32_16x16x32_bf16 v[68:71], a[88:91], v[160:163], v[68:71]
    v_add_f32 v196, v196, v198
    v_mfma_f32_16x16x32_bf16 v[72:75], a[92:95], v[160:163], v[72:75]
    v_add_f32 v197, v197, v199
    s_waitcnt lgkmcnt(7)
    v_mfma_f32_16x16x32_bf16 v[76:79], a[84:87], v[164:167], v[76:79]
    ds_read_b128 v[132:135], v13 offset:5120
    v_mfma_f32_16x16x32_bf16 v[80:83], a[88:91], v[164:167], v[80:83]
    v_add_f32 v200, v200, v202
    v_mfma_f32_16x16x32_bf16 v[84:87], a[92:95], v[164:167], v[84:87]
    v_add_f32 v201, v201, v203
    s_waitcnt lgkmcnt(7)
    v_mfma_f32_16x16x32_bf16 v[88:91], a[84:87], v[168:171], v[88:91]
    ds_read_b128 v[136:139], v13 offset:6144
    v_mfma_f32_16x16x32_bf16 v[92:95], a[88:91], v[168:171], v[92:95]
    v_add_f32 v196, v196, v204
    v_mfma_f32_16x16x32_bf16 v[96:99], a[92:95], v[168:171], v[96:99]
    v_add_f32 v197, v197, v205
    s_waitcnt lgkmcnt(7)
    v_mfma_f32_16x16x32_bf16 v[100:103], a[84:87], v[172:175], v[100:103]
    ds_read_b128 v[140:143], v13 offset:7168
    v_mfma_f32_16x16x32_bf16 v[104:107], a[88:91], v[172:175], v[104:107]
    v_add_f32 v196, v196, v200
    v_mfma_f32_16x16x32_bf16 v[108:111], a[92:95], v[172:175], v[108:111]
    v_add_f32 v197, v197, v201
    s_waitcnt lgkmcnt(7)
    v_mfma_f32_16x16x32_bf16 v[16:19], a[96:99], v[112:115], v[16:19]
    ds_read_b128 v[144:147], v13 offset:8192
    v_mfma_f32_16x16x32_bf16 v[20:23], a[100:103], v[112:115], v[20:23]
    s_mov_b32 s60, 49152
    buffer_load_dwordx4 a[192:195], v254, s[8:11], s60 offen offset:0
    v_mfma_f32_16x16x32_bf16 v[24:27], a[104:107], v[112:115], v[24:27]
    v_lshlrev_b32 v246, 3, v10
    s_waitcnt lgkmcnt(7)
    v_mfma_f32_16x16x32_bf16 v[28:31], a[96:99], v[116:119], v[28:31]
    ds_read_b128 v[148:151], v13 offset:9216
    v_mfma_f32_16x16x32_bf16 v[32:35], a[100:103], v[116:119], v[32:35]
    buffer_load_dwordx4 a[196:199], v254, s[8:11], s60 offen offset:1024
    v_mfma_f32_16x16x32_bf16 v[36:39], a[104:107], v[116:119], v[36:39]
    ds_write_b64 v246, v[196:197] offset:2048
    s_waitcnt lgkmcnt(8)
    v_mfma_f32_16x16x32_bf16 v[40:43], a[96:99], v[120:123], v[40:43]
    ds_read_b128 v[152:155], v13 offset:10240
    v_mfma_f32_16x16x32_bf16 v[44:47], a[100:103], v[120:123], v[44:47]
    buffer_load_dwordx4 a[200:203], v254, s[8:11], s60 offen offset:2048
    v_mfma_f32_16x16x32_bf16 v[48:51], a[104:107], v[120:123], v[48:51]
    s_waitcnt lgkmcnt(8)
    v_mfma_f32_16x16x32_bf16 v[52:55], a[96:99], v[124:127], v[52:55]
    ds_read_b128 v[156:159], v13 offset:11264
    v_mfma_f32_16x16x32_bf16 v[56:59], a[100:103], v[124:127], v[56:59]
    v_mfma_f32_16x16x32_bf16 v[60:63], a[104:107], v[124:127], v[60:63]
    s_waitcnt lgkmcnt(8)
    v_mfma_f32_16x16x32_bf16 v[64:67], a[96:99], v[128:131], v[64:67]
    ds_read_b128 v[160:163], v13 offset:12288
    v_mfma_f32_16x16x32_bf16 v[68:71], a[100:103], v[128:131], v[68:71]
    v_mfma_f32_16x16x32_bf16 v[72:75], a[104:107], v[128:131], v[72:75]
    s_waitcnt lgkmcnt(8)
    v_mfma_f32_16x16x32_bf16 v[76:79], a[96:99], v[132:135], v[76:79]
    ds_read_b128 v[164:167], v13 offset:13312
    v_mfma_f32_16x16x32_bf16 v[80:83], a[100:103], v[132:135], v[80:83]
    v_mfma_f32_16x16x32_bf16 v[84:87], a[104:107], v[132:135], v[84:87]
    s_waitcnt lgkmcnt(8)
    v_mfma_f32_16x16x32_bf16 v[88:91], a[96:99], v[136:139], v[88:91]
    ds_read_b128 v[168:171], v13 offset:14336
    v_mfma_f32_16x16x32_bf16 v[92:95], a[100:103], v[136:139], v[92:95]
    v_mfma_f32_16x16x32_bf16 v[96:99], a[104:107], v[136:139], v[96:99]
    s_waitcnt lgkmcnt(8)
    v_mfma_f32_16x16x32_bf16 v[100:103], a[96:99], v[140:143], v[100:103]
    ds_read_b128 v[172:175], v13 offset:15360
    v_mfma_f32_16x16x32_bf16 v[104:107], a[100:103], v[140:143], v[104:107]
    v_mfma_f32_16x16x32_bf16 v[108:111], a[104:107], v[140:143], v[108:111]
    s_waitcnt vmcnt(9)
    s_waitcnt lgkmcnt(8)
    v_mfma_f32_16x16x32_bf16 v[16:19], a[108:111], v[144:147], v[16:19]
    ds_read_b128 v[112:115], v13 offset:16384
    v_mfma_f32_16x16x32_bf16 v[20:23], a[112:115], v[144:147], v[20:23]
    s_mov_b32 s60, 52224
    buffer_load_dwordx4 a[204:207], v254, s[8:11], s60 offen offset:0
    v_mfma_f32_16x16x32_bf16 v[24:27], a[116:119], v[144:147], v[24:27]
    v_add_f32 v176, v176, v186
    s_waitcnt lgkmcnt(8)
    v_mfma_f32_16x16x32_bf16 v[28:31], a[108:111], v[148:151], v[28:31]
    ds_read_b128 v[116:119], v13 offset:17408
    v_mfma_f32_16x16x32_bf16 v[32:35], a[112:115], v[148:151], v[32:35]
    buffer_load_dwordx4 a[208:211], v254, s[8:11], s60 offen offset:1024
    v_mfma_f32_16x16x32_bf16 v[36:39], a[116:119], v[148:151], v[36:39]
    v_add_f32 v177, v177, v187
    s_waitcnt lgkmcnt(7)
    v_mfma_f32_16x16x32_bf16 v[40:43], a[108:111], v[152:155], v[40:43]
    ds_read_b128 v[120:123], v13 offset:18432
    v_mfma_f32_16x16x32_bf16 v[44:47], a[112:115], v[152:155], v[44:47]
    buffer_load_dwordx4 a[212:215], v254, s[8:11], s60 offen offset:2048
    v_mfma_f32_16x16x32_bf16 v[48:51], a[116:119], v[152:155], v[48:51]
    v_add_f32 v178, v178, v188
    s_waitcnt lgkmcnt(7)
    v_mfma_f32_16x16x32_bf16 v[52:55], a[108:111], v[156:159], v[52:55]
    ds_read_b128 v[124:127], v13 offset:19456
    v_mfma_f32_16x16x32_bf16 v[56:59], a[112:115], v[156:159], v[56:59]
    v_add_f32 v179, v179, v189
    v_mfma_f32_16x16x32_bf16 v[60:63], a[116:119], v[156:159], v[60:63]
    v_add_f32 v180, v180, v190
    s_waitcnt lgkmcnt(7)
    v_mfma_f32_16x16x32_bf16 v[64:67], a[108:111], v[160:163], v[64:67]
    ds_read_b128 v[128:131], v13 offset:20480
    v_mfma_f32_16x16x32_bf16 v[68:71], a[112:115], v[160:163], v[68:71]
    v_add_f32 v181, v181, v191
    v_mfma_f32_16x16x32_bf16 v[72:75], a[116:119], v[160:163], v[72:75]
    v_add_f32 v182, v182, v192
    s_waitcnt lgkmcnt(7)
    v_mfma_f32_16x16x32_bf16 v[76:79], a[108:111], v[164:167], v[76:79]
    ds_read_b128 v[132:135], v13 offset:21504
    v_mfma_f32_16x16x32_bf16 v[80:83], a[112:115], v[164:167], v[80:83]
    v_add_f32 v183, v183, v193
    v_mfma_f32_16x16x32_bf16 v[84:87], a[116:119], v[164:167], v[84:87]
    v_add_f32 v184, v184, v194
    s_waitcnt lgkmcnt(7)
    v_mfma_f32_16x16x32_bf16 v[88:91], a[108:111], v[168:171], v[88:91]
    ds_read_b128 v[136:139], v13 offset:22528
    v_mfma_f32_16x16x32_bf16 v[92:95], a[112:115], v[168:171], v[92:95]
    v_add_f32 v185, v185, v195
    v_mfma_f32_16x16x32_bf16 v[96:99], a[116:119], v[168:171], v[96:99]
    v_add_f32 v176, v176, v178
    s_waitcnt lgkmcnt(7)
    v_mfma_f32_16x16x32_bf16 v[100:103], a[108:111], v[172:175], v[100:103]
    ds_read_b128 v[140:143], v13 offset:23552
    v_mfma_f32_16x16x32_bf16 v[104:107], a[112:115], v[172:175], v[104:107]
    v_add_f32 v177, v177, v179
    v_mfma_f32_16x16x32_bf16 v[108:111], a[116:119], v[172:175], v[108:111]
    v_add_f32 v180, v180, v182
    s_waitcnt lgkmcnt(7)
    v_mfma_f32_16x16x32_bf16 v[16:19], a[120:123], v[112:115], v[16:19]
    ds_read_b128 v[144:147], v13 offset:24576
    v_mfma_f32_16x16x32_bf16 v[20:23], a[124:127], v[112:115], v[20:23]
    s_mov_b32 s60, 55296
    buffer_load_dwordx4 a[216:219], v254, s[8:11], s60 offen offset:0
    v_mfma_f32_16x16x32_bf16 v[24:27], a[128:131], v[112:115], v[24:27]
    v_add_f32 v181, v181, v183
    s_waitcnt lgkmcnt(7)
    v_mfma_f32_16x16x32_bf16 v[28:31], a[120:123], v[116:119], v[28:31]
    ds_read_b128 v[148:151], v13 offset:25600
    v_mfma_f32_16x16x32_bf16 v[32:35], a[124:127], v[116:119], v[32:35]
    buffer_load_dwordx4 a[220:223], v254, s[8:11], s60 offen offset:1024
    v_mfma_f32_16x16x32_bf16 v[36:39], a[128:131], v[116:119], v[36:39]
    v_add_f32 v176, v176, v184
    s_waitcnt lgkmcnt(7)
    v_mfma_f32_16x16x32_bf16 v[40:43], a[120:123], v[120:123], v[40:43]
    ds_read_b128 v[152:155], v13 offset:26624
    v_mfma_f32_16x16x32_bf16 v[44:47], a[124:127], v[120:123], v[44:47]
    buffer_load_dwordx4 a[224:227], v254, s[8:11], s60 offen offset:2048
    v_mfma_f32_16x16x32_bf16 v[48:51], a[128:131], v[120:123], v[48:51]
    v_add_f32 v177, v177, v185
    s_waitcnt lgkmcnt(7)
    v_mfma_f32_16x16x32_bf16 v[52:55], a[120:123], v[124:127], v[52:55]
    ds_read_b128 v[156:159], v13 offset:27648
    v_mfma_f32_16x16x32_bf16 v[56:59], a[124:127], v[124:127], v[56:59]
    v_add_f32 v176, v176, v180
    v_mfma_f32_16x16x32_bf16 v[60:63], a[128:131], v[124:127], v[60:63]
    v_add_f32 v177, v177, v181
    s_waitcnt lgkmcnt(7)
    v_mfma_f32_16x16x32_bf16 v[64:67], a[120:123], v[128:131], v[64:67]
    ds_read_b128 v[160:163], v13 offset:28672
    v_mfma_f32_16x16x32_bf16 v[68:71], a[124:127], v[128:131], v[68:71]
    v_mov_b32 v244, v176
    v_mfma_f32_16x16x32_bf16 v[72:75], a[128:131], v[128:131], v[72:75]
    v_mov_b32 v245, v177
    s_waitcnt lgkmcnt(7)
    v_mfma_f32_16x16x32_bf16 v[76:79], a[120:123], v[132:135], v[76:79]
    ds_read_b128 v[164:167], v13 offset:29696
    v_mfma_f32_16x16x32_bf16 v[80:83], a[124:127], v[132:135], v[80:83]
    v_permlane32_swap_b32 v244, v176
    v_mfma_f32_16x16x32_bf16 v[84:87], a[128:131], v[132:135], v[84:87]
    v_permlane32_swap_b32 v245, v177
    s_waitcnt lgkmcnt(7)
    v_mfma_f32_16x16x32_bf16 v[88:91], a[120:123], v[136:139], v[88:91]
    ds_read_b128 v[168:171], v13 offset:30720
    v_mfma_f32_16x16x32_bf16 v[92:95], a[124:127], v[136:139], v[92:95]
    v_add_f32 v244, v244, v176
    v_mfma_f32_16x16x32_bf16 v[96:99], a[128:131], v[136:139], v[96:99]
    v_add_f32 v245, v245, v177
    s_waitcnt lgkmcnt(7)
    v_mfma_f32_16x16x32_bf16 v[100:103], a[120:123], v[140:143], v[100:103]
    ds_read_b128 v[172:175], v13 offset:31744
    v_mfma_f32_16x16x32_bf16 v[104:107], a[124:127], v[140:143], v[104:107]
    v_mul_f32 v244, 0x3acccccd, v244
    v_mfma_f32_16x16x32_bf16 v[108:111], a[128:131], v[140:143], v[108:111]
    v_mul_f32 v245, 0x3acccccd, v245
    s_waitcnt lgkmcnt(7)
    v_mfma_f32_16x16x32_bf16 v[16:19], a[132:135], v[144:147], v[16:19]
    ds_read_b128 v[112:115], v13 offset:32768
    v_mfma_f32_16x16x32_bf16 v[20:23], a[136:139], v[144:147], v[20:23]
    s_mov_b32 s60, 58368
    buffer_load_dwordx4 a[228:231], v254, s[8:11], s60 offen offset:0
    v_mfma_f32_16x16x32_bf16 v[24:27], a[140:143], v[144:147], v[24:27]
    v_fma_f32 v245, -v244, v244, v245
    s_waitcnt lgkmcnt(7)
    v_mfma_f32_16x16x32_bf16 v[28:31], a[132:135], v[148:151], v[28:31]
    ds_read_b128 v[116:119], v13 offset:33792
    v_mfma_f32_16x16x32_bf16 v[32:35], a[136:139], v[148:151], v[32:35]
    buffer_load_dwordx4 a[232:235], v254, s[8:11], s60 offen offset:1024
    v_mfma_f32_16x16x32_bf16 v[36:39], a[140:143], v[148:151], v[36:39]
    v_max_f32 v245, 0, v245
    s_waitcnt lgkmcnt(7)
    v_mfma_f32_16x16x32_bf16 v[40:43], a[132:135], v[152:155], v[40:43]
    ds_read_b128 v[120:123], v13 offset:34816
    v_mfma_f32_16x16x32_bf16 v[44:47], a[136:139], v[152:155], v[44:47]
    buffer_load_dwordx4 a[236:239], v254, s[8:11], s60 offen offset:2048
    v_mfma_f32_16x16x32_bf16 v[48:51], a[140:143], v[152:155], v[48:51]
    v_cvt_pk_bf16_f32 v245, v245, v245
    s_waitcnt lgkmcnt(7)
    v_mfma_f32_16x16x32_bf16 v[52:55], a[132:135], v[156:159], v[52:55]
    ds_read_b128 v[124:127], v13 offset:35840
    v_mfma_f32_16x16x32_bf16 v[56:59], a[136:139], v[156:159], v[56:59]
    v_and_b32 v245, 0xffff0000, v245
    v_mfma_f32_16x16x32_bf16 v[60:63], a[140:143], v[156:159], v[60:63]
    v_cvt_pk_bf16_f32 v244, v244, v244
    s_waitcnt lgkmcnt(7)
    v_mfma_f32_16x16x32_bf16 v[64:67], a[132:135], v[160:163], v[64:67]
    ds_read_b128 v[128:131], v13 offset:36864
    v_mfma_f32_16x16x32_bf16 v[68:71], a[136:139], v[160:163], v[68:71]
    v_and_b32 v244, 0xffff0000, v244
    v_mfma_f32_16x16x32_bf16 v[72:75], a[140:143], v[160:163], v[72:75]
    v_add_f32 v245, 0x3727c5ac, v245
    s_waitcnt lgkmcnt(7)
    v_mfma_f32_16x16x32_bf16 v[76:79], a[132:135], v[164:167], v[76:79]
    ds_read_b128 v[132:135], v13 offset:37888
    v_mfma_f32_16x16x32_bf16 v[80:83], a[136:139], v[164:167], v[80:83]
    v_cvt_pk_bf16_f32 v245, v245, v245
    v_mfma_f32_16x16x32_bf16 v[84:87], a[140:143], v[164:167], v[84:87]
    v_and_b32 v245, 0xffff0000, v245
    s_waitcnt lgkmcnt(7)
    v_mfma_f32_16x16x32_bf16 v[88:91], a[132:135], v[168:171], v[88:91]
    ds_read_b128 v[136:139], v13 offset:38912
    v_mfma_f32_16x16x32_bf16 v[92:95], a[136:139], v[168:171], v[92:95]
    v_sqrt_f32 v245, v245
    v_mfma_f32_16x16x32_bf16 v[96:99], a[140:143], v[168:171], v[96:99]
    v_cvt_pk_bf16_f32 v245, v245, v245
    s_waitcnt lgkmcnt(7)
    v_mfma_f32_16x16x32_bf16 v[100:103], a[132:135], v[172:175], v[100:103]
    ds_read_b128 v[140:143], v13 offset:39936
    v_mfma_f32_16x16x32_bf16 v[104:107], a[136:139], v[172:175], v[104:107]
    v_and_b32 v245, 0xffff0000, v245
    v_mfma_f32_16x16x32_bf16 v[108:111], a[140:143], v[172:175], v[108:111]
    v_rcp_f32 v245, v245
    s_waitcnt vmcnt(31)
    s_waitcnt lgkmcnt(7)
    v_mfma_f32_16x16x32_bf16 v[16:19], a[144:147], v[112:115], v[16:19]
    ds_read_b128 v[144:147], v13 offset:40960
    v_mfma_f32_16x16x32_bf16 v[20:23], a[148:151], v[112:115], v[20:23]
    s_mov_b32 s63, 0
    buffer_load_dwordx4 a[0:3], v253, s[8:11], s63 offen offset:0
    v_mfma_f32_16x16x32_bf16 v[24:27], a[152:155], v[112:115], v[24:27]
    v_mul_f32 v244, v244, v245
    s_waitcnt lgkmcnt(7)
    v_mfma_f32_16x16x32_bf16 v[28:31], a[144:147], v[116:119], v[28:31]
    ds_read_b128 v[148:151], v13 offset:41984
    v_mfma_f32_16x16x32_bf16 v[32:35], a[148:151], v[116:119], v[32:35]
    s_mov_b32 s63, 0
    buffer_load_dwordx4 a[4:7], v253, s[8:11], s63 offen offset:1024
    v_mfma_f32_16x16x32_bf16 v[36:39], a[152:155], v[116:119], v[36:39]
    v_sub_f32 v244, 0, v244
    s_waitcnt lgkmcnt(7)
    v_mfma_f32_16x16x32_bf16 v[40:43], a[144:147], v[120:123], v[40:43]
    ds_read_b128 v[152:155], v13 offset:43008
    v_mfma_f32_16x16x32_bf16 v[44:47], a[148:151], v[120:123], v[44:47]
    s_mov_b32 s63, 0
    buffer_load_dwordx4 a[8:11], v253, s[8:11], s63 offen offset:2048
    v_mfma_f32_16x16x32_bf16 v[48:51], a[152:155], v[120:123], v[48:51]
    ds_write_b64 v15, v[244:245]
    s_waitcnt lgkmcnt(8)
    v_mfma_f32_16x16x32_bf16 v[52:55], a[144:147], v[124:127], v[52:55]
    ds_read_b128 v[156:159], v13 offset:44032
    v_mfma_f32_16x16x32_bf16 v[56:59], a[148:151], v[124:127], v[56:59]
    s_mov_b32 s63, 0
    buffer_load_dwordx4 a[12:15], v253, s[8:11], s63 offen offset:3072
    v_mfma_f32_16x16x32_bf16 v[60:63], a[152:155], v[124:127], v[60:63]
    s_waitcnt lgkmcnt(8)
    v_mfma_f32_16x16x32_bf16 v[64:67], a[144:147], v[128:131], v[64:67]
    ds_read_b128 v[160:163], v13 offset:45056
    v_mfma_f32_16x16x32_bf16 v[68:71], a[148:151], v[128:131], v[68:71]
    v_mfma_f32_16x16x32_bf16 v[72:75], a[152:155], v[128:131], v[72:75]
    s_waitcnt lgkmcnt(8)
    v_mfma_f32_16x16x32_bf16 v[76:79], a[144:147], v[132:135], v[76:79]
    ds_read_b128 v[164:167], v13 offset:46080
    v_mfma_f32_16x16x32_bf16 v[80:83], a[148:151], v[132:135], v[80:83]
    v_mfma_f32_16x16x32_bf16 v[84:87], a[152:155], v[132:135], v[84:87]
    s_waitcnt lgkmcnt(8)
    v_mfma_f32_16x16x32_bf16 v[88:91], a[144:147], v[136:139], v[88:91]
    ds_read_b128 v[168:171], v13 offset:47104
    v_mfma_f32_16x16x32_bf16 v[92:95], a[148:151], v[136:139], v[92:95]
    v_mfma_f32_16x16x32_bf16 v[96:99], a[152:155], v[136:139], v[96:99]
    s_waitcnt lgkmcnt(8)
    v_mfma_f32_16x16x32_bf16 v[100:103], a[144:147], v[140:143], v[100:103]
    ds_read_b128 v[172:175], v13 offset:48128
    v_mfma_f32_16x16x32_bf16 v[104:107], a[148:151], v[140:143], v[104:107]
    v_mfma_f32_16x16x32_bf16 v[108:111], a[152:155], v[140:143], v[108:111]
    s_waitcnt vmcnt(38)
    s_barrier
    s_waitcnt vmcnt(27)
    s_waitcnt lgkmcnt(8)
    v_mfma_f32_16x16x32_bf16 v[16:19], a[156:159], v[144:147], v[16:19]
    ds_read_b128 v[112:115], v13 offset:49152
    v_mfma_f32_16x16x32_bf16 v[20:23], a[160:163], v[144:147], v[20:23]
    s_mov_b32 s63, 4096
    buffer_load_dwordx4 a[16:19], v253, s[8:11], s63 offen offset:0
    v_mfma_f32_16x16x32_bf16 v[24:27], a[164:167], v[144:147], v[24:27]
    s_waitcnt lgkmcnt(8)
    v_mfma_f32_16x16x32_bf16 v[28:31], a[156:159], v[148:151], v[28:31]
    ds_read_b128 v[116:119], v13 offset:50176
    v_mfma_f32_16x16x32_bf16 v[32:35], a[160:163], v[148:151], v[32:35]
    s_mov_b32 s63, 4096
    buffer_load_dwordx4 a[20:23], v253, s[8:11], s63 offen offset:1024
    v_mfma_f32_16x16x32_bf16 v[36:39], a[164:167], v[148:151], v[36:39]
    s_waitcnt lgkmcnt(8)
    v_mfma_f32_16x16x32_bf16 v[40:43], a[156:159], v[152:155], v[40:43]
    ds_read_b128 v[120:123], v13 offset:51200
    v_mfma_f32_16x16x32_bf16 v[44:47], a[160:163], v[152:155], v[44:47]
    s_mov_b32 s63, 4096
    buffer_load_dwordx4 a[24:27], v253, s[8:11], s63 offen offset:2048
    v_mfma_f32_16x16x32_bf16 v[48:51], a[164:167], v[152:155], v[48:51]
    s_waitcnt lgkmcnt(7)
    v_mfma_f32_16x16x32_bf16 v[52:55], a[156:159], v[156:159], v[52:55]
    ds_read_b128 v[124:127], v13 offset:52224
    v_mfma_f32_16x16x32_bf16 v[56:59], a[160:163], v[156:159], v[56:59]
    s_mov_b32 s63, 4096
    buffer_load_dwordx4 a[28:31], v253, s[8:11], s63 offen offset:3072
    v_mfma_f32_16x16x32_bf16 v[60:63], a[164:167], v[156:159], v[60:63]
    s_waitcnt lgkmcnt(7)
    v_mfma_f32_16x16x32_bf16 v[64:67], a[156:159], v[160:163], v[64:67]
    ds_read_b128 v[128:131], v13 offset:53248
    v_mfma_f32_16x16x32_bf16 v[68:71], a[160:163], v[160:163], v[68:71]
    v_mfma_f32_16x16x32_bf16 v[72:75], a[164:167], v[160:163], v[72:75]
    s_waitcnt lgkmcnt(7)
    v_mfma_f32_16x16x32_bf16 v[76:79], a[156:159], v[164:167], v[76:79]
    ds_read_b128 v[132:135], v13 offset:54272
    v_mfma_f32_16x16x32_bf16 v[80:83], a[160:163], v[164:167], v[80:83]
    v_mfma_f32_16x16x32_bf16 v[84:87], a[164:167], v[164:167], v[84:87]
    s_waitcnt lgkmcnt(7)
    v_mfma_f32_16x16x32_bf16 v[88:91], a[156:159], v[168:171], v[88:91]
    ds_read_b128 v[136:139], v13 offset:55296
    v_mfma_f32_16x16x32_bf16 v[92:95], a[160:163], v[168:171], v[92:95]
    v_mfma_f32_16x16x32_bf16 v[96:99], a[164:167], v[168:171], v[96:99]
    s_waitcnt lgkmcnt(7)
    v_mfma_f32_16x16x32_bf16 v[100:103], a[156:159], v[172:175], v[100:103]
    ds_read_b128 v[140:143], v13 offset:56320
    v_mfma_f32_16x16x32_bf16 v[104:107], a[160:163], v[172:175], v[104:107]
    v_mfma_f32_16x16x32_bf16 v[108:111], a[164:167], v[172:175], v[108:111]
    s_waitcnt vmcnt(23)
    s_waitcnt lgkmcnt(7)
    v_mfma_f32_16x16x32_bf16 v[16:19], a[168:171], v[112:115], v[16:19]
    ds_read_b128 v[144:147], v13 offset:57344
    v_mfma_f32_16x16x32_bf16 v[20:23], a[172:175], v[112:115], v[20:23]
    s_mov_b32 s63, 8192
    buffer_load_dwordx4 a[32:35], v253, s[8:11], s63 offen offset:0
    v_mfma_f32_16x16x32_bf16 v[24:27], a[176:179], v[112:115], v[24:27]
    s_waitcnt lgkmcnt(7)
    v_mfma_f32_16x16x32_bf16 v[28:31], a[168:171], v[116:119], v[28:31]
    ds_read_b128 v[148:151], v13 offset:58368
    v_mfma_f32_16x16x32_bf16 v[32:35], a[172:175], v[116:119], v[32:35]
    s_mov_b32 s63, 8192
    buffer_load_dwordx4 a[36:39], v253, s[8:11], s63 offen offset:1024
    v_mfma_f32_16x16x32_bf16 v[36:39], a[176:179], v[116:119], v[36:39]
    s_waitcnt lgkmcnt(7)
    v_mfma_f32_16x16x32_bf16 v[40:43], a[168:171], v[120:123], v[40:43]
    ds_read_b128 v[152:155], v13 offset:59392
    v_mfma_f32_16x16x32_bf16 v[44:47], a[172:175], v[120:123], v[44:47]
    s_mov_b32 s63, 8192
    buffer_load_dwordx4 a[40:43], v253, s[8:11], s63 offen offset:2048
    v_mfma_f32_16x16x32_bf16 v[48:51], a[176:179], v[120:123], v[48:51]
    s_waitcnt lgkmcnt(7)
    v_mfma_f32_16x16x32_bf16 v[52:55], a[168:171], v[124:127], v[52:55]
    ds_read_b128 v[156:159], v13 offset:60416
    v_mfma_f32_16x16x32_bf16 v[56:59], a[172:175], v[124:127], v[56:59]
    s_mov_b32 s63, 8192
    buffer_load_dwordx4 a[44:47], v253, s[8:11], s63 offen offset:3072
    v_mfma_f32_16x16x32_bf16 v[60:63], a[176:179], v[124:127], v[60:63]
    s_waitcnt lgkmcnt(7)
    v_mfma_f32_16x16x32_bf16 v[64:67], a[168:171], v[128:131], v[64:67]
    ds_read_b128 v[160:163], v13 offset:61440
    v_mfma_f32_16x16x32_bf16 v[68:71], a[172:175], v[128:131], v[68:71]
    v_mfma_f32_16x16x32_bf16 v[72:75], a[176:179], v[128:131], v[72:75]
    s_waitcnt lgkmcnt(7)
    v_mfma_f32_16x16x32_bf16 v[76:79], a[168:171], v[132:135], v[76:79]
    ds_read_b128 v[164:167], v13 offset:62464
    v_mfma_f32_16x16x32_bf16 v[80:83], a[172:175], v[132:135], v[80:83]
    v_mfma_f32_16x16x32_bf16 v[84:87], a[176:179], v[132:135], v[84:87]
    s_waitcnt lgkmcnt(7)
    v_mfma_f32_16x16x32_bf16 v[88:91], a[168:171], v[136:139], v[88:91]
    ds_read_b128 v[168:171], v13 offset:63488
    v_mfma_f32_16x16x32_bf16 v[92:95], a[172:175], v[136:139], v[92:95]
    v_mfma_f32_16x16x32_bf16 v[96:99], a[176:179], v[136:139], v[96:99]
    s_waitcnt lgkmcnt(7)
    v_mfma_f32_16x16x32_bf16 v[100:103], a[168:171], v[140:143], v[100:103]
    ds_read_b128 v[172:175], v13 offset:64512
    v_mfma_f32_16x16x32_bf16 v[104:107], a[172:175], v[140:143], v[104:107]
    v_mfma_f32_16x16x32_bf16 v[108:111], a[176:179], v[140:143], v[108:111]
    s_waitcnt vmcnt(24)
    s_waitcnt lgkmcnt(7)
    v_mfma_f32_16x16x32_bf16 v[16:19], a[180:183], v[144:147], v[16:19]
    ds_read_b128 v[112:115], v14 offset:0
    v_mfma_f32_16x16x32_bf16 v[20:23], a[184:187], v[144:147], v[20:23]
    s_mov_b32 s63, 12288
    buffer_load_dwordx4 a[48:51], v253, s[8:11], s63 offen offset:0
    v_mfma_f32_16x16x32_bf16 v[24:27], a[188:191], v[144:147], v[24:27]
    s_waitcnt lgkmcnt(7)
    v_mfma_f32_16x16x32_bf16 v[28:31], a[180:183], v[148:151], v[28:31]
    ds_read_b128 v[116:119], v14 offset:1024
    v_mfma_f32_16x16x32_bf16 v[32:35], a[184:187], v[148:151], v[32:35]
    s_mov_b32 s63, 12288
    buffer_load_dwordx4 a[52:55], v253, s[8:11], s63 offen offset:1024
    v_mfma_f32_16x16x32_bf16 v[36:39], a[188:191], v[148:151], v[36:39]
    s_waitcnt lgkmcnt(7)
    v_mfma_f32_16x16x32_bf16 v[40:43], a[180:183], v[152:155], v[40:43]
    ds_read_b128 v[120:123], v14 offset:2048
    v_mfma_f32_16x16x32_bf16 v[44:47], a[184:187], v[152:155], v[44:47]
    s_mov_b32 s63, 12288
    buffer_load_dwordx4 a[56:59], v253, s[8:11], s63 offen offset:2048
    v_mfma_f32_16x16x32_bf16 v[48:51], a[188:191], v[152:155], v[48:51]
    s_waitcnt lgkmcnt(7)
    v_mfma_f32_16x16x32_bf16 v[52:55], a[180:183], v[156:159], v[52:55]
    ds_read_b128 v[124:127], v14 offset:3072
    v_mfma_f32_16x16x32_bf16 v[56:59], a[184:187], v[156:159], v[56:59]
    s_mov_b32 s63, 12288
    buffer_load_dwordx4 a[60:63], v253, s[8:11], s63 offen offset:3072
    v_mfma_f32_16x16x32_bf16 v[60:63], a[188:191], v[156:159], v[60:63]
    s_waitcnt lgkmcnt(7)
    v_mfma_f32_16x16x32_bf16 v[64:67], a[180:183], v[160:163], v[64:67]
    ds_read_b128 v[128:131], v14 offset:4096
    v_mfma_f32_16x16x32_bf16 v[68:71], a[184:187], v[160:163], v[68:71]
    v_mfma_f32_16x16x32_bf16 v[72:75], a[188:191], v[160:163], v[72:75]
    s_waitcnt lgkmcnt(7)
    v_mfma_f32_16x16x32_bf16 v[76:79], a[180:183], v[164:167], v[76:79]
    ds_read_b128 v[132:135], v14 offset:5120
    v_mfma_f32_16x16x32_bf16 v[80:83], a[184:187], v[164:167], v[80:83]
    v_mfma_f32_16x16x32_bf16 v[84:87], a[188:191], v[164:167], v[84:87]
    s_waitcnt lgkmcnt(7)
    v_mfma_f32_16x16x32_bf16 v[88:91], a[180:183], v[168:171], v[88:91]
    ds_read_b128 v[136:139], v14 offset:6144
    v_mfma_f32_16x16x32_bf16 v[92:95], a[184:187], v[168:171], v[92:95]
    v_mfma_f32_16x16x32_bf16 v[96:99], a[188:191], v[168:171], v[96:99]
    s_waitcnt lgkmcnt(7)
    v_mfma_f32_16x16x32_bf16 v[100:103], a[180:183], v[172:175], v[100:103]
    ds_read_b128 v[140:143], v14 offset:7168
    v_mfma_f32_16x16x32_bf16 v[104:107], a[184:187], v[172:175], v[104:107]
    v_mfma_f32_16x16x32_bf16 v[108:111], a[188:191], v[172:175], v[108:111]
    s_waitcnt vmcnt(25)
    s_waitcnt lgkmcnt(7)
    v_mfma_f32_16x16x32_bf16 v[16:19], a[192:195], v[112:115], v[16:19]
    ds_read_b128 v[144:147], v14 offset:8192
    v_mfma_f32_16x16x32_bf16 v[20:23], a[196:199], v[112:115], v[20:23]
    s_mov_b32 s63, 16384
    buffer_load_dwordx4 a[64:67], v253, s[8:11], s63 offen offset:0
    v_mfma_f32_16x16x32_bf16 v[24:27], a[200:203], v[112:115], v[24:27]
    s_waitcnt lgkmcnt(7)
    v_mfma_f32_16x16x32_bf16 v[28:31], a[192:195], v[116:119], v[28:31]
    ds_read_b128 v[148:151], v14 offset:9216
    v_mfma_f32_16x16x32_bf16 v[32:35], a[196:199], v[116:119], v[32:35]
    s_mov_b32 s63, 16384
    buffer_load_dwordx4 a[68:71], v253, s[8:11], s63 offen offset:1024
    v_mfma_f32_16x16x32_bf16 v[36:39], a[200:203], v[116:119], v[36:39]
    s_waitcnt lgkmcnt(7)
    v_mfma_f32_16x16x32_bf16 v[40:43], a[192:195], v[120:123], v[40:43]
    ds_read_b128 v[152:155], v14 offset:10240
    v_mfma_f32_16x16x32_bf16 v[44:47], a[196:199], v[120:123], v[44:47]
    s_mov_b32 s63, 16384
    buffer_load_dwordx4 a[72:75], v253, s[8:11], s63 offen offset:2048
    v_mfma_f32_16x16x32_bf16 v[48:51], a[200:203], v[120:123], v[48:51]
    s_waitcnt lgkmcnt(7)
    v_mfma_f32_16x16x32_bf16 v[52:55], a[192:195], v[124:127], v[52:55]
    ds_read_b128 v[156:159], v14 offset:11264
    v_mfma_f32_16x16x32_bf16 v[56:59], a[196:199], v[124:127], v[56:59]
    s_mov_b32 s63, 16384
    buffer_load_dwordx4 a[76:79], v253, s[8:11], s63 offen offset:3072
    v_mfma_f32_16x16x32_bf16 v[60:63], a[200:203], v[124:127], v[60:63]
    s_waitcnt lgkmcnt(7)
    v_mfma_f32_16x16x32_bf16 v[64:67], a[192:195], v[128:131], v[64:67]
    ds_read_b128 v[160:163], v14 offset:12288
    v_mfma_f32_16x16x32_bf16 v[68:71], a[196:199], v[128:131], v[68:71]
    v_mfma_f32_16x16x32_bf16 v[72:75], a[200:203], v[128:131], v[72:75]
    s_waitcnt lgkmcnt(7)
    v_mfma_f32_16x16x32_bf16 v[76:79], a[192:195], v[132:135], v[76:79]
    ds_read_b128 v[164:167], v14 offset:13312
    v_mfma_f32_16x16x32_bf16 v[80:83], a[196:199], v[132:135], v[80:83]
    v_mfma_f32_16x16x32_bf16 v[84:87], a[200:203], v[132:135], v[84:87]
    s_waitcnt lgkmcnt(7)
    v_mfma_f32_16x16x32_bf16 v[88:91], a[192:195], v[136:139], v[88:91]
    ds_read_b128 v[168:171], v14 offset:14336
    v_mfma_f32_16x16x32_bf16 v[92:95], a[196:199], v[136:139], v[92:95]
    v_mfma_f32_16x16x32_bf16 v[96:99], a[200:203], v[136:139], v[96:99]
    s_waitcnt lgkmcnt(7)
    v_mfma_f32_16x16x32_bf16 v[100:103], a[192:195], v[140:143], v[100:103]
    ds_read_b128 v[172:175], v14 offset:15360
    v_mfma_f32_16x16x32_bf16 v[104:107], a[196:199], v[140:143], v[104:107]
    v_mfma_f32_16x16x32_bf16 v[108:111], a[200:203], v[140:143], v[108:111]
    s_waitcnt lgkmcnt(0)
    s_barrier
    s_waitcnt vmcnt(26)
    s_waitcnt lgkmcnt(7)
    v_mfma_f32_16x16x32_bf16 v[16:19], a[204:207], v[144:147], v[16:19]
    ds_read_b128 v[112:115], v14 offset:16384
    v_mfma_f32_16x16x32_bf16 v[20:23], a[208:211], v[144:147], v[20:23]
    s_mov_b32 s63, 20480
    buffer_load_dwordx4 a[80:83], v253, s[8:11], s63 offen offset:0
    v_mfma_f32_16x16x32_bf16 v[24:27], a[212:215], v[144:147], v[24:27]
    v_lshlrev_b32 v246, 3, v1
    s_waitcnt lgkmcnt(7)
    v_mfma_f32_16x16x32_bf16 v[28:31], a[204:207], v[148:151], v[28:31]
    ds_read_b128 v[116:119], v14 offset:17408
    v_mfma_f32_16x16x32_bf16 v[32:35], a[208:211], v[148:151], v[32:35]
    s_mov_b32 s63, 20480
    buffer_load_dwordx4 a[84:87], v253, s[8:11], s63 offen offset:1024
    v_mfma_f32_16x16x32_bf16 v[36:39], a[212:215], v[148:151], v[36:39]
    ds_read_b64 v[176:177], v246 offset:0
    s_waitcnt lgkmcnt(8)
    v_mfma_f32_16x16x32_bf16 v[40:43], a[204:207], v[152:155], v[40:43]
    ds_read_b128 v[120:123], v14 offset:18432
    v_mfma_f32_16x16x32_bf16 v[44:47], a[208:211], v[152:155], v[44:47]
    s_mov_b32 s63, 20480
    buffer_load_dwordx4 a[88:91], v253, s[8:11], s63 offen offset:2048
    v_mfma_f32_16x16x32_bf16 v[48:51], a[212:215], v[152:155], v[48:51]
    ds_read_b64 v[178:179], v246 offset:128
    s_waitcnt lgkmcnt(9)
    v_mfma_f32_16x16x32_bf16 v[52:55], a[204:207], v[156:159], v[52:55]
    ds_read_b128 v[124:127], v14 offset:19456
    v_mfma_f32_16x16x32_bf16 v[56:59], a[208:211], v[156:159], v[56:59]
    s_mov_b32 s63, 20480
    buffer_load_dwordx4 a[92:95], v253, s[8:11], s63 offen offset:3072
    v_mfma_f32_16x16x32_bf16 v[60:63], a[212:215], v[156:159], v[60:63]
    ds_read_b64 v[180:181], v246 offset:256
    s_waitcnt lgkmcnt(10)
    v_mfma_f32_16x16x32_bf16 v[64:67], a[204:207], v[160:163], v[64:67]
    ds_read_b128 v[128:131], v14 offset:20480
    v_mfma_f32_16x16x32_bf16 v[68:71], a[208:211], v[160:163], v[68:71]
    ds_read_b64 v[182:183], v246 offset:384
    v_mfma_f32_16x16x32_bf16 v[72:75], a[212:215], v[160:163], v[72:75]
    ds_read_b64 v[184:185], v246 offset:512
    s_waitcnt lgkmcnt(12)
    v_mfma_f32_16x16x32_bf16 v[76:79], a[204:207], v[164:167], v[76:79]
    ds_read_b128 v[132:135], v14 offset:21504
    v_mfma_f32_16x16x32_bf16 v[80:83], a[208:211], v[164:167], v[80:83]
    ds_read_b64 v[186:187], v246 offset:640
    v_mfma_f32_16x16x32_bf16 v[84:87], a[212:215], v[164:167], v[84:87]
    ds_read_b64 v[188:189], v246 offset:768
    s_waitcnt lgkmcnt(14)
    v_mfma_f32_16x16x32_bf16 v[88:91], a[204:207], v[168:171], v[88:91]
    ds_read_b128 v[136:139], v14 offset:22528
    v_mfma_f32_16x16x32_bf16 v[92:95], a[208:211], v[168:171], v[92:95]
    ds_read_b64 v[190:191], v246 offset:896
    v_mfma_f32_16x16x32_bf16 v[96:99], a[212:215], v[168:171], v[96:99]
    s_mul_i32 s22, s20, 384
    s_waitcnt lgkmcnt(15)
    v_mfma_f32_16x16x32_bf16 v[100:103], a[204:207], v[172:175], v[100:103]
    ds_read_b128 v[140:143], v14 offset:23552
    v_mfma_f32_16x16x32_bf16 v[104:107], a[208:211], v[172:175], v[104:107]
    v_lshl_add_u32 v247, v2, 5, s22
    v_mfma_f32_16x16x32_bf16 v[108:111], a[212:215], v[172:175], v[108:111]
    ds_read_b128 v[208:211], v247 offset:2048
    s_waitcnt vmcnt(27)
    s_waitcnt lgkmcnt(15)
    v_mfma_f32_16x16x32_bf16 v[16:19], a[216:219], v[112:115], v[16:19]
    ds_read_b128 v[144:147], v14 offset:24576
    v_mfma_f32_16x16x32_bf16 v[20:23], a[220:223], v[112:115], v[20:23]
    s_mov_b32 s63, 24576
    buffer_load_dwordx4 a[96:99], v253, s[8:11], s63 offen offset:0
    v_mfma_f32_16x16x32_bf16 v[24:27], a[224:227], v[112:115], v[24:27]
    ds_read_b128 v[212:215], v247 offset:2064
    s_waitcnt lgkmcnt(15)
    v_mfma_f32_16x16x32_bf16 v[28:31], a[216:219], v[116:119], v[28:31]
    ds_read_b128 v[148:151], v14 offset:25600
    v_mfma_f32_16x16x32_bf16 v[32:35], a[220:223], v[116:119], v[32:35]
    s_mov_b32 s63, 24576
    buffer_load_dwordx4 a[100:103], v253, s[8:11], s63 offen offset:1024
    v_mfma_f32_16x16x32_bf16 v[36:39], a[224:227], v[116:119], v[36:39]
    ds_read_b128 v[216:219], v247 offset:2176
    s_waitcnt lgkmcnt(15)
    v_mfma_f32_16x16x32_bf16 v[40:43], a[216:219], v[120:123], v[40:43]
    ds_read_b128 v[152:155], v14 offset:26624
    v_mfma_f32_16x16x32_bf16 v[44:47], a[220:223], v[120:123], v[44:47]
    s_mov_b32 s63, 24576
    buffer_load_dwordx4 a[104:107], v253, s[8:11], s63 offen offset:2048
    v_mfma_f32_16x16x32_bf16 v[48:51], a[224:227], v[120:123], v[48:51]
    ds_read_b128 v[220:223], v247 offset:2192
    s_waitcnt lgkmcnt(15)
    v_mfma_f32_16x16x32_bf16 v[52:55], a[216:219], v[124:127], v[52:55]
    ds_read_b128 v[156:159], v14 offset:27648
    v_mfma_f32_16x16x32_bf16 v[56:59], a[220:223], v[124:127], v[56:59]
    s_mov_b32 s63, 24576
    buffer_load_dwordx4 a[108:111], v253, s[8:11], s63 offen offset:3072
    v_mfma_f32_16x16x32_bf16 v[60:63], a[224:227], v[124:127], v[60:63]
    ds_read_b128 v[224:227], v247 offset:2304
    s_waitcnt lgkmcnt(15)
    v_mfma_f32_16x16x32_bf16 v[64:67], a[216:219], v[128:131], v[64:67]
    ds_read_b128 v[160:163], v14 offset:28672
    v_mfma_f32_16x16x32_bf16 v[68:71], a[220:223], v[128:131], v[68:71]
    ds_read_b128 v[228:231], v247 offset:2320
    v_mfma_f32_16x16x32_bf16 v[72:75], a[224:227], v[128:131], v[72:75]
    s_waitcnt lgkmcnt(15)
    v_mfma_f32_16x16x32_bf16 v[76:79], a[216:219], v[132:135], v[76:79]
    ds_read_b128 v[164:167], v14 offset:29696
    v_mfma_f32_16x16x32_bf16 v[80:83], a[220:223], v[132:135], v[80:83]
    v_mfma_f32_16x16x32_bf16 v[84:87], a[224:227], v[132:135], v[84:87]
    s_waitcnt lgkmcnt(14)
    v_mfma_f32_16x16x32_bf16 v[88:91], a[216:219], v[136:139], v[88:91]
    ds_read_b128 v[168:171], v14 offset:30720
    v_mfma_f32_16x16x32_bf16 v[92:95], a[220:223], v[136:139], v[92:95]
    v_mfma_f32_16x16x32_bf16 v[96:99], a[224:227], v[136:139], v[96:99]
    s_waitcnt lgkmcnt(13)
    v_mfma_f32_16x16x32_bf16 v[100:103], a[216:219], v[140:143], v[100:103]
    ds_read_b128 v[172:175], v14 offset:31744
    v_mfma_f32_16x16x32_bf16 v[104:107], a[220:223], v[140:143], v[104:107]
    v_mfma_f32_16x16x32_bf16 v[108:111], a[224:227], v[140:143], v[108:111]
    s_waitcnt vmcnt(28)
    s_waitcnt lgkmcnt(12)
    v_mfma_f32_16x16x32_bf16 v[16:19], a[228:231], v[144:147], v[16:19]
    v_mfma_f32_16x16x32_bf16 v[20:23], a[232:235], v[144:147], v[20:23]
    s_mov_b32 s63, 28672
    buffer_load_dwordx4 a[112:115], v253, s[8:11], s63 offen offset:0
    v_mfma_f32_16x16x32_bf16 v[24:27], a[236:239], v[144:147], v[24:27]
    s_waitcnt lgkmcnt(10)
    v_mfma_f32_16x16x32_bf16 v[28:31], a[228:231], v[148:151], v[28:31]
    v_mfma_f32_16x16x32_bf16 v[32:35], a[232:235], v[148:151], v[32:35]
    s_mov_b32 s63, 28672
    buffer_load_dwordx4 a[116:119], v253, s[8:11], s63 offen offset:1024
    v_mfma_f32_16x16x32_bf16 v[36:39], a[236:239], v[148:151], v[36:39]
    s_waitcnt lgkmcnt(8)
    v_mfma_f32_16x16x32_bf16 v[40:43], a[228:231], v[152:155], v[40:43]
    v_mfma_f32_16x16x32_bf16 v[44:47], a[232:235], v[152:155], v[44:47]
    s_mov_b32 s63, 28672
    buffer_load_dwordx4 a[120:123], v253, s[8:11], s63 offen offset:2048
    v_mfma_f32_16x16x32_bf16 v[48:51], a[236:239], v[152:155], v[48:51]
    s_waitcnt lgkmcnt(6)
    v_mfma_f32_16x16x32_bf16 v[52:55], a[228:231], v[156:159], v[52:55]
    v_mfma_f32_16x16x32_bf16 v[56:59], a[232:235], v[156:159], v[56:59]
    s_mov_b32 s63, 28672
    buffer_load_dwordx4 a[124:127], v253, s[8:11], s63 offen offset:3072
    v_mfma_f32_16x16x32_bf16 v[60:63], a[236:239], v[156:159], v[60:63]
    s_waitcnt lgkmcnt(4)
    v_mfma_f32_16x16x32_bf16 v[64:67], a[228:231], v[160:163], v[64:67]
    v_mfma_f32_16x16x32_bf16 v[68:71], a[232:235], v[160:163], v[68:71]
    v_mfma_f32_16x16x32_bf16 v[72:75], a[236:239], v[160:163], v[72:75]
    s_waitcnt lgkmcnt(2)
    v_mfma_f32_16x16x32_bf16 v[76:79], a[228:231], v[164:167], v[76:79]
    v_mfma_f32_16x16x32_bf16 v[80:83], a[232:235], v[164:167], v[80:83]
    v_mfma_f32_16x16x32_bf16 v[84:87], a[236:239], v[164:167], v[84:87]
    s_waitcnt lgkmcnt(1)
    v_mfma_f32_16x16x32_bf16 v[88:91], a[228:231], v[168:171], v[88:91]
    v_mfma_f32_16x16x32_bf16 v[92:95], a[232:235], v[168:171], v[92:95]
    v_mfma_f32_16x16x32_bf16 v[96:99], a[236:239], v[168:171], v[96:99]
    s_waitcnt lgkmcnt(0)
    v_mfma_f32_16x16x32_bf16 v[100:103], a[228:231], v[172:175], v[100:103]
    v_mfma_f32_16x16x32_bf16 v[104:107], a[232:235], v[172:175], v[104:107]
    v_mfma_f32_16x16x32_bf16 v[108:111], a[236:239], v[172:175], v[108:111]
    v_mov_b32 v112, 0xc0135761
    v_mov_b32 v114, 0xbdd2d3e8
    v_mov_b32 v116, 1.0
    v_mov_b32 v113, 0xc0135761
    v_mov_b32 v115, 0xbdd2d3e8
    v_mov_b32 v117, 1.0
    s_waitcnt lgkmcnt(0)
    v_swap_b32 v209, v210
    v_swap_b32 v213, v214
    v_swap_b32 v217, v218
    v_swap_b32 v221, v222
    v_swap_b32 v225, v226
    v_swap_b32 v229, v230
    s_mul_i32 s22, s52, 393216
    s_mul_i32 s23, s53, 3072
    s_add_u32 s22, s22, s23
    s_lshl_b32 s23, s20, 8
    s_add_u32 s22, s22, s23
    s_add_u32 s22, s22, 0x1200000
    v_mul_u32_u24 v4, 49152, v2
    v_lshl_add_u32 v4, v1, 4, v4
    v_add_u32 v4, s22, v4
    v_pk_fma_f32 v[120:121], v[208:209], v[176:177], v[210:211] op_sel_hi:[1,0,1]
    v_pk_fma_f32 v[124:125], v[212:213], v[176:177], v[214:215] op_sel_hi:[1,0,1]
    v_pk_fma_f32 v[128:129], v[216:217], v[176:177], v[218:219] op_sel_hi:[1,0,1]
    v_pk_fma_f32 v[132:133], v[220:221], v[176:177], v[222:223] op_sel_hi:[1,0,1]
    v_pk_fma_f32 v[136:137], v[224:225], v[176:177], v[226:227] op_sel_hi:[1,0,1]
    v_pk_fma_f32 v[140:141], v[228:229], v[176:177], v[230:231] op_sel_hi:[1,0,1]
    v_pk_fma_f32 v[120:121], v[16:17], v[176:177], v[120:121] op_sel:[0,1,0] op_sel_hi:[1,1,1]
    v_pk_fma_f32 v[124:125], v[18:19], v[176:177], v[124:125] op_sel:[0,1,0] op_sel_hi:[1,1,1]
    v_pk_fma_f32 v[128:129], v[20:21], v[176:177], v[128:129] op_sel:[0,1,0] op_sel_hi:[1,1,1]
    v_pk_fma_f32 v[132:133], v[22:23], v[176:177], v[132:133] op_sel:[0,1,0] op_sel_hi:[1,1,1]
    v_pk_fma_f32 v[136:137], v[24:25], v[176:177], v[136:137] op_sel:[0,1,0] op_sel_hi:[1,1,1]
    v_pk_fma_f32 v[140:141], v[26:27], v[176:177], v[140:141] op_sel:[0,1,0] op_sel_hi:[1,1,1]
    s_mov_b32 s63, 32768
    buffer_load_dwordx4 a[128:131], v253, s[8:11], s63 offen offset:0
    v_pk_mul_f32 v[122:123], v[120:121], v[120:121]
    v_pk_mul_f32 v[130:131], v[128:129], v[128:129]
    v_pk_mul_f32 v[138:139], v[136:137], v[136:137]
    v_pk_fma_f32 v[122:123], v[122:123], v[114:115], v[112:113]
    v_pk_fma_f32 v[130:131], v[130:131], v[114:115], v[112:113]
    v_pk_fma_f32 v[138:139], v[138:139], v[114:115], v[112:113]
    v_pk_mul_f32 v[122:123], v[122:123], v[120:121]
    v_pk_mul_f32 v[130:131], v[130:131], v[128:129]
    v_pk_mul_f32 v[138:139], v[138:139], v[136:137]
    v_exp_f32 v122, v122
    v_exp_f32 v123, v123
    v_exp_f32 v130, v130
    s_mov_b32 s63, 32768
    buffer_load_dwordx4 a[132:135], v253, s[8:11], s63 offen offset:1024
    v_exp_f32 v131, v131
    v_exp_f32 v138, v138
    v_exp_f32 v139, v139
    v_pk_mul_f32 v[124:125], v[120:121], v[124:125]
    v_pk_mul_f32 v[132:133], v[128:129], v[132:133]
    v_pk_mul_f32 v[140:141], v[136:137], v[140:141]
    v_pk_add_f32 v[122:123], v[122:123], v[116:117]
    v_pk_add_f32 v[130:131], v[130:131], v[116:117]
    v_pk_add_f32 v[138:139], v[138:139], v[116:117]
    v_rcp_f32 v122, v122
    v_rcp_f32 v123, v123
    v_rcp_f32 v130, v130
    s_mov_b32 s63, 32768
    buffer_load_dwordx4 a[136:139], v253, s[8:11], s63 offen offset:2048
    v_rcp_f32 v131, v131
    v_rcp_f32 v138, v138
    v_rcp_f32 v139, v139
    v_pk_mul_f32 v[124:125], v[124:125], v[122:123]
    v_pk_mul_f32 v[132:133], v[132:133], v[130:131]
    v_pk_mul_f32 v[140:141], v[140:141], v[138:139]
    v_cvt_pk_bf16_f32 v144, v124, v125
    v_cvt_pk_bf16_f32 v148, v132, v133
    v_cvt_pk_bf16_f32 v152, v140, v141
    v_pk_fma_f32 v[120:121], v[208:209], v[178:179], v[210:211] op_sel_hi:[1,0,1]
    v_pk_fma_f32 v[124:125], v[212:213], v[178:179], v[214:215] op_sel_hi:[1,0,1]
    v_pk_fma_f32 v[128:129], v[216:217], v[178:179], v[218:219] op_sel_hi:[1,0,1]
    s_mov_b32 s63, 32768
    buffer_load_dwordx4 a[140:143], v253, s[8:11], s63 offen offset:3072
    v_pk_fma_f32 v[132:133], v[220:221], v[178:179], v[222:223] op_sel_hi:[1,0,1]
    v_pk_fma_f32 v[136:137], v[224:225], v[178:179], v[226:227] op_sel_hi:[1,0,1]
    v_pk_fma_f32 v[140:141], v[228:229], v[178:179], v[230:231] op_sel_hi:[1,0,1]
    v_pk_fma_f32 v[120:121], v[28:29], v[178:179], v[120:121] op_sel:[0,1,0] op_sel_hi:[1,1,1]
    v_pk_fma_f32 v[124:125], v[30:31], v[178:179], v[124:125] op_sel:[0,1,0] op_sel_hi:[1,1,1]
    v_pk_fma_f32 v[128:129], v[32:33], v[178:179], v[128:129] op_sel:[0,1,0] op_sel_hi:[1,1,1]
    v_pk_fma_f32 v[132:133], v[34:35], v[178:179], v[132:133] op_sel:[0,1,0] op_sel_hi:[1,1,1]
    v_pk_fma_f32 v[136:137], v[36:37], v[178:179], v[136:137] op_sel:[0,1,0] op_sel_hi:[1,1,1]
    v_pk_fma_f32 v[140:141], v[38:39], v[178:179], v[140:141] op_sel:[0,1,0] op_sel_hi:[1,1,1]
    v_pk_mul_f32 v[122:123], v[120:121], v[120:121]
    v_pk_mul_f32 v[130:131], v[128:129], v[128:129]
    v_pk_mul_f32 v[138:139], v[136:137], v[136:137]
    s_mov_b32 s63, 36864
    buffer_load_dwordx4 a[144:147], v253, s[8:11], s63 offen offset:0
    v_pk_fma_f32 v[122:123], v[122:123], v[114:115], v[112:113]
    v_pk_fma_f32 v[130:131], v[130:131], v[114:115], v[112:113]
    v_pk_fma_f32 v[138:139], v[138:139], v[114:115], v[112:113]
    v_pk_mul_f32 v[122:123], v[122:123], v[120:121]
    v_pk_mul_f32 v[130:131], v[130:131], v[128:129]
    v_pk_mul_f32 v[138:139], v[138:139], v[136:137]
    v_exp_f32 v122, v122
    v_exp_f32 v123, v123
    v_exp_f32 v130, v130
    v_exp_f32 v131, v131
    v_exp_f32 v138, v138
    v_exp_f32 v139, v139
    s_mov_b32 s63, 36864
    buffer_load_dwordx4 a[148:151], v253, s[8:11], s63 offen offset:1024
    v_pk_mul_f32 v[124:125], v[120:121], v[124:125]
    v_pk_mul_f32 v[132:133], v[128:129], v[132:133]
    v_pk_mul_f32 v[140:141], v[136:137], v[140:141]
    v_pk_add_f32 v[122:123], v[122:123], v[116:117]
    v_pk_add_f32 v[130:131], v[130:131], v[116:117]
    v_pk_add_f32 v[138:139], v[138:139], v[116:117]
    v_rcp_f32 v122, v122
    v_rcp_f32 v123, v123
    v_rcp_f32 v130, v130
    v_rcp_f32 v131, v131
    v_rcp_f32 v138, v138
    v_rcp_f32 v139, v139
    s_mov_b32 s63, 36864
    buffer_load_dwordx4 a[152:155], v253, s[8:11], s63 offen offset:2048
    v_pk_mul_f32 v[124:125], v[124:125], v[122:123]
    v_pk_mul_f32 v[132:133], v[132:133], v[130:131]
    v_pk_mul_f32 v[140:141], v[140:141], v[138:139]
    v_cvt_pk_bf16_f32 v145, v124, v125
    v_cvt_pk_bf16_f32 v149, v132, v133
    v_cvt_pk_bf16_f32 v153, v140, v141
    v_pk_fma_f32 v[120:121], v[208:209], v[180:181], v[210:211] op_sel_hi:[1,0,1]
    v_pk_fma_f32 v[124:125], v[212:213], v[180:181], v[214:215] op_sel_hi:[1,0,1]
    v_pk_fma_f32 v[128:129], v[216:217], v[180:181], v[218:219] op_sel_hi:[1,0,1]
    v_pk_fma_f32 v[132:133], v[220:221], v[180:181], v[222:223] op_sel_hi:[1,0,1]
    v_pk_fma_f32 v[136:137], v[224:225], v[180:181], v[226:227] op_sel_hi:[1,0,1]
    v_pk_fma_f32 v[140:141], v[228:229], v[180:181], v[230:231] op_sel_hi:[1,0,1]
    s_mov_b32 s63, 36864
    buffer_load_dwordx4 a[156:159], v253, s[8:11], s63 offen offset:3072
    v_pk_fma_f32 v[120:121], v[40:41], v[180:181], v[120:121] op_sel:[0,1,0] op_sel_hi:[1,1,1]
    v_pk_fma_f32 v[124:125], v[42:43], v[180:181], v[124:125] op_sel:[0,1,0] op_sel_hi:[1,1,1]
    v_pk_fma_f32 v[128:129], v[44:45], v[180:181], v[128:129] op_sel:[0,1,0] op_sel_hi:[1,1,1]
    v_pk_fma_f32 v[132:133], v[46:47], v[180:181], v[132:133] op_sel:[0,1,0] op_sel_hi:[1,1,1]
    v_pk_fma_f32 v[136:137], v[48:49], v[180:181], v[136:137] op_sel:[0,1,0] op_sel_hi:[1,1,1]
    v_pk_fma_f32 v[140:141], v[50:51], v[180:181], v[140:141] op_sel:[0,1,0] op_sel_hi:[1,1,1]
    v_pk_mul_f32 v[122:123], v[120:121], v[120:121]
    v_pk_mul_f32 v[130:131], v[128:129], v[128:129]
    v_pk_mul_f32 v[138:139], v[136:137], v[136:137]
    v_pk_fma_f32 v[122:123], v[122:123], v[114:115], v[112:113]
    v_pk_fma_f32 v[130:131], v[130:131], v[114:115], v[112:113]
    v_pk_fma_f32 v[138:139], v[138:139], v[114:115], v[112:113]
    s_mov_b32 s63, 40960
    buffer_load_dwordx4 a[160:163], v253, s[8:11], s63 offen offset:0
    v_pk_mul_f32 v[122:123], v[122:123], v[120:121]
    v_pk_mul_f32 v[130:131], v[130:131], v[128:129]
    v_pk_mul_f32 v[138:139], v[138:139], v[136:137]
    v_exp_f32 v122, v122
    v_exp_f32 v123, v123
    v_exp_f32 v130, v130
    v_exp_f32 v131, v131
    v_exp_f32 v138, v138
    v_exp_f32 v139, v139
    v_pk_mul_f32 v[124:125], v[120:121], v[124:125]
    v_pk_mul_f32 v[132:133], v[128:129], v[132:133]
    v_pk_mul_f32 v[140:141], v[136:137], v[140:141]
    s_mov_b32 s63, 40960
    buffer_load_dwordx4 a[164:167], v253, s[8:11], s63 offen offset:1024
    v_pk_add_f32 v[122:123], v[122:123], v[116:117]
    v_pk_add_f32 v[130:131], v[130:131], v[116:117]
    v_pk_add_f32 v[138:139], v[138:139], v[116:117]
    v_rcp_f32 v122, v122
    v_rcp_f32 v123, v123
    v_rcp_f32 v130, v130
    v_rcp_f32 v131, v131
    v_rcp_f32 v138, v138
    v_rcp_f32 v139, v139
    v_pk_mul_f32 v[124:125], v[124:125], v[122:123]
    v_pk_mul_f32 v[132:133], v[132:133], v[130:131]
    v_pk_mul_f32 v[140:141], v[140:141], v[138:139]
    s_mov_b32 s63, 40960
    buffer_load_dwordx4 a[168:171], v253, s[8:11], s63 offen offset:2048
    v_cvt_pk_bf16_f32 v146, v124, v125
    v_cvt_pk_bf16_f32 v150, v132, v133
    v_cvt_pk_bf16_f32 v154, v140, v141
    v_pk_fma_f32 v[120:121], v[208:209], v[182:183], v[210:211] op_sel_hi:[1,0,1]
    v_pk_fma_f32 v[124:125], v[212:213], v[182:183], v[214:215] op_sel_hi:[1,0,1]
    v_pk_fma_f32 v[128:129], v[216:217], v[182:183], v[218:219] op_sel_hi:[1,0,1]
    v_pk_fma_f32 v[132:133], v[220:221], v[182:183], v[222:223] op_sel_hi:[1,0,1]
    v_pk_fma_f32 v[136:137], v[224:225], v[182:183], v[226:227] op_sel_hi:[1,0,1]
    v_pk_fma_f32 v[140:141], v[228:229], v[182:183], v[230:231] op_sel_hi:[1,0,1]
    v_pk_fma_f32 v[120:121], v[52:53], v[182:183], v[120:121] op_sel:[0,1,0] op_sel_hi:[1,1,1]
    v_pk_fma_f32 v[124:125], v[54:55], v[182:183], v[124:125] op_sel:[0,1,0] op_sel_hi:[1,1,1]
    v_pk_fma_f32 v[128:129], v[56:57], v[182:183], v[128:129] op_sel:[0,1,0] op_sel_hi:[1,1,1]
    s_mov_b32 s63, 40960
    buffer_load_dwordx4 a[172:175], v253, s[8:11], s63 offen offset:3072
    v_pk_fma_f32 v[132:133], v[58:59], v[182:183], v[132:133] op_sel:[0,1,0] op_sel_hi:[1,1,1]
    v_pk_fma_f32 v[136:137], v[60:61], v[182:183], v[136:137] op_sel:[0,1,0] op_sel_hi:[1,1,1]
    v_pk_fma_f32 v[140:141], v[62:63], v[182:183], v[140:141] op_sel:[0,1,0] op_sel_hi:[1,1,1]
    v_pk_mul_f32 v[122:123], v[120:121], v[120:121]
    v_pk_mul_f32 v[130:131], v[128:129], v[128:129]
    v_pk_mul_f32 v[138:139], v[136:137], v[136:137]
    v_pk_fma_f32 v[122:123], v[122:123], v[114:115], v[112:113]
    v_pk_fma_f32 v[130:131], v[130:131], v[114:115], v[112:113]
    v_pk_fma_f32 v[138:139], v[138:139], v[114:115], v[112:113]
    v_pk_mul_f32 v[122:123], v[122:123], v[120:121]
    v_pk_mul_f32 v[130:131], v[130:131], v[128:129]
    v_pk_mul_f32 v[138:139], v[138:139], v[136:137]
    s_mov_b32 s63, 45056
    buffer_load_dwordx4 a[176:179], v253, s[8:11], s63 offen offset:0
    v_exp_f32 v122, v122
    v_exp_f32 v123, v123
    v_exp_f32 v130, v130
    v_exp_f32 v131, v131
    v_exp_f32 v138, v138
    v_exp_f32 v139, v139
    v_pk_mul_f32 v[124:125], v[120:121], v[124:125]
    v_pk_mul_f32 v[132:133], v[128:129], v[132:133]
    v_pk_mul_f32 v[140:141], v[136:137], v[140:141]
    v_pk_add_f32 v[122:123], v[122:123], v[116:117]
    v_pk_add_f32 v[130:131], v[130:131], v[116:117]
    v_pk_add_f32 v[138:139], v[138:139], v[116:117]
    s_mov_b32 s63, 45056
    buffer_load_dwordx4 a[180:183], v253, s[8:11], s63 offen offset:1024
    v_rcp_f32 v122, v122
    v_rcp_f32 v123, v123
    v_rcp_f32 v130, v130
    v_rcp_f32 v131, v131
    v_rcp_f32 v138, v138
    v_rcp_f32 v139, v139
    v_pk_mul_f32 v[124:125], v[124:125], v[122:123]
    v_pk_mul_f32 v[132:133], v[132:133], v[130:131]
    v_pk_mul_f32 v[140:141], v[140:141], v[138:139]
    v_cvt_pk_bf16_f32 v147, v124, v125
    v_cvt_pk_bf16_f32 v151, v132, v133
    v_cvt_pk_bf16_f32 v155, v140, v141
    s_mov_b32 s63, 45056
    buffer_load_dwordx4 a[184:187], v253, s[8:11], s63 offen offset:2048
    v_permlane32_swap_b32 v144, v146
    v_permlane32_swap_b32 v145, v147
    v_permlane32_swap_b32 v148, v150
    v_permlane32_swap_b32 v149, v151
    v_permlane32_swap_b32 v152, v154
    v_permlane32_swap_b32 v153, v155
    v_permlane16_swap_b32 v144, v145
    v_permlane16_swap_b32 v146, v147
    v_permlane16_swap_b32 v148, v149
    v_permlane16_swap_b32 v150, v151
    v_permlane16_swap_b32 v152, v153
    v_permlane16_swap_b32 v154, v155
    s_mov_b32 s63, 45056
    buffer_load_dwordx4 a[188:191], v253, s[8:11], s63 offen offset:3072
    s_mov_b32 s22, 0
    buffer_store_dwordx4 v[144:147], v4, s[8:11], s22 offen offset:0 sc1
    buffer_store_dwordx4 v[148:151], v4, s[8:11], s22 offen offset:1024 sc1
    buffer_store_dwordx4 v[152:155], v4, s[8:11], s22 offen offset:2048 sc1
    v_pk_fma_f32 v[120:121], v[208:209], v[184:185], v[210:211] op_sel_hi:[1,0,1]
    v_pk_fma_f32 v[124:125], v[212:213], v[184:185], v[214:215] op_sel_hi:[1,0,1]
    v_pk_fma_f32 v[128:129], v[216:217], v[184:185], v[218:219] op_sel_hi:[1,0,1]
    v_pk_fma_f32 v[132:133], v[220:221], v[184:185], v[222:223] op_sel_hi:[1,0,1]
    v_pk_fma_f32 v[136:137], v[224:225], v[184:185], v[226:227] op_sel_hi:[1,0,1]
    v_pk_fma_f32 v[140:141], v[228:229], v[184:185], v[230:231] op_sel_hi:[1,0,1]
    v_pk_fma_f32 v[120:121], v[64:65], v[184:185], v[120:121] op_sel:[0,1,0] op_sel_hi:[1,1,1]
    v_pk_fma_f32 v[124:125], v[66:67], v[184:185], v[124:125] op_sel:[0,1,0] op_sel_hi:[1,1,1]
    v_pk_fma_f32 v[128:129], v[68:69], v[184:185], v[128:129] op_sel:[0,1,0] op_sel_hi:[1,1,1]
    v_pk_fma_f32 v[132:133], v[70:71], v[184:185], v[132:133] op_sel:[0,1,0] op_sel_hi:[1,1,1]
    v_pk_fma_f32 v[136:137], v[72:73], v[184:185], v[136:137] op_sel:[0,1,0] op_sel_hi:[1,1,1]
    v_pk_fma_f32 v[140:141], v[74:75], v[184:185], v[140:141] op_sel:[0,1,0] op_sel_hi:[1,1,1]
    v_pk_mul_f32 v[122:123], v[120:121], v[120:121]
    v_pk_mul_f32 v[130:131], v[128:129], v[128:129]
    v_pk_mul_f32 v[138:139], v[136:137], v[136:137]
    v_pk_fma_f32 v[122:123], v[122:123], v[114:115], v[112:113]
    v_pk_fma_f32 v[130:131], v[130:131], v[114:115], v[112:113]
    v_pk_fma_f32 v[138:139], v[138:139], v[114:115], v[112:113]
    v_pk_mul_f32 v[122:123], v[122:123], v[120:121]
    v_pk_mul_f32 v[130:131], v[130:131], v[128:129]
    v_pk_mul_f32 v[138:139], v[138:139], v[136:137]
    v_exp_f32 v122, v122
    v_exp_f32 v123, v123
    v_exp_f32 v130, v130
    v_exp_f32 v131, v131
    v_exp_f32 v138, v138
    v_exp_f32 v139, v139
    v_pk_mul_f32 v[124:125], v[120:121], v[124:125]
    v_pk_mul_f32 v[132:133], v[128:129], v[132:133]
    v_pk_mul_f32 v[140:141], v[136:137], v[140:141]
    v_pk_add_f32 v[122:123], v[122:123], v[116:117]
    v_pk_add_f32 v[130:131], v[130:131], v[116:117]
    v_pk_add_f32 v[138:139], v[138:139], v[116:117]
    v_rcp_f32 v122, v122
    v_rcp_f32 v123, v123
    v_rcp_f32 v130, v130
    v_rcp_f32 v131, v131
    v_rcp_f32 v138, v138
    v_rcp_f32 v139, v139
    v_pk_mul_f32 v[124:125], v[124:125], v[122:123]
    v_pk_mul_f32 v[132:133], v[132:133], v[130:131]
    v_pk_mul_f32 v[140:141], v[140:141], v[138:139]
    v_cvt_pk_bf16_f32 v156, v124, v125
    v_cvt_pk_bf16_f32 v160, v132, v133
    v_cvt_pk_bf16_f32 v164, v140, v141
    v_pk_fma_f32 v[120:121], v[208:209], v[186:187], v[210:211] op_sel_hi:[1,0,1]
    v_pk_fma_f32 v[124:125], v[212:213], v[186:187], v[214:215] op_sel_hi:[1,0,1]
    v_pk_fma_f32 v[128:129], v[216:217], v[186:187], v[218:219] op_sel_hi:[1,0,1]
    v_pk_fma_f32 v[132:133], v[220:221], v[186:187], v[222:223] op_sel_hi:[1,0,1]
    v_pk_fma_f32 v[136:137], v[224:225], v[186:187], v[226:227] op_sel_hi:[1,0,1]
    v_pk_fma_f32 v[140:141], v[228:229], v[186:187], v[230:231] op_sel_hi:[1,0,1]
    v_pk_fma_f32 v[120:121], v[76:77], v[186:187], v[120:121] op_sel:[0,1,0] op_sel_hi:[1,1,1]
    v_pk_fma_f32 v[124:125], v[78:79], v[186:187], v[124:125] op_sel:[0,1,0] op_sel_hi:[1,1,1]
    v_pk_fma_f32 v[128:129], v[80:81], v[186:187], v[128:129] op_sel:[0,1,0] op_sel_hi:[1,1,1]
    v_pk_fma_f32 v[132:133], v[82:83], v[186:187], v[132:133] op_sel:[0,1,0] op_sel_hi:[1,1,1]
    v_pk_fma_f32 v[136:137], v[84:85], v[186:187], v[136:137] op_sel:[0,1,0] op_sel_hi:[1,1,1]
    v_pk_fma_f32 v[140:141], v[86:87], v[186:187], v[140:141] op_sel:[0,1,0] op_sel_hi:[1,1,1]
    v_pk_mul_f32 v[122:123], v[120:121], v[120:121]
    v_pk_mul_f32 v[130:131], v[128:129], v[128:129]
    v_pk_mul_f32 v[138:139], v[136:137], v[136:137]
    v_pk_fma_f32 v[122:123], v[122:123], v[114:115], v[112:113]
    v_pk_fma_f32 v[130:131], v[130:131], v[114:115], v[112:113]
    v_pk_fma_f32 v[138:139], v[138:139], v[114:115], v[112:113]
    v_pk_mul_f32 v[122:123], v[122:123], v[120:121]
    v_pk_mul_f32 v[130:131], v[130:131], v[128:129]
    v_pk_mul_f32 v[138:139], v[138:139], v[136:137]
    v_exp_f32 v122, v122
    v_exp_f32 v123, v123
    v_exp_f32 v130, v130
    v_exp_f32 v131, v131
    v_exp_f32 v138, v138
    v_exp_f32 v139, v139
    v_pk_mul_f32 v[124:125], v[120:121], v[124:125]
    v_pk_mul_f32 v[132:133], v[128:129], v[132:133]
    v_pk_mul_f32 v[140:141], v[136:137], v[140:141]
    v_pk_add_f32 v[122:123], v[122:123], v[116:117]
    v_pk_add_f32 v[130:131], v[130:131], v[116:117]
    v_pk_add_f32 v[138:139], v[138:139], v[116:117]
    v_rcp_f32 v122, v122
    v_rcp_f32 v123, v123
    v_rcp_f32 v130, v130
    v_rcp_f32 v131, v131
    v_rcp_f32 v138, v138
    v_rcp_f32 v139, v139
    v_pk_mul_f32 v[124:125], v[124:125], v[122:123]
    v_pk_mul_f32 v[132:133], v[132:133], v[130:131]
    v_pk_mul_f32 v[140:141], v[140:141], v[138:139]
    v_cvt_pk_bf16_f32 v157, v124, v125
    v_cvt_pk_bf16_f32 v161, v132, v133
    v_cvt_pk_bf16_f32 v165, v140, v141
    v_pk_fma_f32 v[120:121], v[208:209], v[188:189], v[210:211] op_sel_hi:[1,0,1]
    v_pk_fma_f32 v[124:125], v[212:213], v[188:189], v[214:215] op_sel_hi:[1,0,1]
    v_pk_fma_f32 v[128:129], v[216:217], v[188:189], v[218:219] op_sel_hi:[1,0,1]
    v_pk_fma_f32 v[132:133], v[220:221], v[188:189], v[222:223] op_sel_hi:[1,0,1]
    v_pk_fma_f32 v[136:137], v[224:225], v[188:189], v[226:227] op_sel_hi:[1,0,1]
    v_pk_fma_f32 v[140:141], v[228:229], v[188:189], v[230:231] op_sel_hi:[1,0,1]
    v_pk_fma_f32 v[120:121], v[88:89], v[188:189], v[120:121] op_sel:[0,1,0] op_sel_hi:[1,1,1]
    v_pk_fma_f32 v[124:125], v[90:91], v[188:189], v[124:125] op_sel:[0,1,0] op_sel_hi:[1,1,1]
    v_pk_fma_f32 v[128:129], v[92:93], v[188:189], v[128:129] op_sel:[0,1,0] op_sel_hi:[1,1,1]
    v_pk_fma_f32 v[132:133], v[94:95], v[188:189], v[132:133] op_sel:[0,1,0] op_sel_hi:[1,1,1]
    v_pk_fma_f32 v[136:137], v[96:97], v[188:189], v[136:137] op_sel:[0,1,0] op_sel_hi:[1,1,1]
    v_pk_fma_f32 v[140:141], v[98:99], v[188:189], v[140:141] op_sel:[0,1,0] op_sel_hi:[1,1,1]
    v_pk_mul_f32 v[122:123], v[120:121], v[120:121]
    v_pk_mul_f32 v[130:131], v[128:129], v[128:129]
    v_pk_mul_f32 v[138:139], v[136:137], v[136:137]
    v_pk_fma_f32 v[122:123], v[122:123], v[114:115], v[112:113]
    v_pk_fma_f32 v[130:131], v[130:131], v[114:115], v[112:113]
    v_pk_fma_f32 v[138:139], v[138:139], v[114:115], v[112:113]
    v_pk_mul_f32 v[122:123], v[122:123], v[120:121]
    v_pk_mul_f32 v[130:131], v[130:131], v[128:129]
    v_pk_mul_f32 v[138:139], v[138:139], v[136:137]
    v_exp_f32 v122, v122
    v_exp_f32 v123, v123
    v_exp_f32 v130, v130
    v_exp_f32 v131, v131
    v_exp_f32 v138, v138
    v_exp_f32 v139, v139
    v_pk_mul_f32 v[124:125], v[120:121], v[124:125]
    v_pk_mul_f32 v[132:133], v[128:129], v[132:133]
    v_pk_mul_f32 v[140:141], v[136:137], v[140:141]
    v_pk_add_f32 v[122:123], v[122:123], v[116:117]
    v_pk_add_f32 v[130:131], v[130:131], v[116:117]
    v_pk_add_f32 v[138:139], v[138:139], v[116:117]
    v_rcp_f32 v122, v122
    v_rcp_f32 v123, v123
    v_rcp_f32 v130, v130
    v_rcp_f32 v131, v131
    v_rcp_f32 v138, v138
    v_rcp_f32 v139, v139
    v_pk_mul_f32 v[124:125], v[124:125], v[122:123]
    v_pk_mul_f32 v[132:133], v[132:133], v[130:131]
    v_pk_mul_f32 v[140:141], v[140:141], v[138:139]
    v_cvt_pk_bf16_f32 v158, v124, v125
    v_cvt_pk_bf16_f32 v162, v132, v133
    v_cvt_pk_bf16_f32 v166, v140, v141
    v_pk_fma_f32 v[120:121], v[208:209], v[190:191], v[210:211] op_sel_hi:[1,0,1]
    v_pk_fma_f32 v[124:125], v[212:213], v[190:191], v[214:215] op_sel_hi:[1,0,1]
    v_pk_fma_f32 v[128:129], v[216:217], v[190:191], v[218:219] op_sel_hi:[1,0,1]
    v_pk_fma_f32 v[132:133], v[220:221], v[190:191], v[222:223] op_sel_hi:[1,0,1]
    v_pk_fma_f32 v[136:137], v[224:225], v[190:191], v[226:227] op_sel_hi:[1,0,1]
    v_pk_fma_f32 v[140:141], v[228:229], v[190:191], v[230:231] op_sel_hi:[1,0,1]
    v_pk_fma_f32 v[120:121], v[100:101], v[190:191], v[120:121] op_sel:[0,1,0] op_sel_hi:[1,1,1]
    v_pk_fma_f32 v[124:125], v[102:103], v[190:191], v[124:125] op_sel:[0,1,0] op_sel_hi:[1,1,1]
    v_pk_fma_f32 v[128:129], v[104:105], v[190:191], v[128:129] op_sel:[0,1,0] op_sel_hi:[1,1,1]
    v_pk_fma_f32 v[132:133], v[106:107], v[190:191], v[132:133] op_sel:[0,1,0] op_sel_hi:[1,1,1]
    v_pk_fma_f32 v[136:137], v[108:109], v[190:191], v[136:137] op_sel:[0,1,0] op_sel_hi:[1,1,1]
    v_pk_fma_f32 v[140:141], v[110:111], v[190:191], v[140:141] op_sel:[0,1,0] op_sel_hi:[1,1,1]
    v_pk_mul_f32 v[122:123], v[120:121], v[120:121]
    v_pk_mul_f32 v[130:131], v[128:129], v[128:129]
    v_pk_mul_f32 v[138:139], v[136:137], v[136:137]
    v_pk_fma_f32 v[122:123], v[122:123], v[114:115], v[112:113]
    v_pk_fma_f32 v[130:131], v[130:131], v[114:115], v[112:113]
    v_pk_fma_f32 v[138:139], v[138:139], v[114:115], v[112:113]
    v_pk_mul_f32 v[122:123], v[122:123], v[120:121]
    v_pk_mul_f32 v[130:131], v[130:131], v[128:129]
    v_pk_mul_f32 v[138:139], v[138:139], v[136:137]
    v_exp_f32 v122, v122
    v_exp_f32 v123, v123
    v_exp_f32 v130, v130
    v_exp_f32 v131, v131
    v_exp_f32 v138, v138
    v_exp_f32 v139, v139
    v_pk_mul_f32 v[124:125], v[120:121], v[124:125]
    v_pk_mul_f32 v[132:133], v[128:129], v[132:133]
    v_pk_mul_f32 v[140:141], v[136:137], v[140:141]
    v_pk_add_f32 v[122:123], v[122:123], v[116:117]
    v_pk_add_f32 v[130:131], v[130:131], v[116:117]
    v_pk_add_f32 v[138:139], v[138:139], v[116:117]
    v_rcp_f32 v122, v122
    v_rcp_f32 v123, v123
    v_rcp_f32 v130, v130
    v_rcp_f32 v131, v131
    v_rcp_f32 v138, v138
    v_rcp_f32 v139, v139
    v_pk_mul_f32 v[124:125], v[124:125], v[122:123]
    v_pk_mul_f32 v[132:133], v[132:133], v[130:131]
    v_pk_mul_f32 v[140:141], v[140:141], v[138:139]
    v_cvt_pk_bf16_f32 v159, v124, v125
    v_cvt_pk_bf16_f32 v163, v132, v133
    v_cvt_pk_bf16_f32 v167, v140, v141
    v_permlane32_swap_b32 v156, v158
    v_permlane32_swap_b32 v157, v159
    v_permlane32_swap_b32 v160, v162
    v_permlane32_swap_b32 v161, v163
    v_permlane32_swap_b32 v164, v166
    v_permlane32_swap_b32 v165, v167
    v_permlane16_swap_b32 v156, v157
    v_permlane16_swap_b32 v158, v159
    v_permlane16_swap_b32 v160, v161
    v_permlane16_swap_b32 v162, v163
    v_permlane16_swap_b32 v164, v165
    v_permlane16_swap_b32 v166, v167
    s_mov_b32 s22, 196608
    buffer_store_dwordx4 v[156:159], v4, s[8:11], s22 offen offset:0 sc1
    buffer_store_dwordx4 v[160:163], v4, s[8:11], s22 offen offset:1024 sc1
    buffer_store_dwordx4 v[164:167], v4, s[8:11], s22 offen offset:2048 sc1
    s_mul_i32 s22, s52, 4352
    s_lshl_b32 s23, s53, 2
    s_add_u32 s22, s22, s23
    s_add_u32 s22, s22, 0x51000
    s_waitcnt vmcnt(0)
KF_S4_BAR:
    s_barrier
    s_cmp_lg_u32 s20, 0
    s_cbranch_scc1 KF_S4_SIG
    v_mov_b32 v8, s22
    v_mov_b32 v9, 1
    s_mov_b64 s[26:27], exec
    s_mov_b64 exec, 1
    buffer_store_dword v9, v8, s[8:11], 0 offen sc1
    s_mov_b64 exec, s[26:27]
KF_S4_SIG:
    s_mov_b32 s63, 49152
    buffer_load_dwordx4 a[192:195], v253, s[8:11], s63 offen offset:0
    s_mov_b32 s63, 49152
    buffer_load_dwordx4 a[196:199], v253, s[8:11], s63 offen offset:1024
    s_mov_b32 s63, 49152
    buffer_load_dwordx4 a[200:203], v253, s[8:11], s63 offen offset:2048
    s_mov_b32 s63, 49152
    buffer_load_dwordx4 a[204:207], v253, s[8:11], s63 offen offset:3072
    s_mov_b32 s63, 53248
    buffer_load_dwordx4 a[208:211], v253, s[8:11], s63 offen offset:0
    s_mov_b32 s63, 53248
    buffer_load_dwordx4 a[212:215], v253, s[8:11], s63 offen offset:1024
    s_mov_b32 s63, 53248
    buffer_load_dwordx4 a[216:219], v253, s[8:11], s63 offen offset:2048
    s_mov_b32 s63, 53248
    buffer_load_dwordx4 a[220:223], v253, s[8:11], s63 offen offset:3072
    s_mov_b32 s63, 57344
    buffer_load_dwordx4 a[224:227], v253, s[8:11], s63 offen offset:0
    s_mov_b32 s63, 57344
    buffer_load_dwordx4 a[228:231], v253, s[8:11], s63 offen offset:1024
    s_mov_b32 s63, 57344
    buffer_load_dwordx4 a[232:235], v253, s[8:11], s63 offen offset:2048
    s_mov_b32 s63, 57344
    buffer_load_dwordx4 a[236:239], v253, s[8:11], s63 offen offset:3072
    s_mul_i32 s23, s20, 12
    s_mul_i32 s22, s54, 192
    s_add_u32 s22, s22, s23
    s_lshl_b32 s22, s22, 10
    s_add_u32 s22, s22, 0x1200000
    s_add_u32 s23, s20, 0
    s_and_b32 s23, s23, 3
    s_mul_i32 s24, s23, 49152
    s_add_u32 s24, s24, s22
    v_add_u32 v4, s24, v255
    s_add_u32 s23, s20, 1
    s_and_b32 s23, s23, 3
    s_mul_i32 s24, s23, 49152
    s_add_u32 s24, s24, s22
    v_add_u32 v5, s24, v255
    s_mul_i32 s24, s23, 15360
    s_add_u32 s24, s24, 0
    v_add_u32 v241, s24, v255
    s_add_u32 s23, s20, 2
    s_and_b32 s23, s23, 3
    s_mul_i32 s24, s23, 49152
    s_add_u32 s24, s24, s22
    v_add_u32 v6, s24, v255
    s_mul_i32 s24, s23, 15360
    s_add_u32 s24, s24, 5120
    v_add_u32 v242, s24, v255
    s_add_u32 s23, s20, 3
    s_and_b32 s23, s23, 3
    s_mul_i32 s24, s23, 49152
    s_add_u32 s24, s24, s22
    v_add_u32 v7, s24, v255
    s_mul_i32 s24, s23, 15360
    s_add_u32 s24, s24, 10240
    v_add_u32 v243, s24, v255
    s_mul_i32 s24, s20, 15360
    v_add_u32 v240, s24, v255
    s_lshl_b32 s22, s54, 2
    s_add_u32 s22, s22, s20
    s_mul_i32 s22, s22, 20480
    s_and_b32 s23, s55, 3
    s_mul_i32 s23, s23, 5120
    s_add_u32 s22, s22, s23
    s_lshr_b32 s23, s55, 2
    s_lshl_b32 s23, s23, 3
    s_add_u32 s22, s22, s23
    s_add_u32 s22, s22, 0x700000
    v_mul_u32_u24 v10, 1280, v2
    v_lshl_add_u32 v10, v1, 4, v10
    v_add_u32 v10, s22, v10
    s_mul_i32 s22, s55, 320
    s_add_u32 s22, s22, 12800
    v_mul_u32_u24 v11, 80, v2
    v_add_u32 v11, s22, v11
    s_lshl_b32 s24, s20, 12
    s_add_u32 s24, s24, 65536
    v_mul_u32_u24 v12, 176, v1
    v_mul_u32_u24 v13, 40, v2
    v_add3_u32 v12, v12, v13, s24
    s_mul_i32 s22, s20, 655360
    s_mul_i32 s23, s54, 1280
    s_add_u32 s22, s22, s23
    s_mul_i32 s23, s55, 160
    s_add_u32 s22, s22, s23
    v_add_u32 v13, 0, v3
    v_mul_u32_u24 v14, 205, v13
    v_lshrrev_b32 v14, 11, v14
    v_mul_u32_u24 v15, 10, v14
    v_sub_u32 v13, v13, v15
    v_lshlrev_b32 v13, 4, v13
    v_mul_u32_u24 v15, 176, v14
    v_add3_u32 v244, v15, v13, s24
    v_mul_u32_u24 v15, 40960, v14
    v_add3_u32 v247, v15, v13, s22
    v_add_u32 v13, 64, v3
    v_mul_u32_u24 v14, 205, v13
    v_lshrrev_b32 v14, 11, v14
    v_mul_u32_u24 v15, 10, v14
    v_sub_u32 v13, v13, v15
    v_lshlrev_b32 v13, 4, v13
    v_mul_u32_u24 v15, 176, v14
    v_add3_u32 v245, v15, v13, s24
    v_mul_u32_u24 v15, 40960, v14
    v_add3_u32 v248, v15, v13, s22
    v_add_u32 v13, 128, v3
    v_min_u32 v13, 159, v13
    v_mul_u32_u24 v14, 205, v13
    v_lshrrev_b32 v14, 11, v14
    v_mul_u32_u24 v15, 10, v14
    v_sub_u32 v13, v13, v15
    v_lshlrev_b32 v13, 4, v13
    v_mul_u32_u24 v15, 176, v14
    v_add3_u32 v246, v15, v13, s24
    v_mul_u32_u24 v15, 40960, v14
    v_add3_u32 v249, v15, v13, s22
    s_lshr_b32 s22, s54, 1
    s_mul_i32 s22, s22, 4352
    s_add_u32 s22, s22, 0x51000
    s_cmp_lg_u32 s20, 0
    s_cbranch_scc1 KF_W4_DONE
    v_min_u32 v8, 15, v3
    v_lshl_add_u32 v8, v8, 2, s22
    s_mov_b32 s28, 0
KF_W4_LOOP:
    buffer_load_dword v250, v8, s[8:11], 0 offen sc1
    s_add_u32 s28, s28, 1
    s_waitcnt vmcnt(0)
    v_cmp_eq_u32 vcc, 0, v250
    s_cmp_ge_u32 s28, 200000
    s_cbranch_scc1 KF_W4_DONE
    s_cbranch_vccz KF_W4_DONE
    s_sleep 2
    s_branch KF_W4_LOOP
KF_W4_DONE:
    s_barrier
    s_movk_i32 s22, 0
    buffer_load_dwordx4 v[96:99], v4, s[8:11], s22 offen offset:0 sc1
    buffer_load_dwordx4 v[100:103], v5, s[8:11], s22 offen offset:0 sc1
    buffer_load_dwordx4 v[104:107], v6, s[8:11], s22 offen offset:0 sc1
    buffer_load_dwordx4 v[108:111], v7, s[8:11], s22 offen offset:0 sc1
    s_movk_i32 s22, 0
    buffer_load_dwordx4 v[112:115], v4, s[8:11], s22 offen offset:1024 sc1
    buffer_load_dwordx4 v[116:119], v5, s[8:11], s22 offen offset:1024 sc1
    buffer_load_dwordx4 v[120:123], v6, s[8:11], s22 offen offset:1024 sc1
    buffer_load_dwordx4 v[124:127], v7, s[8:11], s22 offen offset:1024 sc1
    s_movk_i32 s22, 0
    buffer_load_dwordx4 v[128:131], v4, s[8:11], s22 offen offset:2048 sc1
    buffer_load_dwordx4 v[132:135], v5, s[8:11], s22 offen offset:2048 sc1
    buffer_load_dwordx4 v[136:139], v6, s[8:11], s22 offen offset:2048 sc1
    buffer_load_dwordx4 v[140:143], v7, s[8:11], s22 offen offset:2048 sc1
    s_movk_i32 s22, 0
    buffer_load_dwordx4 v[144:147], v4, s[8:11], s22 offen offset:3072 sc1
    buffer_load_dwordx4 v[148:151], v5, s[8:11], s22 offen offset:3072 sc1
    buffer_load_dwordx4 v[152:155], v6, s[8:11], s22 offen offset:3072 sc1
    buffer_load_dwordx4 v[156:159], v7, s[8:11], s22 offen offset:3072 sc1
    s_movk_i32 s22, 4096
    buffer_load_dwordx4 v[160:163], v4, s[8:11], s22 offen offset:0 sc1
    buffer_load_dwordx4 v[164:167], v5, s[8:11], s22 offen offset:0 sc1
    buffer_load_dwordx4 v[168:171], v6, s[8:11], s22 offen offset:0 sc1
    buffer_load_dwordx4 v[172:175], v7, s[8:11], s22 offen offset:0 sc1
    s_waitcnt vmcnt(16)
    v_mfma_f32_16x16x32_bf16 v[16:19], a[0:3], v[96:99], 0
    v_mfma_f32_16x16x32_bf16 v[20:23], a[4:7], v[96:99], 0
    v_mfma_f32_16x16x32_bf16 v[24:27], a[8:11], v[96:99], 0
    v_mfma_f32_16x16x32_bf16 v[28:31], a[12:15], v[96:99], 0
    s_movk_i32 s22, 4096
    buffer_load_dwordx4 v[176:179], v4, s[8:11], s22 offen offset:1024 sc1
    v_mfma_f32_16x16x32_bf16 v[32:35], a[16:19], v[96:99], 0
    v_mfma_f32_16x16x32_bf16 v[36:39], a[0:3], v[100:103], 0
    v_mfma_f32_16x16x32_bf16 v[40:43], a[4:7], v[100:103], 0
    v_mfma_f32_16x16x32_bf16 v[44:47], a[8:11], v[100:103], 0
    buffer_load_dwordx4 v[180:183], v5, s[8:11], s22 offen offset:1024 sc1
    v_mfma_f32_16x16x32_bf16 v[48:51], a[12:15], v[100:103], 0
    v_mfma_f32_16x16x32_bf16 v[52:55], a[16:19], v[100:103], 0
    v_mfma_f32_16x16x32_bf16 v[56:59], a[0:3], v[104:107], 0
    v_mfma_f32_16x16x32_bf16 v[60:63], a[4:7], v[104:107], 0
    buffer_load_dwordx4 v[184:187], v6, s[8:11], s22 offen offset:1024 sc1
    v_mfma_f32_16x16x32_bf16 v[64:67], a[8:11], v[104:107], 0
    v_mfma_f32_16x16x32_bf16 v[68:71], a[12:15], v[104:107], 0
    v_mfma_f32_16x16x32_bf16 v[72:75], a[16:19], v[104:107], 0
    v_mfma_f32_16x16x32_bf16 v[76:79], a[0:3], v[108:111], 0
    buffer_load_dwordx4 v[188:191], v7, s[8:11], s22 offen offset:1024 sc1
    v_mfma_f32_16x16x32_bf16 v[80:83], a[4:7], v[108:111], 0
    v_mfma_f32_16x16x32_bf16 v[84:87], a[8:11], v[108:111], 0
    v_mfma_f32_16x16x32_bf16 v[88:91], a[12:15], v[108:111], 0
    v_mfma_f32_16x16x32_bf16 v[92:95], a[16:19], v[108:111], 0
    s_waitcnt vmcnt(16)
    v_mfma_f32_16x16x32_bf16 v[16:19], a[20:23], v[112:115], v[16:19]
    v_mfma_f32_16x16x32_bf16 v[20:23], a[24:27], v[112:115], v[20:23]
    v_mfma_f32_16x16x32_bf16 v[24:27], a[28:31], v[112:115], v[24:27]
    v_mfma_f32_16x16x32_bf16 v[28:31], a[32:35], v[112:115], v[28:31]
    s_movk_i32 s22, 4096
    buffer_load_dwordx4 v[192:195], v4, s[8:11], s22 offen offset:2048 sc1
    v_mfma_f32_16x16x32_bf16 v[32:35], a[36:39], v[112:115], v[32:35]
    v_mfma_f32_16x16x32_bf16 v[36:39], a[20:23], v[116:119], v[36:39]
    v_mfma_f32_16x16x32_bf16 v[40:43], a[24:27], v[116:119], v[40:43]
    v_mfma_f32_16x16x32_bf16 v[44:47], a[28:31], v[116:119], v[44:47]
    buffer_load_dwordx4 v[196:199], v5, s[8:11], s22 offen offset:2048 sc1
    v_mfma_f32_16x16x32_bf16 v[48:51], a[32:35], v[116:119], v[48:51]
    v_mfma_f32_16x16x32_bf16 v[52:55], a[36:39], v[116:119], v[52:55]
    v_mfma_f32_16x16x32_bf16 v[56:59], a[20:23], v[120:123], v[56:59]
    v_mfma_f32_16x16x32_bf16 v[60:63], a[24:27], v[120:123], v[60:63]
    buffer_load_dwordx4 v[200:203], v6, s[8:11], s22 offen offset:2048 sc1
    v_mfma_f32_16x16x32_bf16 v[64:67], a[28:31], v[120:123], v[64:67]
    v_mfma_f32_16x16x32_bf16 v[68:71], a[32:35], v[120:123], v[68:71]
    v_mfma_f32_16x16x32_bf16 v[72:75], a[36:39], v[120:123], v[72:75]
    v_mfma_f32_16x16x32_bf16 v[76:79], a[20:23], v[124:127], v[76:79]
    buffer_load_dwordx4 v[204:207], v7, s[8:11], s22 offen offset:2048 sc1
    v_mfma_f32_16x16x32_bf16 v[80:83], a[24:27], v[124:127], v[80:83]
    v_mfma_f32_16x16x32_bf16 v[84:87], a[28:31], v[124:127], v[84:87]
    v_mfma_f32_16x16x32_bf16 v[88:91], a[32:35], v[124:127], v[88:91]
    v_mfma_f32_16x16x32_bf16 v[92:95], a[36:39], v[124:127], v[92:95]
    s_waitcnt vmcnt(16)
    v_mfma_f32_16x16x32_bf16 v[16:19], a[40:43], v[128:131], v[16:19]
    v_mfma_f32_16x16x32_bf16 v[20:23], a[44:47], v[128:131], v[20:23]
    v_mfma_f32_16x16x32_bf16 v[24:27], a[48:51], v[128:131], v[24:27]
    v_mfma_f32_16x16x32_bf16 v[28:31], a[52:55], v[128:131], v[28:31]
    s_movk_i32 s22, 4096
    buffer_load_dwordx4 v[208:211], v4, s[8:11], s22 offen offset:3072 sc1
    v_mfma_f32_16x16x32_bf16 v[32:35], a[56:59], v[128:131], v[32:35]
    v_mfma_f32_16x16x32_bf16 v[36:39], a[40:43], v[132:135], v[36:39]
    v_mfma_f32_16x16x32_bf16 v[40:43], a[44:47], v[132:135], v[40:43]
    v_mfma_f32_16x16x32_bf16 v[44:47], a[48:51], v[132:135], v[44:47]
    buffer_load_dwordx4 v[212:215], v5, s[8:11], s22 offen offset:3072 sc1
    v_mfma_f32_16x16x32_bf16 v[48:51], a[52:55], v[132:135], v[48:51]
    v_mfma_f32_16x16x32_bf16 v[52:55], a[56:59], v[132:135], v[52:55]
    v_mfma_f32_16x16x32_bf16 v[56:59], a[40:43], v[136:139], v[56:59]
    v_mfma_f32_16x16x32_bf16 v[60:63], a[44:47], v[136:139], v[60:63]
    buffer_load_dwordx4 v[216:219], v6, s[8:11], s22 offen offset:3072 sc1
    v_mfma_f32_16x16x32_bf16 v[64:67], a[48:51], v[136:139], v[64:67]
    v_mfma_f32_16x16x32_bf16 v[68:71], a[52:55], v[136:139], v[68:71]
    v_mfma_f32_16x16x32_bf16 v[72:75], a[56:59], v[136:139], v[72:75]
    v_mfma_f32_16x16x32_bf16 v[76:79], a[40:43], v[140:143], v[76:79]
    buffer_load_dwordx4 v[220:223], v7, s[8:11], s22 offen offset:3072 sc1
    v_mfma_f32_16x16x32_bf16 v[80:83], a[44:47], v[140:143], v[80:83]
    v_mfma_f32_16x16x32_bf16 v[84:87], a[48:51], v[140:143], v[84:87]
    v_mfma_f32_16x16x32_bf16 v[88:91], a[52:55], v[140:143], v[88:91]
    v_mfma_f32_16x16x32_bf16 v[92:95], a[56:59], v[140:143], v[92:95]
    s_waitcnt vmcnt(16)
    v_mfma_f32_16x16x32_bf16 v[16:19], a[60:63], v[144:147], v[16:19]
    v_mfma_f32_16x16x32_bf16 v[20:23], a[64:67], v[144:147], v[20:23]
    v_mfma_f32_16x16x32_bf16 v[24:27], a[68:71], v[144:147], v[24:27]
    v_mfma_f32_16x16x32_bf16 v[28:31], a[72:75], v[144:147], v[28:31]
    s_movk_i32 s22, 8192
    buffer_load_dwordx4 v[224:227], v4, s[8:11], s22 offen offset:0 sc1
    v_mfma_f32_16x16x32_bf16 v[32:35], a[76:79], v[144:147], v[32:35]
    v_mfma_f32_16x16x32_bf16 v[36:39], a[60:63], v[148:151], v[36:39]
    v_mfma_f32_16x16x32_bf16 v[40:43], a[64:67], v[148:151], v[40:43]
    v_mfma_f32_16x16x32_bf16 v[44:47], a[68:71], v[148:151], v[44:47]
    buffer_load_dwordx4 v[228:231], v5, s[8:11], s22 offen offset:0 sc1
    v_mfma_f32_16x16x32_bf16 v[48:51], a[72:75], v[148:151], v[48:51]
    v_mfma_f32_16x16x32_bf16 v[52:55], a[76:79], v[148:151], v[52:55]
    v_mfma_f32_16x16x32_bf16 v[56:59], a[60:63], v[152:155], v[56:59]
    v_mfma_f32_16x16x32_bf16 v[60:63], a[64:67], v[152:155], v[60:63]
    buffer_load_dwordx4 v[232:235], v6, s[8:11], s22 offen offset:0 sc1
    v_mfma_f32_16x16x32_bf16 v[64:67], a[68:71], v[152:155], v[64:67]
    v_mfma_f32_16x16x32_bf16 v[68:71], a[72:75], v[152:155], v[68:71]
    v_mfma_f32_16x16x32_bf16 v[72:75], a[76:79], v[152:155], v[72:75]
    v_mfma_f32_16x16x32_bf16 v[76:79], a[60:63], v[156:159], v[76:79]
    buffer_load_dwordx4 v[236:239], v7, s[8:11], s22 offen offset:0 sc1
    v_mfma_f32_16x16x32_bf16 v[80:83], a[64:67], v[156:159], v[80:83]
    v_mfma_f32_16x16x32_bf16 v[84:87], a[68:71], v[156:159], v[84:87]
    v_mfma_f32_16x16x32_bf16 v[88:91], a[72:75], v[156:159], v[88:91]
    v_mfma_f32_16x16x32_bf16 v[92:95], a[76:79], v[156:159], v[92:95]
    s_waitcnt vmcnt(16)
    v_mfma_f32_16x16x32_bf16 v[16:19], a[80:83], v[160:163], v[16:19]
    v_mfma_f32_16x16x32_bf16 v[20:23], a[84:87], v[160:163], v[20:23]
    v_mfma_f32_16x16x32_bf16 v[24:27], a[88:91], v[160:163], v[24:27]
    v_mfma_f32_16x16x32_bf16 v[28:31], a[92:95], v[160:163], v[28:31]
    s_movk_i32 s22, 8192
    buffer_load_dwordx4 v[96:99], v4, s[8:11], s22 offen offset:1024 sc1
    v_mfma_f32_16x16x32_bf16 v[32:35], a[96:99], v[160:163], v[32:35]
    v_mfma_f32_16x16x32_bf16 v[36:39], a[80:83], v[164:167], v[36:39]
    v_mfma_f32_16x16x32_bf16 v[40:43], a[84:87], v[164:167], v[40:43]
    v_mfma_f32_16x16x32_bf16 v[44:47], a[88:91], v[164:167], v[44:47]
    buffer_load_dwordx4 v[100:103], v5, s[8:11], s22 offen offset:1024 sc1
    v_mfma_f32_16x16x32_bf16 v[48:51], a[92:95], v[164:167], v[48:51]
    v_mfma_f32_16x16x32_bf16 v[52:55], a[96:99], v[164:167], v[52:55]
    v_mfma_f32_16x16x32_bf16 v[56:59], a[80:83], v[168:171], v[56:59]
    v_mfma_f32_16x16x32_bf16 v[60:63], a[84:87], v[168:171], v[60:63]
    buffer_load_dwordx4 v[104:107], v6, s[8:11], s22 offen offset:1024 sc1
    v_mfma_f32_16x16x32_bf16 v[64:67], a[88:91], v[168:171], v[64:67]
    v_mfma_f32_16x16x32_bf16 v[68:71], a[92:95], v[168:171], v[68:71]
    v_mfma_f32_16x16x32_bf16 v[72:75], a[96:99], v[168:171], v[72:75]
    v_mfma_f32_16x16x32_bf16 v[76:79], a[80:83], v[172:175], v[76:79]
    buffer_load_dwordx4 v[108:111], v7, s[8:11], s22 offen offset:1024 sc1
    v_mfma_f32_16x16x32_bf16 v[80:83], a[84:87], v[172:175], v[80:83]
    v_mfma_f32_16x16x32_bf16 v[84:87], a[88:91], v[172:175], v[84:87]
    v_mfma_f32_16x16x32_bf16 v[88:91], a[92:95], v[172:175], v[88:91]
    v_mfma_f32_16x16x32_bf16 v[92:95], a[96:99], v[172:175], v[92:95]
    s_waitcnt vmcnt(16)
    v_mfma_f32_16x16x32_bf16 v[16:19], a[100:103], v[176:179], v[16:19]
    v_mfma_f32_16x16x32_bf16 v[20:23], a[104:107], v[176:179], v[20:23]
    v_mfma_f32_16x16x32_bf16 v[24:27], a[108:111], v[176:179], v[24:27]
    v_mfma_f32_16x16x32_bf16 v[28:31], a[112:115], v[176:179], v[28:31]
    s_movk_i32 s22, 8192
    buffer_load_dwordx4 v[112:115], v4, s[8:11], s22 offen offset:2048 sc1
    v_mfma_f32_16x16x32_bf16 v[32:35], a[116:119], v[176:179], v[32:35]
    v_mfma_f32_16x16x32_bf16 v[36:39], a[100:103], v[180:183], v[36:39]
    v_mfma_f32_16x16x32_bf16 v[40:43], a[104:107], v[180:183], v[40:43]
    v_mfma_f32_16x16x32_bf16 v[44:47], a[108:111], v[180:183], v[44:47]
    buffer_load_dwordx4 v[116:119], v5, s[8:11], s22 offen offset:2048 sc1
    v_mfma_f32_16x16x32_bf16 v[48:51], a[112:115], v[180:183], v[48:51]
    v_mfma_f32_16x16x32_bf16 v[52:55], a[116:119], v[180:183], v[52:55]
    v_mfma_f32_16x16x32_bf16 v[56:59], a[100:103], v[184:187], v[56:59]
    v_mfma_f32_16x16x32_bf16 v[60:63], a[104:107], v[184:187], v[60:63]
    buffer_load_dwordx4 v[120:123], v6, s[8:11], s22 offen offset:2048 sc1
    v_mfma_f32_16x16x32_bf16 v[64:67], a[108:111], v[184:187], v[64:67]
    v_mfma_f32_16x16x32_bf16 v[68:71], a[112:115], v[184:187], v[68:71]
    v_mfma_f32_16x16x32_bf16 v[72:75], a[116:119], v[184:187], v[72:75]
    v_mfma_f32_16x16x32_bf16 v[76:79], a[100:103], v[188:191], v[76:79]
    buffer_load_dwordx4 v[124:127], v7, s[8:11], s22 offen offset:2048 sc1
    v_mfma_f32_16x16x32_bf16 v[80:83], a[104:107], v[188:191], v[80:83]
    v_mfma_f32_16x16x32_bf16 v[84:87], a[108:111], v[188:191], v[84:87]
    v_mfma_f32_16x16x32_bf16 v[88:91], a[112:115], v[188:191], v[88:91]
    v_mfma_f32_16x16x32_bf16 v[92:95], a[116:119], v[188:191], v[92:95]
    s_waitcnt vmcnt(16)
    v_mfma_f32_16x16x32_bf16 v[16:19], a[120:123], v[192:195], v[16:19]
    v_mfma_f32_16x16x32_bf16 v[20:23], a[124:127], v[192:195], v[20:23]
    v_mfma_f32_16x16x32_bf16 v[24:27], a[128:131], v[192:195], v[24:27]
    v_mfma_f32_16x16x32_bf16 v[28:31], a[132:135], v[192:195], v[28:31]
    s_movk_i32 s22, 8192
    buffer_load_dwordx4 v[128:131], v4, s[8:11], s22 offen offset:3072 sc1
    v_mfma_f32_16x16x32_bf16 v[32:35], a[136:139], v[192:195], v[32:35]
    v_mfma_f32_16x16x32_bf16 v[36:39], a[120:123], v[196:199], v[36:39]
    v_mfma_f32_16x16x32_bf16 v[40:43], a[124:127], v[196:199], v[40:43]
    v_mfma_f32_16x16x32_bf16 v[44:47], a[128:131], v[196:199], v[44:47]
    buffer_load_dwordx4 v[132:135], v5, s[8:11], s22 offen offset:3072 sc1
    v_mfma_f32_16x16x32_bf16 v[48:51], a[132:135], v[196:199], v[48:51]
    v_mfma_f32_16x16x32_bf16 v[52:55], a[136:139], v[196:199], v[52:55]
    v_mfma_f32_16x16x32_bf16 v[56:59], a[120:123], v[200:203], v[56:59]
    v_mfma_f32_16x16x32_bf16 v[60:63], a[124:127], v[200:203], v[60:63]
    buffer_load_dwordx4 v[136:139], v6, s[8:11], s22 offen offset:3072 sc1
    v_mfma_f32_16x16x32_bf16 v[64:67], a[128:131], v[200:203], v[64:67]
    v_mfma_f32_16x16x32_bf16 v[68:71], a[132:135], v[200:203], v[68:71]
    v_mfma_f32_16x16x32_bf16 v[72:75], a[136:139], v[200:203], v[72:75]
    v_mfma_f32_16x16x32_bf16 v[76:79], a[120:123], v[204:207], v[76:79]
    buffer_load_dwordx4 v[140:143], v7, s[8:11], s22 offen offset:3072 sc1
    v_mfma_f32_16x16x32_bf16 v[80:83], a[124:127], v[204:207], v[80:83]
    v_mfma_f32_16x16x32_bf16 v[84:87], a[128:131], v[204:207], v[84:87]
    v_mfma_f32_16x16x32_bf16 v[88:91], a[132:135], v[204:207], v[88:91]
    v_mfma_f32_16x16x32_bf16 v[92:95], a[136:139], v[204:207], v[92:95]
    s_waitcnt vmcnt(16)
    v_mfma_f32_16x16x32_bf16 v[16:19], a[140:143], v[208:211], v[16:19]
    v_mfma_f32_16x16x32_bf16 v[20:23], a[144:147], v[208:211], v[20:23]
    v_mfma_f32_16x16x32_bf16 v[24:27], a[148:151], v[208:211], v[24:27]
    v_mfma_f32_16x16x32_bf16 v[28:31], a[152:155], v[208:211], v[28:31]
    buffer_load_dwordx2 v[176:177], v10, s[8:11], 0 offen offset:0 sc1
    v_mfma_f32_16x16x32_bf16 v[32:35], a[156:159], v[208:211], v[32:35]
    v_mfma_f32_16x16x32_bf16 v[36:39], a[140:143], v[212:215], v[36:39]
    v_mfma_f32_16x16x32_bf16 v[40:43], a[144:147], v[212:215], v[40:43]
    v_mfma_f32_16x16x32_bf16 v[44:47], a[148:151], v[212:215], v[44:47]
    buffer_load_dwordx2 v[178:179], v10, s[8:11], 0 offen offset:256 sc1
    v_mfma_f32_16x16x32_bf16 v[48:51], a[152:155], v[212:215], v[48:51]
    v_mfma_f32_16x16x32_bf16 v[52:55], a[156:159], v[212:215], v[52:55]
    v_mfma_f32_16x16x32_bf16 v[56:59], a[140:143], v[216:219], v[56:59]
    v_mfma_f32_16x16x32_bf16 v[60:63], a[144:147], v[216:219], v[60:63]
    buffer_load_dwordx2 v[180:181], v10, s[8:11], 0 offen offset:512 sc1
    v_mfma_f32_16x16x32_bf16 v[64:67], a[148:151], v[216:219], v[64:67]
    v_mfma_f32_16x16x32_bf16 v[68:71], a[152:155], v[216:219], v[68:71]
    v_mfma_f32_16x16x32_bf16 v[72:75], a[156:159], v[216:219], v[72:75]
    v_mfma_f32_16x16x32_bf16 v[76:79], a[140:143], v[220:223], v[76:79]
    buffer_load_dwordx2 v[182:183], v10, s[8:11], 0 offen offset:768 sc1
    v_mfma_f32_16x16x32_bf16 v[80:83], a[144:147], v[220:223], v[80:83]
    v_mfma_f32_16x16x32_bf16 v[84:87], a[148:151], v[220:223], v[84:87]
    v_mfma_f32_16x16x32_bf16 v[88:91], a[152:155], v[220:223], v[88:91]
    v_mfma_f32_16x16x32_bf16 v[92:95], a[156:159], v[220:223], v[92:95]
    buffer_load_dwordx2 v[184:185], v10, s[8:11], 0 offen offset:1024 sc1
    s_waitcnt vmcnt(17)
    v_mfma_f32_16x16x32_bf16 v[16:19], a[160:163], v[224:227], v[16:19]
    v_mfma_f32_16x16x32_bf16 v[20:23], a[164:167], v[224:227], v[20:23]
    v_mfma_f32_16x16x32_bf16 v[24:27], a[168:171], v[224:227], v[24:27]
    v_mfma_f32_16x16x32_bf16 v[28:31], a[172:175], v[224:227], v[28:31]
    buffer_load_dwordx4 v[144:147], v11, s[8:11], 0 offen offset:0
    v_mfma_f32_16x16x32_bf16 v[32:35], a[176:179], v[224:227], v[32:35]
    v_mfma_f32_16x16x32_bf16 v[36:39], a[160:163], v[228:231], v[36:39]
    v_mfma_f32_16x16x32_bf16 v[40:43], a[164:167], v[228:231], v[40:43]
    v_mfma_f32_16x16x32_bf16 v[44:47], a[168:171], v[228:231], v[44:47]
    buffer_load_dwordx4 v[148:151], v11, s[8:11], 0 offen offset:16
    v_mfma_f32_16x16x32_bf16 v[48:51], a[172:175], v[228:231], v[48:51]
    v_mfma_f32_16x16x32_bf16 v[52:55], a[176:179], v[228:231], v[52:55]
    v_mfma_f32_16x16x32_bf16 v[56:59], a[160:163], v[232:235], v[56:59]
    v_mfma_f32_16x16x32_bf16 v[60:63], a[164:167], v[232:235], v[60:63]
    buffer_load_dwordx4 v[152:155], v11, s[8:11], 0 offen offset:32
    v_mfma_f32_16x16x32_bf16 v[64:67], a[168:171], v[232:235], v[64:67]
    v_mfma_f32_16x16x32_bf16 v[68:71], a[172:175], v[232:235], v[68:71]
    v_mfma_f32_16x16x32_bf16 v[72:75], a[176:179], v[232:235], v[72:75]
    v_mfma_f32_16x16x32_bf16 v[76:79], a[160:163], v[236:239], v[76:79]
    buffer_load_dwordx4 v[156:159], v11, s[8:11], 0 offen offset:48
    v_mfma_f32_16x16x32_bf16 v[80:83], a[164:167], v[236:239], v[80:83]
    v_mfma_f32_16x16x32_bf16 v[84:87], a[168:171], v[236:239], v[84:87]
    v_mfma_f32_16x16x32_bf16 v[88:91], a[172:175], v[236:239], v[88:91]
    v_mfma_f32_16x16x32_bf16 v[92:95], a[176:179], v[236:239], v[92:95]
    buffer_load_dwordx4 v[160:163], v11, s[8:11], 0 offen offset:64
    s_waitcnt vmcnt(18)
    v_mfma_f32_16x16x32_bf16 v[16:19], a[180:183], v[96:99], v[16:19]
    v_mfma_f32_16x16x32_bf16 v[20:23], a[184:187], v[96:99], v[20:23]
    v_mfma_f32_16x16x32_bf16 v[24:27], a[188:191], v[96:99], v[24:27]
    v_mfma_f32_16x16x32_bf16 v[28:31], a[192:195], v[96:99], v[28:31]
    v_mfma_f32_16x16x32_bf16 v[32:35], a[196:199], v[96:99], v[32:35]
    v_mfma_f32_16x16x32_bf16 v[36:39], a[180:183], v[100:103], v[36:39]
    v_mfma_f32_16x16x32_bf16 v[40:43], a[184:187], v[100:103], v[40:43]
    v_mfma_f32_16x16x32_bf16 v[44:47], a[188:191], v[100:103], v[44:47]
    v_mfma_f32_16x16x32_bf16 v[48:51], a[192:195], v[100:103], v[48:51]
    v_mfma_f32_16x16x32_bf16 v[52:55], a[196:199], v[100:103], v[52:55]
    v_mfma_f32_16x16x32_bf16 v[56:59], a[180:183], v[104:107], v[56:59]
    v_mfma_f32_16x16x32_bf16 v[60:63], a[184:187], v[104:107], v[60:63]
    v_mfma_f32_16x16x32_bf16 v[64:67], a[188:191], v[104:107], v[64:67]
    v_mfma_f32_16x16x32_bf16 v[68:71], a[192:195], v[104:107], v[68:71]
    v_mfma_f32_16x16x32_bf16 v[72:75], a[196:199], v[104:107], v[72:75]
    v_mfma_f32_16x16x32_bf16 v[76:79], a[180:183], v[108:111], v[76:79]
    v_mfma_f32_16x16x32_bf16 v[80:83], a[184:187], v[108:111], v[80:83]
    v_mfma_f32_16x16x32_bf16 v[84:87], a[188:191], v[108:111], v[84:87]
    v_mfma_f32_16x16x32_bf16 v[88:91], a[192:195], v[108:111], v[88:91]
    v_mfma_f32_16x16x32_bf16 v[92:95], a[196:199], v[108:111], v[92:95]
    s_waitcnt vmcnt(14)
    v_mfma_f32_16x16x32_bf16 v[16:19], a[200:203], v[112:115], v[16:19]
    v_mfma_f32_16x16x32_bf16 v[20:23], a[204:207], v[112:115], v[20:23]
    v_mfma_f32_16x16x32_bf16 v[24:27], a[208:211], v[112:115], v[24:27]
    v_mfma_f32_16x16x32_bf16 v[28:31], a[212:215], v[112:115], v[28:31]
    v_mfma_f32_16x16x32_bf16 v[32:35], a[216:219], v[112:115], v[32:35]
    v_mfma_f32_16x16x32_bf16 v[36:39], a[200:203], v[116:119], v[36:39]
    v_mfma_f32_16x16x32_bf16 v[40:43], a[204:207], v[116:119], v[40:43]
    v_mfma_f32_16x16x32_bf16 v[44:47], a[208:211], v[116:119], v[44:47]
    v_mfma_f32_16x16x32_bf16 v[48:51], a[212:215], v[116:119], v[48:51]
    v_mfma_f32_16x16x32_bf16 v[52:55], a[216:219], v[116:119], v[52:55]
    v_mfma_f32_16x16x32_bf16 v[56:59], a[200:203], v[120:123], v[56:59]
    v_mfma_f32_16x16x32_bf16 v[60:63], a[204:207], v[120:123], v[60:63]
    v_mfma_f32_16x16x32_bf16 v[64:67], a[208:211], v[120:123], v[64:67]
    v_mfma_f32_16x16x32_bf16 v[68:71], a[212:215], v[120:123], v[68:71]
    v_mfma_f32_16x16x32_bf16 v[72:75], a[216:219], v[120:123], v[72:75]
    v_mfma_f32_16x16x32_bf16 v[76:79], a[200:203], v[124:127], v[76:79]
    v_mfma_f32_16x16x32_bf16 v[80:83], a[204:207], v[124:127], v[80:83]
    v_mfma_f32_16x16x32_bf16 v[84:87], a[208:211], v[124:127], v[84:87]
    v_mfma_f32_16x16x32_bf16 v[88:91], a[212:215], v[124:127], v[88:91]
    v_mfma_f32_16x16x32_bf16 v[92:95], a[216:219], v[124:127], v[92:95]
    s_waitcnt vmcnt(10)
    v_mfma_f32_16x16x32_bf16 v[36:39], a[220:223], v[132:135], v[36:39]
    v_mfma_f32_16x16x32_bf16 v[40:43], a[224:227], v[132:135], v[40:43]
    v_mfma_f32_16x16x32_bf16 v[44:47], a[228:231], v[132:135], v[44:47]
    v_mfma_f32_16x16x32_bf16 v[48:51], a[232:235], v[132:135], v[48:51]
    v_mfma_f32_16x16x32_bf16 v[52:55], a[236:239], v[132:135], v[52:55]
    v_mfma_f32_16x16x32_bf16 v[56:59], a[220:223], v[136:139], v[56:59]
    v_mfma_f32_16x16x32_bf16 v[60:63], a[224:227], v[136:139], v[60:63]
    v_mfma_f32_16x16x32_bf16 v[64:67], a[228:231], v[136:139], v[64:67]
    s_nop 0
    ds_write_b128 v241, v[36:39] offset:0
    v_mfma_f32_16x16x32_bf16 v[68:71], a[232:235], v[136:139], v[68:71]
    ds_write_b128 v241, v[40:43] offset:1024
    v_mfma_f32_16x16x32_bf16 v[72:75], a[236:239], v[136:139], v[72:75]
    ds_write_b128 v241, v[44:47] offset:2048
    v_mfma_f32_16x16x32_bf16 v[76:79], a[220:223], v[140:143], v[76:79]
    ds_write_b128 v241, v[48:51] offset:3072
    v_mfma_f32_16x16x32_bf16 v[80:83], a[224:227], v[140:143], v[80:83]
    ds_write_b128 v241, v[52:55] offset:4096
    v_mfma_f32_16x16x32_bf16 v[84:87], a[228:231], v[140:143], v[84:87]
    ds_write_b128 v242, v[56:59] offset:0
    v_mfma_f32_16x16x32_bf16 v[88:91], a[232:235], v[140:143], v[88:91]
    ds_write_b128 v242, v[60:63] offset:1024
    v_mfma_f32_16x16x32_bf16 v[92:95], a[236:239], v[140:143], v[92:95]
    ds_write_b128 v242, v[64:67] offset:2048
    v_mfma_f32_16x16x32_bf16 v[16:19], a[220:223], v[128:131], v[16:19]
    ds_write_b128 v242, v[68:71] offset:3072
    v_mfma_f32_16x16x32_bf16 v[20:23], a[224:227], v[128:131], v[20:23]
    ds_write_b128 v242, v[72:75] offset:4096
    v_mfma_f32_16x16x32_bf16 v[24:27], a[228:231], v[128:131], v[24:27]
    ds_write_b128 v243, v[76:79] offset:0
    v_mfma_f32_16x16x32_bf16 v[28:31], a[232:235], v[128:131], v[28:31]
    ds_write_b128 v243, v[80:83] offset:1024
    v_mfma_f32_16x16x32_bf16 v[32:35], a[236:239], v[128:131], v[32:35]
    ds_write_b128 v243, v[84:87] offset:2048
    ds_write_b128 v243, v[88:91] offset:3072
    ds_write_b128 v243, v[92:95] offset:4096
    s_waitcnt lgkmcnt(0)
    s_barrier
    ds_read_b128 v[36:39], v240 offset:0
    ds_read_b128 v[56:59], v240 offset:5120
    ds_read_b128 v[76:79], v240 offset:10240
    ds_read_b128 v[40:43], v240 offset:1024
    ds_read_b128 v[60:63], v240 offset:6144
    ds_read_b128 v[80:83], v240 offset:11264
    ds_read_b128 v[44:47], v240 offset:2048
    ds_read_b128 v[64:67], v240 offset:7168
    ds_read_b128 v[84:87], v240 offset:12288
    ds_read_b128 v[48:51], v240 offset:3072
    ds_read_b128 v[68:71], v240 offset:8192
    ds_read_b128 v[88:91], v240 offset:13312
    ds_read_b128 v[52:55], v240 offset:4096
    ds_read_b128 v[72:75], v240 offset:9216
    ds_read_b128 v[92:95], v240 offset:14336
    s_waitcnt vmcnt(0)
    v_lshlrev_b32 v96, 16, v176
    v_and_b32 v97, 0xffff0000, v176
    v_lshlrev_b32 v98, 16, v177
    v_and_b32 v99, 0xffff0000, v177
    v_lshlrev_b32 v100, 16, v178
    v_and_b32 v101, 0xffff0000, v178
    v_lshlrev_b32 v102, 16, v179
    v_and_b32 v103, 0xffff0000, v179
    v_lshlrev_b32 v104, 16, v180
    v_and_b32 v105, 0xffff0000, v180
    v_lshlrev_b32 v106, 16, v181
    v_and_b32 v107, 0xffff0000, v181
    v_lshlrev_b32 v108, 16, v182
    v_and_b32 v109, 0xffff0000, v182
    v_lshlrev_b32 v110, 16, v183
    v_and_b32 v111, 0xffff0000, v183
    v_lshlrev_b32 v112, 16, v184
    v_and_b32 v113, 0xffff0000, v184
    v_lshlrev_b32 v114, 16, v185
    v_and_b32 v115, 0xffff0000, v185
    s_waitcnt lgkmcnt(12)
    v_pk_add_f32 v[16:17], v[16:17], v[36:37]
    v_pk_add_f32 v[56:57], v[56:57], v[76:77]
    v_pk_add_f32 v[18:19], v[18:19], v[38:39]
    v_pk_add_f32 v[58:59], v[58:59], v[78:79]
    v_pk_add_f32 v[16:17], v[16:17], v[56:57]
    v_pk_add_f32 v[18:19], v[18:19], v[58:59]
    v_pk_fma_f32 v[96:97], v[16:17], v[144:145], v[96:97]
    v_pk_fma_f32 v[98:99], v[18:19], v[146:147], v[98:99]
    v_cvt_pk_bf16_f32 v176, v96, v97
    v_cvt_pk_bf16_f32 v177, v98, v99
    ds_write_b64 v12, v[176:177] offset:0
    s_waitcnt lgkmcnt(10)
    v_pk_add_f32 v[20:21], v[20:21], v[40:41]
    v_pk_add_f32 v[60:61], v[60:61], v[80:81]
    v_pk_add_f32 v[22:23], v[22:23], v[42:43]
    v_pk_add_f32 v[62:63], v[62:63], v[82:83]
    v_pk_add_f32 v[20:21], v[20:21], v[60:61]
    v_pk_add_f32 v[22:23], v[22:23], v[62:63]
    v_pk_fma_f32 v[100:101], v[20:21], v[148:149], v[100:101]
    v_pk_fma_f32 v[102:103], v[22:23], v[150:151], v[102:103]
    v_cvt_pk_bf16_f32 v178, v100, v101
    v_cvt_pk_bf16_f32 v179, v102, v103
    ds_write_b64 v12, v[178:179] offset:8
    s_waitcnt lgkmcnt(8)
    v_pk_add_f32 v[24:25], v[24:25], v[44:45]
    v_pk_add_f32 v[64:65], v[64:65], v[84:85]
    v_pk_add_f32 v[26:27], v[26:27], v[46:47]
    v_pk_add_f32 v[66:67], v[66:67], v[86:87]
    v_pk_add_f32 v[24:25], v[24:25], v[64:65]
    v_pk_add_f32 v[26:27], v[26:27], v[66:67]
    v_pk_fma_f32 v[104:105], v[24:25], v[152:153], v[104:105]
    v_pk_fma_f32 v[106:107], v[26:27], v[154:155], v[106:107]
    v_cvt_pk_bf16_f32 v180, v104, v105
    v_cvt_pk_bf16_f32 v181, v106, v107
    ds_write_b64 v12, v[180:181] offset:16
    s_waitcnt lgkmcnt(6)
    v_pk_add_f32 v[28:29], v[28:29], v[48:49]
    v_pk_add_f32 v[68:69], v[68:69], v[88:89]
    v_pk_add_f32 v[30:31], v[30:31], v[50:51]
    v_pk_add_f32 v[70:71], v[70:71], v[90:91]
    v_pk_add_f32 v[28:29], v[28:29], v[68:69]
    v_pk_add_f32 v[30:31], v[30:31], v[70:71]
    v_pk_fma_f32 v[108:109], v[28:29], v[156:157], v[108:109]
    v_pk_fma_f32 v[110:111], v[30:31], v[158:159], v[110:111]
    v_cvt_pk_bf16_f32 v182, v108, v109
    v_cvt_pk_bf16_f32 v183, v110, v111
    ds_write_b64 v12, v[182:183] offset:24
    s_waitcnt lgkmcnt(4)
    v_pk_add_f32 v[32:33], v[32:33], v[52:53]
    v_pk_add_f32 v[72:73], v[72:73], v[92:93]
    v_pk_add_f32 v[34:35], v[34:35], v[54:55]
    v_pk_add_f32 v[74:75], v[74:75], v[94:95]
    v_pk_add_f32 v[32:33], v[32:33], v[72:73]
    v_pk_add_f32 v[34:35], v[34:35], v[74:75]
    v_pk_fma_f32 v[112:113], v[32:33], v[160:161], v[112:113]
    v_pk_fma_f32 v[114:115], v[34:35], v[162:163], v[114:115]
    v_cvt_pk_bf16_f32 v184, v112, v113
    v_cvt_pk_bf16_f32 v185, v114, v115
    ds_write_b64 v12, v[184:185] offset:32
    s_waitcnt lgkmcnt(0)
    ds_read_b128 v[16:19], v244
    ds_read_b128 v[20:23], v245
    ds_read_b128 v[24:27], v246
    s_waitcnt lgkmcnt(2)
    buffer_store_dwordx4 v[16:19], v247, s[12:15], 0 offen
    s_waitcnt lgkmcnt(1)
    buffer_store_dwordx4 v[20:23], v248, s[12:15], 0 offen
    s_waitcnt lgkmcnt(0)
    buffer_store_dwordx4 v[24:27], v249, s[12:15], 0 offen
KF_END:
    s_endpgm
.p2align 4
CODE_END:
.section .rodata,"a"
.p2align 6
.amdhsa_kernel k1_kernel
  .amdhsa_next_free_vgpr 164
  .amdhsa_next_free_sgpr 48
  .amdhsa_accum_offset 164
  .amdhsa_group_segment_fixed_size 0
  .amdhsa_kernarg_size 96
  .amdhsa_user_sgpr_count 2
  .amdhsa_user_sgpr_kernarg_segment_ptr 1
  .amdhsa_system_sgpr_workgroup_id_x 1
  .amdhsa_float_denorm_mode_32 3
  .amdhsa_float_denorm_mode_16_64 3
.end_amdhsa_kernel
.section .rodata,"a"
.p2align 6
.amdhsa_kernel k2_kernel
  .amdhsa_next_free_vgpr 232
  .amdhsa_next_free_sgpr 64
  .amdhsa_accum_offset 232
  .amdhsa_group_segment_fixed_size 0
  .amdhsa_kernarg_size 96
  .amdhsa_user_sgpr_count 2
  .amdhsa_user_sgpr_kernarg_segment_ptr 1
  .amdhsa_system_sgpr_workgroup_id_x 1
  .amdhsa_float_denorm_mode_32 3
  .amdhsa_float_denorm_mode_16_64 3
.end_amdhsa_kernel
.section .rodata,"a"
.p2align 6
.amdhsa_kernel kf_kernel
  .amdhsa_next_free_vgpr 496
  .amdhsa_next_free_sgpr 64
  .amdhsa_accum_offset 256
  .amdhsa_group_segment_fixed_size 0
  .amdhsa_kernarg_size 96
  .amdhsa_user_sgpr_count 2
  .amdhsa_user_sgpr_kernarg_segment_ptr 1
  .amdhsa_system_sgpr_workgroup_id_x 1
  .amdhsa_float_denorm_mode_32 3
  .amdhsa_float_denorm_mode_16_64 3
.end_amdhsa_kernel
```
